```python
import torch

def _softmax(x, axis=-1):
    return torch.softmax(x, dim=axis)
def _gelu(x):
    return torch.nn.functional.gelu(x, approximate="tanh")
def _silu(x):
    return torch.nn.functional.silu(x)
def _sigmoid(x):
    return torch.sigmoid(x)
def _layernorm(x, axis=-1, eps=1e-5):
    m = x.mean(dim=axis, keepdim=True)
    v = x.var(dim=axis, keepdim=True, unbiased=False)
    return (x - m) / torch.sqrt(v + eps)
def _scatter_add(tgt, idx, src, axis=0):
    return tgt.clone().index_add_(axis, idx, src)
def _segment_sum(src, seg, n):
    out = torch.zeros((n,) + src.shape[1:], dtype=src.dtype)
    return out.index_add_(0, seg, src)
def _pad(x, pw):
    flat = tuple(v for pair in reversed(pw) for v in pair)
    return torch.nn.functional.pad(x, flat)

kernel_name = 'interleave_layers__linear_kernel_hedgehog__geglu_ffn__prompt'

def setup_inputs():

    _w = (lambda a: (lambda t: t.to(torch.bfloat16) if t.is_floating_point() else t)(torch.as_tensor(a)))
    def _A_setup():
        B, S, D, H = 1, 2048, 640, 32
        Dh = D // H
        return {
            "x": _w((lambda *s: torch.randn(*s, dtype=torch.bfloat16) * 0.05)(B, S, D)),
            "wqkv": _w((lambda *s: torch.randn(*s, dtype=torch.bfloat16) * 0.2)(D, 3 * D)),
            "w_phi": _w((lambda *s: torch.randn(*s, dtype=torch.bfloat16) * 0.2)(H, Dh, Dh) * (Dh ** -0.5)),
            "wo": _w((lambda *s: torch.randn(*s, dtype=torch.bfloat16) * 0.05)(D, D)),
        }
    _A_in = _A_setup()

    def _B_setup():
        B, S, D, F = 1, 2048, 640, 1536
        return {
            "x": _w((lambda *s: torch.randn(*s, dtype=torch.bfloat16) * 0.05)(B, S, D)),
            "w_gate": _w((lambda *s: torch.randn(*s, dtype=torch.bfloat16) * 0.05)(D, F)),
            "w_up": _w((lambda *s: torch.randn(*s, dtype=torch.bfloat16) * 0.05)(D, F)),
            "w_down": _w((lambda *s: torch.randn(*s, dtype=torch.bfloat16) * 0.05)(F, D)),
        }
    _B_in = _B_setup()

    return {
        "A_x": _A_in["x"],
        "A_wqkv": _A_in["wqkv"],
        "A_w_phi": _A_in["w_phi"],
        "A_wo": _A_in["wo"],
        "B_x": _B_in["x"],
        "B_w_gate": _B_in["w_gate"],
        "B_w_up": _B_in["w_up"],
        "B_w_down": _B_in["w_down"],
    }

def reference(A_x, A_wqkv, A_w_phi, A_wo, B_x, B_w_gate, B_w_up, B_w_down):
    def _A_ref(x, wqkv, w_phi, wo):
        B, S, D = x.shape
        H = 32; Dh = D // H
        qkv = (lambda x, *d: x.permute(*d))((x @ wqkv).reshape(B, S, 3, H, Dh), 2, 0, 3, 1, 4)
        q, k, v = qkv[0], qkv[1], qkv[2]
        pq = torch.einsum("bhsd,hdf->bhsf", q, w_phi)
        pk = torch.einsum("bhsd,hdf->bhsf", k, w_phi)
        phi_q = torch.concatenate([_softmax(pq, axis=-1), _softmax(-pq, axis=-1)], axis=-1)
        phi_k = torch.concatenate([_softmax(pk, axis=-1), _softmax(-pk, axis=-1)], axis=-1)
        kv = torch.einsum("bhsf,bhsd->bhfd", phi_k, v)
        z  = torch.einsum("bhsf->bhf", phi_k)
        num = torch.einsum("bhqf,bhfd->bhqd", phi_q, kv)
        den = torch.einsum("bhqf,bhf->bhq", phi_q, z)[..., None] + 1e-6
        o = num / den
        return (lambda x, *d: x.permute(*d))(o, 0, 2, 1, 3).reshape(B, S, D) @ wo

    def _B_ref(x, w_gate, w_up, w_down):
        return (_gelu(x @ w_gate) * (x @ w_up)) @ w_down

    x = A_x
    x = x + _A_ref(_layernorm(x, axis=-1), A_wqkv, A_w_phi, A_wo)
    x = x + _B_ref(_layernorm(x, axis=-1), B_w_gate, B_w_up, B_w_down)
    x = x + _A_ref(_layernorm(x, axis=-1), A_wqkv, A_w_phi, A_wo)
    x = x + _B_ref(_layernorm(x, axis=-1), B_w_gate, B_w_up, B_w_down)
    return x
```

```asm
; @launch grid=(256,1,1) block=(256,1,1) lds=163840
.amdgcn_target "amdgcn-amd-amdhsa--gfx950"
.text
.globl interleave_layers__linear_kernel_hedgehog__geglu_ffn__prompt_kernel
.p2align 8
.type interleave_layers__linear_kernel_hedgehog__geglu_ffn__prompt_kernel,@function
interleave_layers__linear_kernel_hedgehog__geglu_ffn__prompt_kernel:
    s_cmp_ge_u32 s2, 256
    s_cbranch_scc1 L_done
    s_load_dwordx4 s[4:7], s[0:1], 0
    s_load_dwordx4 s[8:11], s[0:1], 16
    s_load_dwordx4 s[12:15], s[0:1], 40
    s_load_dwordx4 s[16:19], s[0:1], 56
    s_load_dwordx4 s[20:23], s[0:1], 72
    v_lshrrev_b32 v5, 6, v0
    v_and_b32 v1, 63, v0
    v_readfirstlane_b32 s24, v5
    v_lshlrev_b32 v2, 4, v1
    v_and_b32 v3, 15, v1
    v_lshrrev_b32 v4, 4, v1
    s_getpc_b64 s[70:71]
L_pc_here:
    s_lshr_b32 s46, s2, 3
    s_lshl_b32 s46, s46, 2
    s_add_u32 s46, s46, s24
    s_min_u32 s46, s46, ((L_done - L_pc_here) >> 9) - 1
    s_lshl_b32 s46, s46, 9
    s_add_u32 s70, s70, s46
    s_addc_u32 s71, s71, 0
    v_lshlrev_b32 v5, 3, v1
    global_load_dwordx2 v[126:127], v5, s[70:71]
    s_waitcnt lgkmcnt(0)
    s_mov_b32 s28, 0
    s_mov_b32 s59, 98304
    s_mov_b32 s58, 0
    s_cmp_eq_u32 s24, 3
    s_cbranch_scc1 L_a_x0_1
    s_cmp_ge_u32 s2, 192
    s_cbranch_scc1 L_a_phi_2
    s_lshr_b32 s60, s2, 6
    s_lshr_b32 s61, s2, 2
    s_and_b32 s61, s61, 15
    s_and_b32 s62, s2, 3
    s_mul_i32 s46, s62, 614400
    s_mul_i32 s47, s60, 1280
    s_add_u32 s46, s46, s47
    s_mul_i32 s47, s61, 80
    s_add_u32 s46, s46, s47
    s_add_u32 s40, s6, s46
    s_addc_u32 s41, s7, 0
    s_mov_b32 s42, 3840
    s_mov_b32 s43, 5
    s_mov_b32 s44, 13108
    s_mov_b32 s45, 799
    s_mul_i32 s46, s24, 320
    s_mul_i32 s47, s24, 5120
    v_add_u32 v10, s46, v1
    s_add_u32 s47, s47, 0
    v_add_u32 v11, 0, v10
    v_min_u32 v11, s45, v11
    v_mul_u32_u24 v12, s44, v11
    v_lshrrev_b32 v12, 16, v12
    v_mul_u32_u24 v13, s43, v12
    v_sub_u32 v13, v11, v13
    v_lshlrev_b32 v13, 4, v13
    v_mad_u32_u24 v14, v12, s42, v13
    s_add_u32 m0, s47, 0
    s_nop 0
    global_load_lds_dwordx4 v14, s[40:41]
    v_add_u32 v11, 64, v10
    v_min_u32 v11, s45, v11
    v_mul_u32_u24 v12, s44, v11
    v_lshrrev_b32 v12, 16, v12
    v_mul_u32_u24 v13, s43, v12
    v_sub_u32 v13, v11, v13
    v_lshlrev_b32 v13, 4, v13
    v_mad_u32_u24 v15, v12, s42, v13
    s_add_u32 m0, s47, 1024
    s_nop 0
    global_load_lds_dwordx4 v15, s[40:41]
    v_add_u32 v11, 128, v10
    v_min_u32 v11, s45, v11
    v_mul_u32_u24 v12, s44, v11
    v_lshrrev_b32 v12, 16, v12
    v_mul_u32_u24 v13, s43, v12
    v_sub_u32 v13, v11, v13
    v_lshlrev_b32 v13, 4, v13
    v_mad_u32_u24 v16, v12, s42, v13
    s_add_u32 m0, s47, 2048
    s_nop 0
    global_load_lds_dwordx4 v16, s[40:41]
    v_add_u32 v11, 192, v10
    v_min_u32 v11, s45, v11
    v_mul_u32_u24 v12, s44, v11
    v_lshrrev_b32 v12, 16, v12
    v_mul_u32_u24 v13, s43, v12
    v_sub_u32 v13, v11, v13
    v_lshlrev_b32 v13, 4, v13
    v_mad_u32_u24 v17, v12, s42, v13
    s_add_u32 m0, s47, 3072
    s_nop 0
    global_load_lds_dwordx4 v17, s[40:41]
    v_add_u32 v11, 256, v10
    v_min_u32 v11, s45, v11
    v_mul_u32_u24 v12, s44, v11
    v_lshrrev_b32 v12, 16, v12
    v_mul_u32_u24 v13, s43, v12
    v_sub_u32 v13, v11, v13
    v_lshlrev_b32 v13, 4, v13
    v_mad_u32_u24 v18, v12, s42, v13
    s_add_u32 m0, s47, 4096
    s_nop 0
    global_load_lds_dwordx4 v18, s[40:41]
    s_getreg_b32 s46, hwreg(HW_REG_XCC_ID, 0, 4)
    s_and_b32 s46, s46, 7
    s_lshl_b32 s46, s46, 2
    v_mov_b32 v5, s46
    v_mov_b32 v6, 1
    s_mov_b64 exec, 1
    s_cmp_lg_u32 s24, 0
    s_nop 2
    s_cbranch_scc1 L_rk_o_5
    global_atomic_add v124, v5, v6, s[20:21] sc0
    s_branch L_rk_j_6
L_rk_o_5:
    global_load_dword v126, v5, s[20:21] offset:192
L_rk_j_6:
    s_mov_b64 exec, -1
    s_min_u32 s46, s2, 223
    s_cmp_ge_u32 s46, 160
    s_cbranch_scc1 L_b_wd_8
    s_cmp_ge_u32 s46, 128
    s_cbranch_scc1 L_b_wo_7
    s_lshr_b32 s39, s46, 6
    s_lshr_b32 s37, s46, 2
    s_and_b32 s37, s37, 15
    s_and_b32 s38, s46, 3
    s_cmp_eq_u32 s39, 0
    s_cselect_b32 s48, s12, s14
    s_cselect_b32 s49, s13, s15
    s_mul_i32 s47, s38, 491520
    s_mul_i32 s50, s37, 192
    s_add_u32 s47, s47, s50
    s_add_u32 s30, s48, s47
    s_addc_u32 s31, s49, 0
    s_mov_b32 s32, 3072
    s_mov_b32 s33, 12
    s_mov_b32 s34, 5462
    s_mov_b32 s35, 1919
    s_mov_b32 s36, 0
    s_branch L_b_dec_9
L_b_wo_7:
    s_sub_u32 s46, s46, 128
    s_lshr_b32 s37, s46, 2
    s_and_b32 s38, s46, 3
    s_mul_i32 s47, s38, 204800
    s_mul_i32 s50, s37, 160
    s_add_u32 s47, s47, s50
    s_add_u32 s30, s10, s47
    s_addc_u32 s31, s11, 0
    s_mov_b32 s32, 1280
    s_mov_b32 s33, 10
    s_mov_b32 s34, 6554
    s_mov_b32 s35, 1599
    s_mov_b32 s36, 1
    s_mov_b32 s39, 0
    s_branch L_b_dec_9
L_b_wd_8:
    s_sub_u32 s46, s46, 160
    s_lshr_b32 s37, s46, 3
    s_and_b32 s38, s46, 7
    s_mul_i32 s47, s38, 245760
    s_mul_i32 s50, s37, 160
    s_add_u32 s47, s47, s50
    s_add_u32 s30, s16, s47
    s_addc_u32 s31, s17, 0
    s_mov_b32 s32, 1280
    s_mov_b32 s33, 10
    s_mov_b32 s34, 6554
    s_mov_b32 s35, 1919
    s_mov_b32 s36, 2
    s_mov_b32 s39, 0
L_b_dec_9:
    s_lshr_b32 s48, s24, 1
    v_add_u32 v245, 49152, v2
    v_lshlrev_b32 v246, 2, v1
    v_lshrrev_b32 v11, 1, v4
    v_and_b32 v12, 1, v4
    v_lshlrev_b32 v13, 7, v11
    s_lshl_b32 s46, s24, 5
    v_add3_u32 v13, v13, v3, s46
    v_mul_u32_u24 v14, 80, v13
    v_mul_u32_u24 v15, 40, v12
    v_add_u32 v14, v14, v15
    v_add_u32 v224, 131072, v14
    v_lshlrev_b32 v15, 6, v13
    v_lshl_add_u32 v15, v12, 4, v15
    v_add_u32 v225, 114688, v15
    v_lshlrev_b32 v14, 8, v11
    v_lshl_add_u32 v14, v3, 4, v14
    v_lshl_add_u32 v244, v12, 3, v14
    s_and_b32 s49, s24, 1
    v_bfe_u32 v11, v1, 2, 2
    v_lshl_add_u32 v11, v4, 3, v11
    s_lshl_b32 s47, s48, 7
    v_add_u32 v11, s47, v11
    v_and_b32 v12, 3, v1
    v_lshlrev_b32 v12, 3, v12
    v_mul_u32_u24 v13, 80, v11
    v_add_u32 v13, v13, v12
    v_add_u32 v226, 131072, v13
    v_lshlrev_b32 v14, 6, v11
    s_lshl_b32 s47, s49, 5
    s_add_u32 s47, s47, 114688
    v_add3_u32 v227, v14, v12, s47
    v_lshrrev_b32 v11, 2, v3
    v_lshlrev_b32 v11, 1, v11
    v_and_b32 v12, 1, v3
    v_add_u32 v11, v11, v12
    v_lshl_add_u32 v11, v4, 3, v11
    v_lshlrev_b32 v12, 4, v11
    v_lshlrev_b32 v13, 3, v11
    v_lshlrev_b32 v14, 3, v1
    v_add_u32 v235, 151552, v2
    v_add_u32 v236, 152576, v12
    v_add_u32 v237, 153088, v14
    v_add_u32 v238, 153344, v13
    s_cmp_eq_u32 s49, 1
    s_cselect_b64 vcc, -1, 0
    s_mov_b32 s94, 0x33333333
    s_cselect_b32 s94, s94, -1
    s_mov_b32 s95, s94
    s_mov_b32 s96, s94
    s_mov_b32 s97, 0
    v_add_u32 v12, 1024, v12
    v_cndmask_b32 v228, v2, v12, vcc
    v_add_u32 v13, 1792, v13
    v_add_u32 v14, 1536, v14
    v_cndmask_b32 v229, v14, v13, vcc
    v_lshlrev_b32 v11, 12, v4
    v_lshl_add_u32 v11, v3, 4, v11
    s_lshl_b32 s46, s24, 8
    v_add_u32 v11, s46, v11
    v_add_u32 v230, 0, v11
    v_add_u32 v231, 16384, v11
    v_add_u32 v232, 32768, v11
    v_add_u32 v233, 49152, v11
    v_lshlrev_b32 v11, 4, v3
    v_lshl_add_u32 v11, v4, 3, v11
    s_add_u32 s46, s46, 151552
    v_add_u32 v234, s46, v11
    s_lshl_b32 s46, s24, 5
    v_add_u32 v11, s46, v3
    v_mul_u32_u24 v11, 80, v11
    v_lshl_add_u32 v11, v4, 3, v11
    v_add_u32 v239, 131072, v11
    v_cmp_eq_u32 vcc, 0, v3
    s_nop 1
    v_cndmask_b32 v12, 0, 1, vcc
    v_cmp_eq_u32 vcc, 1, v3
    s_nop 1
    v_cndmask_b32 v13, 0, 1, vcc
    v_mul_u32_u24 v12, 0x3f80, v12
    v_mul_u32_u24 v13, 0x3f80, v13
    v_lshl_or_b32 v240, v13, 16, v12
    v_cmp_eq_u32 vcc, 2, v3
    s_nop 1
    v_cndmask_b32 v12, 0, 1, vcc
    v_cmp_eq_u32 vcc, 3, v3
    s_nop 1
    v_cndmask_b32 v13, 0, 1, vcc
    v_mul_u32_u24 v12, 0x3f80, v12
    v_mul_u32_u24 v13, 0x3f80, v13
    v_lshl_or_b32 v241, v13, 16, v12
    v_cmp_eq_u32 vcc, 4, v3
    s_nop 1
    v_cndmask_b32 v12, 0, 1, vcc
    v_cmp_eq_u32 vcc, 5, v3
    s_nop 1
    v_cndmask_b32 v13, 0, 1, vcc
    v_mul_u32_u24 v12, 0x3f80, v12
    v_mul_u32_u24 v13, 0x3f80, v13
    v_lshl_or_b32 v242, v13, 16, v12
    v_cmp_eq_u32 vcc, 6, v3
    s_nop 1
    v_cndmask_b32 v12, 0, 1, vcc
    v_cmp_eq_u32 vcc, 7, v3
    s_nop 1
    v_cndmask_b32 v13, 0, 1, vcc
    v_mul_u32_u24 v12, 0x3f80, v12
    v_mul_u32_u24 v13, 0x3f80, v13
    v_lshl_or_b32 v243, v13, 16, v12
    v_mov_b32 v24, 0x3f803f80
    v_mov_b32 v25, 0x3f803f80
    v_mov_b32 v26, 0x3f803f80
    v_mov_b32 v27, 0x3f803f80
    s_waitcnt vmcnt(1)
    v_mov_b32 v5, 140032
    v_mov_b32 v6, 0
    ds_write_b32 v5, v6
    s_waitcnt lgkmcnt(0)
    s_barrier
    v_mov_b32 v5, 128
    global_load_dword v125, v5, s[20:21] sc1
    v_lshrrev_b32 v5, 2, v3
    v_and_b32 v6, 3, v3
    v_lshrrev_b32 v7, 1, v5
    v_mul_u32_u24 v7, 20, v7
    v_and_b32 v8, 1, v5
    v_mul_u32_u24 v8, 10, v8
    v_add3_u32 v7, v7, v8, v6
    s_lshl_b32 s47, s24, 2
    v_add_u32 v7, s47, v7
    v_lshlrev_b32 v7, 1, v7
    v_mul_u32_u24 v8, 640, v4
    v_add_u32 v28, v7, v8
    s_cmp_eq_u32 s24, 2
    s_cselect_b32 s48, 1, 0
    s_cmp_eq_u32 s60, 2
    s_cselect_b32 s49, 1, 0
    s_and_b32 s49, s49, s48
    s_lshl_b32 s50, s49, 2
    v_subrev_u32 v28, s50, v28
    v_add_u32 v9, s47, v6
    v_cmp_gt_u32 vcc, 10, v9
    s_nop 1
    v_cndmask_b32 v30, 0, -1, vcc
    v_cmp_lt_u32 vcc, 1, v6
    s_nop 1
    v_cndmask_b32 v9, 0, -1, vcc
    s_cmp_eq_u32 s49, 1
    s_cselect_b64 vcc, -1, 0
    v_cndmask_b32 v30, v30, v9, vcc
    s_cmp_lg_u32 s60, 0
    s_cselect_b32 s50, 1, 0
    s_and_b32 s50, s50, s48
    s_cmp_eq_u32 s49, 1
    s_mov_b32 s66, 0x33333333
    s_cselect_b32 s66, 0xcccccccc, s66
    s_cmp_eq_u32 s50, 1
    s_cselect_b32 s66, s66, -1
    s_mov_b32 s67, s66
    s_and_b32 s68, s66, 0xffff
    s_mov_b32 s69, 0
    v_bfe_u32 v9, v28, 1, 1
    v_and_b32 v28, -4, v28
    v_mul_u32_u24 v9, 0x0202, v9
    v_lshl_or_b32 v9, v9, 16, v9
    v_add_u32 v109, 0x05040100, v9
    v_mov_b32 v9, 0x0c0c0c0c
    v_cmp_ne_u32 vcc, 0, v30
    s_nop 1
    v_cndmask_b32 v109, v9, v109, vcc
    v_add_u32 v110, 0, v28
    v_add_u32 v111, 320, v28
    v_add_u32 v112, 2560, v28
    v_add_u32 v113, 2880, v28
    v_add_u32 v114, 5120, v28
    v_add_u32 v115, 5440, v28
    v_add_u32 v116, 7680, v28
    v_add_u32 v117, 8000, v28
    v_add_u32 v118, 10240, v28
    v_add_u32 v119, 10560, v28
    ds_read2_b32 v[32:33], v110 offset0:0 offset1:20
    ds_read2_b32 v[34:35], v110 offset0:40 offset1:60
    ds_read2_b32 v[36:37], v111 offset0:0 offset1:20
    ds_read2_b32 v[38:39], v111 offset0:40 offset1:60
    ds_read2_b32 v[40:41], v112 offset0:0 offset1:20
    ds_read2_b32 v[42:43], v112 offset0:40 offset1:60
    ds_read2_b32 v[44:45], v113 offset0:0 offset1:20
    ds_read2_b32 v[46:47], v113 offset0:40 offset1:60
    ds_read2_b32 v[48:49], v114 offset0:0 offset1:20
    ds_read2_b32 v[50:51], v114 offset0:40 offset1:60
    ds_read2_b32 v[52:53], v115 offset0:0 offset1:20
    ds_read2_b32 v[54:55], v115 offset0:40 offset1:60
    ds_read2_b32 v[56:57], v116 offset0:0 offset1:20
    ds_read2_b32 v[58:59], v116 offset0:40 offset1:60
    ds_read2_b32 v[60:61], v117 offset0:0 offset1:20
    ds_read2_b32 v[62:63], v117 offset0:40 offset1:60
    ds_read2_b32 v[64:65], v118 offset0:0 offset1:20
    ds_read2_b32 v[66:67], v118 offset0:40 offset1:60
    ds_read2_b32 v[68:69], v119 offset0:0 offset1:20
    ds_read2_b32 v[70:71], v119 offset0:40 offset1:60
    s_waitcnt lgkmcnt(15)
    v_perm_b32 v80, v33, v32, v109
    v_perm_b32 v81, v35, v34, v109
    v_perm_b32 v82, v37, v36, v109
    v_perm_b32 v83, v39, v38, v109
    v_perm_b32 v84, v41, v40, v109
    s_waitcnt lgkmcnt(14)
    v_perm_b32 v85, v43, v42, v109
    s_waitcnt lgkmcnt(13)
    v_perm_b32 v86, v45, v44, v109
    s_waitcnt lgkmcnt(12)
    v_perm_b32 v87, v47, v46, v109
    s_waitcnt lgkmcnt(11)
    v_perm_b32 v88, v49, v48, v109
    s_waitcnt lgkmcnt(10)
    v_perm_b32 v89, v51, v50, v109
    s_waitcnt lgkmcnt(9)
    v_perm_b32 v90, v53, v52, v109
    s_waitcnt lgkmcnt(8)
    v_perm_b32 v91, v55, v54, v109
    s_waitcnt lgkmcnt(7)
    v_perm_b32 v92, v57, v56, v109
    s_waitcnt lgkmcnt(6)
    v_perm_b32 v93, v59, v58, v109
    s_waitcnt lgkmcnt(5)
    v_perm_b32 v94, v61, v60, v109
    s_waitcnt lgkmcnt(4)
    v_perm_b32 v95, v63, v62, v109
    s_waitcnt lgkmcnt(3)
    v_perm_b32 v96, v65, v64, v109
    s_waitcnt lgkmcnt(2)
    v_perm_b32 v97, v67, v66, v109
    s_waitcnt lgkmcnt(1)
    v_perm_b32 v98, v69, v68, v109
    s_waitcnt lgkmcnt(0)
    v_perm_b32 v99, v71, v70, v109
    v_mfma_f32_16x16x32_bf16 v[104:107], v[24:27], v[80:83], 0
    v_mfma_f32_16x16x32_bf16 v[104:107], v[24:27], v[84:87], v[104:107]
    v_mfma_f32_16x16x32_bf16 v[104:107], v[24:27], v[88:91], v[104:107]
    v_mfma_f32_16x16x32_bf16 v[104:107], v[24:27], v[92:95], v[104:107]
    v_mfma_f32_16x16x32_bf16 v[104:107], v[24:27], v[96:99], v[104:107]
    s_cmp_eq_u32 s60, 0
    s_cselect_b32 s54, 3, 5
    s_mov_b32 s48, 32768
    s_cselect_b32 s48, 1802240, s48
    s_lshl_b32 s54, s54, 10
    s_cmp_eq_u32 s60, 0
    s_mov_b32 s49, 110592
    s_cselect_b32 s49, 65536, s49
    s_mul_i32 s49, s49, s61
    s_add_u32 s48, s48, s49
    s_cmp_eq_u32 s60, 2
    s_cselect_b32 s49, 2, 0
    s_add_u32 s49, s49, s24
    s_cmp_eq_u32 s66, -1
    s_cselect_b32 s49, s49, 4
    s_lshl_b32 s49, s49, 10
    s_add_u32 s48, s48, s49
    s_mul_i32 s49, s54, 20
    s_add_u32 s49, s49, s48
    s_lshl_b32 s50, s62, 8
    s_add_u32 s49, s49, s50
    s_add_u32 s56, s22, s49
    s_addc_u32 s57, s23, 0
    s_mul_i32 s49, s62, 5
    s_mul_i32 s49, s49, s54
    s_add_u32 s48, s48, s49
    s_add_u32 s52, s22, s48
    s_addc_u32 s53, s23, 0
    s_mov_b64 exec, s[66:67]
    global_store_dwordx4 v2, v[80:83], s[52:53] sc1
    s_add_u32 s52, s52, s54
    s_addc_u32 s53, s53, 0
    global_store_dwordx4 v2, v[84:87], s[52:53] sc1
    s_add_u32 s52, s52, s54
    s_addc_u32 s53, s53, 0
    global_store_dwordx4 v2, v[88:91], s[52:53] sc1
    s_add_u32 s52, s52, s54
    s_addc_u32 s53, s53, 0
    global_store_dwordx4 v2, v[92:95], s[52:53] sc1
    s_add_u32 s52, s52, s54
    s_addc_u32 s53, s53, 0
    global_store_dwordx4 v2, v[96:99], s[52:53] sc1
    s_mov_b64 exec, -1
    v_cvt_pk_bf16_f32 v32, v104, v104
    v_and_b32 v36, 0xffff0000, v32
    v_sub_f32 v36, v104, v36
    v_mov_b32 v34, 0
    v_mov_b32 v35, 0
    v_cvt_pk_bf16_f32 v33, v36, v34
    s_mov_b64 exec, s[68:69]
    global_store_dwordx4 v2, v[32:35], s[56:57] sc1
    s_mov_b64 exec, -1
    s_lshl_b32 s58, s61, 7
    s_lshl_b32 s46, s60, 2
    s_add_u32 s46, s46, s62
    s_lshl_b32 s46, s46, 2
    s_add_u32 s58, s58, s46
    s_add_u32 s58, s58, 18432
    s_branch L_a_join_4
L_a_phi_2:
    s_xor_b32 s46, s2, 255
    s_or_b32 s46, s46, s24
    s_cmp_lg_u32 s46, 0
    s_cbranch_scc1 L_zero_skip_10
    s_add_u32 s52, s22, 4096
    s_addc_u32 s53, s23, 0
    v_mov_b32 v40, 0
    v_mov_b32 v41, 0
    v_mov_b32 v42, 0
    v_mov_b32 v43, 0
    v_add_u32 v5, 0, v2
    v_add_u32 v6, 8192, v2
    v_add_u32 v7, 16384, v2
    global_store_dwordx4 v5, v[40:43], s[52:53] offset:-4096 sc1
    global_store_dwordx4 v5, v[40:43], s[52:53] offset:-3072 sc1
    global_store_dwordx4 v5, v[40:43], s[52:53] offset:-2048 sc1
    global_store_dwordx4 v5, v[40:43], s[52:53] offset:-1024 sc1
    global_store_dwordx4 v5, v[40:43], s[52:53] offset:0 sc1
    global_store_dwordx4 v5, v[40:43], s[52:53] offset:1024 sc1
    global_store_dwordx4 v5, v[40:43], s[52:53] offset:2048 sc1
    global_store_dwordx4 v5, v[40:43], s[52:53] offset:3072 sc1
    global_store_dwordx4 v6, v[40:43], s[52:53] offset:-4096 sc1
    global_store_dwordx4 v6, v[40:43], s[52:53] offset:-3072 sc1
    global_store_dwordx4 v6, v[40:43], s[52:53] offset:-2048 sc1
    global_store_dwordx4 v6, v[40:43], s[52:53] offset:-1024 sc1
    global_store_dwordx4 v6, v[40:43], s[52:53] offset:0 sc1
    global_store_dwordx4 v6, v[40:43], s[52:53] offset:1024 sc1
    global_store_dwordx4 v6, v[40:43], s[52:53] offset:2048 sc1
    global_store_dwordx4 v6, v[40:43], s[52:53] offset:3072 sc1
    global_store_dwordx4 v7, v[40:43], s[52:53] offset:-4096 sc1
    global_store_dwordx4 v7, v[40:43], s[52:53] offset:-3072 sc1
    global_store_dwordx4 v7, v[40:43], s[52:53] offset:-2048 sc1
    global_store_dwordx4 v7, v[40:43], s[52:53] offset:-1024 sc1
    global_store_dwordx4 v7, v[40:43], s[52:53] offset:0 sc1
    global_store_dwordx4 v7, v[40:43], s[52:53] offset:1024 sc1
    global_store_dwordx4 v7, v[40:43], s[52:53] offset:2048 sc1
    global_store_dwordx4 v7, v[40:43], s[52:53] offset:3072 sc1
    s_waitcnt vmcnt(0)
    v_mov_b32 v5, 128
    v_mov_b32 v6, 1
    s_mov_b64 exec, 1
    global_store_dword v5, v6, s[20:21] sc1
    s_mov_b64 exec, -1
    s_waitcnt vmcnt(0)
    s_nop 0
L_zero_skip_10:
    s_sub_u32 s60, s2, 192
    s_min_u32 s64, s60, 15
    s_mul_i32 s46, s64, 1600
    s_add_u32 s40, s8, s46
    s_addc_u32 s41, s9, 0
    v_min_u32 v7, 99, v0
    v_lshlrev_b32 v7, 4, v7
    s_lshl_b32 s46, s24, 10
    s_mov_b32 m0, s46
    s_nop 0
    global_load_lds_dwordx4 v7, s[40:41]
    s_getreg_b32 s46, hwreg(HW_REG_XCC_ID, 0, 4)
    s_and_b32 s46, s46, 7
    s_lshl_b32 s46, s46, 2
    v_mov_b32 v5, s46
    v_mov_b32 v6, 1
    s_mov_b64 exec, 1
    s_cmp_lg_u32 s24, 0
    s_nop 2
    s_cbranch_scc1 L_rk_o_13
    global_atomic_add v124, v5, v6, s[20:21] sc0
    s_branch L_rk_j_14
L_rk_o_13:
    global_load_dword v126, v5, s[20:21] offset:192
L_rk_j_14:
    s_mov_b64 exec, -1
    s_min_u32 s46, s2, 223
    s_cmp_ge_u32 s46, 160
    s_cbranch_scc1 L_b_wd_16
    s_cmp_ge_u32 s46, 128
    s_cbranch_scc1 L_b_wo_15
    s_lshr_b32 s39, s46, 6
    s_lshr_b32 s37, s46, 2
    s_and_b32 s37, s37, 15
    s_and_b32 s38, s46, 3
    s_cmp_eq_u32 s39, 0
    s_cselect_b32 s48, s12, s14
    s_cselect_b32 s49, s13, s15
    s_mul_i32 s47, s38, 491520
    s_mul_i32 s50, s37, 192
    s_add_u32 s47, s47, s50
    s_add_u32 s30, s48, s47
    s_addc_u32 s31, s49, 0
    s_mov_b32 s32, 3072
    s_mov_b32 s33, 12
    s_mov_b32 s34, 5462
    s_mov_b32 s35, 1919
    s_mov_b32 s36, 0
    s_branch L_b_dec_17
L_b_wo_15:
    s_sub_u32 s46, s46, 128
    s_lshr_b32 s37, s46, 2
    s_and_b32 s38, s46, 3
    s_mul_i32 s47, s38, 204800
    s_mul_i32 s50, s37, 160
    s_add_u32 s47, s47, s50
    s_add_u32 s30, s10, s47
    s_addc_u32 s31, s11, 0
    s_mov_b32 s32, 1280
    s_mov_b32 s33, 10
    s_mov_b32 s34, 6554
    s_mov_b32 s35, 1599
    s_mov_b32 s36, 1
    s_mov_b32 s39, 0
    s_branch L_b_dec_17
L_b_wd_16:
    s_sub_u32 s46, s46, 160
    s_lshr_b32 s37, s46, 3
    s_and_b32 s38, s46, 7
    s_mul_i32 s47, s38, 245760
    s_mul_i32 s50, s37, 160
    s_add_u32 s47, s47, s50
    s_add_u32 s30, s16, s47
    s_addc_u32 s31, s17, 0
    s_mov_b32 s32, 1280
    s_mov_b32 s33, 10
    s_mov_b32 s34, 6554
    s_mov_b32 s35, 1919
    s_mov_b32 s36, 2
    s_mov_b32 s39, 0
L_b_dec_17:
    s_lshr_b32 s48, s24, 1
    v_add_u32 v245, 49152, v2
    v_lshlrev_b32 v246, 2, v1
    v_lshrrev_b32 v11, 1, v4
    v_and_b32 v12, 1, v4
    v_lshlrev_b32 v13, 7, v11
    s_lshl_b32 s46, s24, 5
    v_add3_u32 v13, v13, v3, s46
    v_mul_u32_u24 v14, 80, v13
    v_mul_u32_u24 v15, 40, v12
    v_add_u32 v14, v14, v15
    v_add_u32 v224, 131072, v14
    v_lshlrev_b32 v15, 6, v13
    v_lshl_add_u32 v15, v12, 4, v15
    v_add_u32 v225, 114688, v15
    v_lshlrev_b32 v14, 8, v11
    v_lshl_add_u32 v14, v3, 4, v14
    v_lshl_add_u32 v244, v12, 3, v14
    s_and_b32 s49, s24, 1
    v_bfe_u32 v11, v1, 2, 2
    v_lshl_add_u32 v11, v4, 3, v11
    s_lshl_b32 s47, s48, 7
    v_add_u32 v11, s47, v11
    v_and_b32 v12, 3, v1
    v_lshlrev_b32 v12, 3, v12
    v_mul_u32_u24 v13, 80, v11
    v_add_u32 v13, v13, v12
    v_add_u32 v226, 131072, v13
    v_lshlrev_b32 v14, 6, v11
    s_lshl_b32 s47, s49, 5
    s_add_u32 s47, s47, 114688
    v_add3_u32 v227, v14, v12, s47
    v_lshrrev_b32 v11, 2, v3
    v_lshlrev_b32 v11, 1, v11
    v_and_b32 v12, 1, v3
    v_add_u32 v11, v11, v12
    v_lshl_add_u32 v11, v4, 3, v11
    v_lshlrev_b32 v12, 4, v11
    v_lshlrev_b32 v13, 3, v11
    v_lshlrev_b32 v14, 3, v1
    v_add_u32 v235, 151552, v2
    v_add_u32 v236, 152576, v12
    v_add_u32 v237, 153088, v14
    v_add_u32 v238, 153344, v13
    s_cmp_eq_u32 s49, 1
    s_cselect_b64 vcc, -1, 0
    s_mov_b32 s94, 0x33333333
    s_cselect_b32 s94, s94, -1
    s_mov_b32 s95, s94
    s_mov_b32 s96, s94
    s_mov_b32 s97, 0
    v_add_u32 v12, 1024, v12
    v_cndmask_b32 v228, v2, v12, vcc
    v_add_u32 v13, 1792, v13
    v_add_u32 v14, 1536, v14
    v_cndmask_b32 v229, v14, v13, vcc
    v_lshlrev_b32 v11, 12, v4
    v_lshl_add_u32 v11, v3, 4, v11
    s_lshl_b32 s46, s24, 8
    v_add_u32 v11, s46, v11
    v_add_u32 v230, 0, v11
    v_add_u32 v231, 16384, v11
    v_add_u32 v232, 32768, v11
    v_add_u32 v233, 49152, v11
    v_lshlrev_b32 v11, 4, v3
    v_lshl_add_u32 v11, v4, 3, v11
    s_add_u32 s46, s46, 151552
    v_add_u32 v234, s46, v11
    s_lshl_b32 s46, s24, 5
    v_add_u32 v11, s46, v3
    v_mul_u32_u24 v11, 80, v11
    v_lshl_add_u32 v11, v4, 3, v11
    v_add_u32 v239, 131072, v11
    v_cmp_eq_u32 vcc, 0, v3
    s_nop 1
    v_cndmask_b32 v12, 0, 1, vcc
    v_cmp_eq_u32 vcc, 1, v3
    s_nop 1
    v_cndmask_b32 v13, 0, 1, vcc
    v_mul_u32_u24 v12, 0x3f80, v12
    v_mul_u32_u24 v13, 0x3f80, v13
    v_lshl_or_b32 v240, v13, 16, v12
    v_cmp_eq_u32 vcc, 2, v3
    s_nop 1
    v_cndmask_b32 v12, 0, 1, vcc
    v_cmp_eq_u32 vcc, 3, v3
    s_nop 1
    v_cndmask_b32 v13, 0, 1, vcc
    v_mul_u32_u24 v12, 0x3f80, v12
    v_mul_u32_u24 v13, 0x3f80, v13
    v_lshl_or_b32 v241, v13, 16, v12
    v_cmp_eq_u32 vcc, 4, v3
    s_nop 1
    v_cndmask_b32 v12, 0, 1, vcc
    v_cmp_eq_u32 vcc, 5, v3
    s_nop 1
    v_cndmask_b32 v13, 0, 1, vcc
    v_mul_u32_u24 v12, 0x3f80, v12
    v_mul_u32_u24 v13, 0x3f80, v13
    v_lshl_or_b32 v242, v13, 16, v12
    v_cmp_eq_u32 vcc, 6, v3
    s_nop 1
    v_cndmask_b32 v12, 0, 1, vcc
    v_cmp_eq_u32 vcc, 7, v3
    s_nop 1
    v_cndmask_b32 v13, 0, 1, vcc
    v_mul_u32_u24 v12, 0x3f80, v12
    v_mul_u32_u24 v13, 0x3f80, v13
    v_lshl_or_b32 v243, v13, 16, v12
    s_waitcnt vmcnt(1)
    v_mov_b32 v5, 140032
    v_mov_b32 v6, 0
    ds_write_b32 v5, v6
    s_waitcnt lgkmcnt(0)
    s_barrier
    v_mov_b32 v5, 128
    global_load_dword v125, v5, s[20:21] sc1
    s_mov_b32 s58, 0
    s_cmp_ge_u32 s60, 16
    s_nop 1
    s_cbranch_scc1 L_nophi_11
    s_mov_b32 s55, s24
    s_cmp_ge_u32 s55, 3
    s_cselect_b32 s63, 1, 0
    s_mul_i32 s64, s63, 3
    s_sub_u32 s64, s55, s64
    v_lshrrev_b32 v5, 2, v3
    v_and_b32 v6, 3, v3
    v_and_b32 v7, 1, v5
    v_mul_u32_u24 v7, 10, v7
    s_lshl_b32 s47, s64, 2
    v_add_u32 v9, s47, v6
    v_add_u32 v7, v7, v9
    v_and_b32 v8, 1, v4
    v_mul_u32_u24 v8, 200, v8
    s_mul_i32 s48, s63, 160
    v_add_u32 v8, s48, v8
    v_lshrrev_b32 v10, 1, v4
    v_mul_u32_u24 v11, 400, v10
    v_add3_u32 v7, v7, v8, v11
    v_lshlrev_b32 v28, 1, v7
    v_lshrrev_b32 v5, 1, v5
    v_cmp_eq_u32 vcc, v5, v10
    s_nop 1
    v_cndmask_b32 v30, 0, -1, vcc
    v_cmp_gt_u32 vcc, 10, v9
    s_nop 1
    v_cndmask_b32 v30, 0, v30, vcc
    s_cmp_eq_u32 s63, 0
    s_cselect_b32 s49, -1, 0
    v_and_b32 v31, s49, v30
    ds_read_u16 v32, v28 offset:0
    ds_read_u16_d16_hi v33, v28 offset:40
    ds_read_u16 v34, v28 offset:80
    ds_read_u16_d16_hi v35, v28 offset:120
    ds_read_u16 v36, v28 offset:160
    ds_read_u16_d16_hi v37, v28 offset:200
    ds_read_u16 v38, v28 offset:240
    ds_read_u16_d16_hi v39, v28 offset:280
    s_waitcnt lgkmcnt(6)
    v_or_b32 v80, v32, v33
    v_and_b32 v80, v30, v80
    s_waitcnt lgkmcnt(4)
    v_or_b32 v81, v34, v35
    v_and_b32 v81, v31, v81
    s_waitcnt lgkmcnt(2)
    v_or_b32 v82, v36, v37
    v_and_b32 v82, v31, v82
    s_waitcnt lgkmcnt(0)
    v_or_b32 v83, v38, v39
    v_and_b32 v83, v31, v83
    s_mul_i32 s48, s60, 6
    s_add_u32 s48, s48, s55
    s_lshl_b32 s48, s48, 10
    s_add_u32 s48, s48, 2850816
    s_add_u32 s52, s22, s48
    s_addc_u32 s53, s23, 0
    global_store_dwordx4 v2, v[80:83], s[52:53] sc1
    s_add_u32 s55, s24, 3
    s_cmp_ge_u32 s55, 6
    s_cbranch_scc1 L_tile_end_18
    s_cmp_ge_u32 s55, 3
    s_cselect_b32 s63, 1, 0
    s_mul_i32 s64, s63, 3
    s_sub_u32 s64, s55, s64
    v_lshrrev_b32 v5, 2, v3
    v_and_b32 v6, 3, v3
    v_and_b32 v7, 1, v5
    v_mul_u32_u24 v7, 10, v7
    s_lshl_b32 s47, s64, 2
    v_add_u32 v9, s47, v6
    v_add_u32 v7, v7, v9
    v_and_b32 v8, 1, v4
    v_mul_u32_u24 v8, 200, v8
    s_mul_i32 s48, s63, 160
    v_add_u32 v8, s48, v8
    v_lshrrev_b32 v10, 1, v4
    v_mul_u32_u24 v11, 400, v10
    v_add3_u32 v7, v7, v8, v11
    v_lshlrev_b32 v28, 1, v7
    v_lshrrev_b32 v5, 1, v5
    v_cmp_eq_u32 vcc, v5, v10
    s_nop 1
    v_cndmask_b32 v30, 0, -1, vcc
    v_cmp_gt_u32 vcc, 10, v9
    s_nop 1
    v_cndmask_b32 v30, 0, v30, vcc
    s_cmp_eq_u32 s63, 0
    s_cselect_b32 s49, -1, 0
    v_and_b32 v31, s49, v30
    ds_read_u16 v32, v28 offset:0
    ds_read_u16_d16_hi v33, v28 offset:40
    ds_read_u16 v34, v28 offset:80
    ds_read_u16_d16_hi v35, v28 offset:120
    ds_read_u16 v36, v28 offset:160
    ds_read_u16_d16_hi v37, v28 offset:200
    ds_read_u16 v38, v28 offset:240
    ds_read_u16_d16_hi v39, v28 offset:280
    s_waitcnt lgkmcnt(6)
    v_or_b32 v80, v32, v33
    v_and_b32 v80, v30, v80
    s_waitcnt lgkmcnt(4)
    v_or_b32 v81, v34, v35
    v_and_b32 v81, v31, v81
    s_waitcnt lgkmcnt(2)
    v_or_b32 v82, v36, v37
    v_and_b32 v82, v31, v82
    s_waitcnt lgkmcnt(0)
    v_or_b32 v83, v38, v39
    v_and_b32 v83, v31, v83
    s_mul_i32 s48, s60, 6
    s_add_u32 s48, s48, s55
    s_lshl_b32 s48, s48, 10
    s_add_u32 s48, s48, 2850816
    s_add_u32 s52, s22, s48
    s_addc_u32 s53, s23, 0
    global_store_dwordx4 v2, v[80:83], s[52:53] sc1
    s_nop 1
L_tile_end_18:
    s_lshl_b32 s58, s60, 7
    s_add_u32 s58, s58, 18480
L_nophi_11:
    s_branch L_a_join_4
L_a_x0_1:
    s_lshr_b32 s61, s2, 1
    s_and_b32 s63, s2, 1
    s_mul_i32 s46, s61, 20480
    s_mul_i32 s47, s63, 640
    s_add_u32 s46, s46, s47
    s_add_u32 s40, s4, s46
    s_addc_u32 s41, s5, 0
    v_mul_u32_u24 v5, 1280, v3
    v_lshlrev_b32 v6, 4, v4
    v_add_u32 v5, v5, v6
    global_load_dwordx4 v[40:43], v5, s[40:41] offset:0
    global_load_dwordx4 v[44:47], v5, s[40:41] offset:64
    global_load_dwordx4 v[48:51], v5, s[40:41] offset:128
    global_load_dwordx4 v[52:55], v5, s[40:41] offset:192
    global_load_dwordx4 v[56:59], v5, s[40:41] offset:256
    global_load_dwordx4 v[60:63], v5, s[40:41] offset:320
    global_load_dwordx4 v[64:67], v5, s[40:41] offset:384
    global_load_dwordx4 v[68:71], v5, s[40:41] offset:448
    global_load_dwordx4 v[72:75], v5, s[40:41] offset:512
    global_load_dwordx4 v[76:79], v5, s[40:41] offset:576
    s_getreg_b32 s46, hwreg(HW_REG_XCC_ID, 0, 4)
    s_and_b32 s46, s46, 7
    s_lshl_b32 s46, s46, 2
    v_mov_b32 v5, s46
    v_mov_b32 v6, 1
    s_mov_b64 exec, 1
    s_cmp_lg_u32 s24, 0
    s_nop 2
    s_cbranch_scc1 L_rk_o_19
    global_atomic_add v124, v5, v6, s[20:21] sc0
    s_branch L_rk_j_20
L_rk_o_19:
    global_load_dword v126, v5, s[20:21] offset:192
L_rk_j_20:
    s_mov_b64 exec, -1
    s_min_u32 s46, s2, 223
    s_cmp_ge_u32 s46, 160
    s_cbranch_scc1 L_b_wd_22
    s_cmp_ge_u32 s46, 128
    s_cbranch_scc1 L_b_wo_21
    s_lshr_b32 s39, s46, 6
    s_lshr_b32 s37, s46, 2
    s_and_b32 s37, s37, 15
    s_and_b32 s38, s46, 3
    s_cmp_eq_u32 s39, 0
    s_cselect_b32 s48, s12, s14
    s_cselect_b32 s49, s13, s15
    s_mul_i32 s47, s38, 491520
    s_mul_i32 s50, s37, 192
    s_add_u32 s47, s47, s50
    s_add_u32 s30, s48, s47
    s_addc_u32 s31, s49, 0
    s_mov_b32 s32, 3072
    s_mov_b32 s33, 12
    s_mov_b32 s34, 5462
    s_mov_b32 s35, 1919
    s_mov_b32 s36, 0
    s_branch L_b_dec_23
L_b_wo_21:
    s_sub_u32 s46, s46, 128
    s_lshr_b32 s37, s46, 2
    s_and_b32 s38, s46, 3
    s_mul_i32 s47, s38, 204800
    s_mul_i32 s50, s37, 160
    s_add_u32 s47, s47, s50
    s_add_u32 s30, s10, s47
    s_addc_u32 s31, s11, 0
    s_mov_b32 s32, 1280
    s_mov_b32 s33, 10
    s_mov_b32 s34, 6554
    s_mov_b32 s35, 1599
    s_mov_b32 s36, 1
    s_mov_b32 s39, 0
    s_branch L_b_dec_23
L_b_wd_22:
    s_sub_u32 s46, s46, 160
    s_lshr_b32 s37, s46, 3
    s_and_b32 s38, s46, 7
    s_mul_i32 s47, s38, 245760
    s_mul_i32 s50, s37, 160
    s_add_u32 s47, s47, s50
    s_add_u32 s30, s16, s47
    s_addc_u32 s31, s17, 0
    s_mov_b32 s32, 1280
    s_mov_b32 s33, 10
    s_mov_b32 s34, 6554
    s_mov_b32 s35, 1919
    s_mov_b32 s36, 2
    s_mov_b32 s39, 0
L_b_dec_23:
    s_lshr_b32 s48, s24, 1
    v_add_u32 v245, 49152, v2
    v_lshlrev_b32 v246, 2, v1
    v_lshrrev_b32 v11, 1, v4
    v_and_b32 v12, 1, v4
    v_lshlrev_b32 v13, 7, v11
    s_lshl_b32 s46, s24, 5
    v_add3_u32 v13, v13, v3, s46
    v_mul_u32_u24 v14, 80, v13
    v_mul_u32_u24 v15, 40, v12
    v_add_u32 v14, v14, v15
    v_add_u32 v224, 131072, v14
    v_lshlrev_b32 v15, 6, v13
    v_lshl_add_u32 v15, v12, 4, v15
    v_add_u32 v225, 114688, v15
    v_lshlrev_b32 v14, 8, v11
    v_lshl_add_u32 v14, v3, 4, v14
    v_lshl_add_u32 v244, v12, 3, v14
    s_and_b32 s49, s24, 1
    v_bfe_u32 v11, v1, 2, 2
    v_lshl_add_u32 v11, v4, 3, v11
    s_lshl_b32 s47, s48, 7
    v_add_u32 v11, s47, v11
    v_and_b32 v12, 3, v1
    v_lshlrev_b32 v12, 3, v12
    v_mul_u32_u24 v13, 80, v11
    v_add_u32 v13, v13, v12
    v_add_u32 v226, 131072, v13
    v_lshlrev_b32 v14, 6, v11
    s_lshl_b32 s47, s49, 5
    s_add_u32 s47, s47, 114688
    v_add3_u32 v227, v14, v12, s47
    v_lshrrev_b32 v11, 2, v3
    v_lshlrev_b32 v11, 1, v11
    v_and_b32 v12, 1, v3
    v_add_u32 v11, v11, v12
    v_lshl_add_u32 v11, v4, 3, v11
    v_lshlrev_b32 v12, 4, v11
    v_lshlrev_b32 v13, 3, v11
    v_lshlrev_b32 v14, 3, v1
    v_add_u32 v235, 151552, v2
    v_add_u32 v236, 152576, v12
    v_add_u32 v237, 153088, v14
    v_add_u32 v238, 153344, v13
    s_cmp_eq_u32 s49, 1
    s_cselect_b64 vcc, -1, 0
    s_mov_b32 s94, 0x33333333
    s_cselect_b32 s94, s94, -1
    s_mov_b32 s95, s94
    s_mov_b32 s96, s94
    s_mov_b32 s97, 0
    v_add_u32 v12, 1024, v12
    v_cndmask_b32 v228, v2, v12, vcc
    v_add_u32 v13, 1792, v13
    v_add_u32 v14, 1536, v14
    v_cndmask_b32 v229, v14, v13, vcc
    v_lshlrev_b32 v11, 12, v4
    v_lshl_add_u32 v11, v3, 4, v11
    s_lshl_b32 s46, s24, 8
    v_add_u32 v11, s46, v11
    v_add_u32 v230, 0, v11
    v_add_u32 v231, 16384, v11
    v_add_u32 v232, 32768, v11
    v_add_u32 v233, 49152, v11
    v_lshlrev_b32 v11, 4, v3
    v_lshl_add_u32 v11, v4, 3, v11
    s_add_u32 s46, s46, 151552
    v_add_u32 v234, s46, v11
    s_lshl_b32 s46, s24, 5
    v_add_u32 v11, s46, v3
    v_mul_u32_u24 v11, 80, v11
    v_lshl_add_u32 v11, v4, 3, v11
    v_add_u32 v239, 131072, v11
    v_cmp_eq_u32 vcc, 0, v3
    s_nop 1
    v_cndmask_b32 v12, 0, 1, vcc
    v_cmp_eq_u32 vcc, 1, v3
    s_nop 1
    v_cndmask_b32 v13, 0, 1, vcc
    v_mul_u32_u24 v12, 0x3f80, v12
    v_mul_u32_u24 v13, 0x3f80, v13
    v_lshl_or_b32 v240, v13, 16, v12
    v_cmp_eq_u32 vcc, 2, v3
    s_nop 1
    v_cndmask_b32 v12, 0, 1, vcc
    v_cmp_eq_u32 vcc, 3, v3
    s_nop 1
    v_cndmask_b32 v13, 0, 1, vcc
    v_mul_u32_u24 v12, 0x3f80, v12
    v_mul_u32_u24 v13, 0x3f80, v13
    v_lshl_or_b32 v241, v13, 16, v12
    v_cmp_eq_u32 vcc, 4, v3
    s_nop 1
    v_cndmask_b32 v12, 0, 1, vcc
    v_cmp_eq_u32 vcc, 5, v3
    s_nop 1
    v_cndmask_b32 v13, 0, 1, vcc
    v_mul_u32_u24 v12, 0x3f80, v12
    v_mul_u32_u24 v13, 0x3f80, v13
    v_lshl_or_b32 v242, v13, 16, v12
    v_cmp_eq_u32 vcc, 6, v3
    s_nop 1
    v_cndmask_b32 v12, 0, 1, vcc
    v_cmp_eq_u32 vcc, 7, v3
    s_nop 1
    v_cndmask_b32 v13, 0, 1, vcc
    v_mul_u32_u24 v12, 0x3f80, v12
    v_mul_u32_u24 v13, 0x3f80, v13
    v_lshl_or_b32 v243, v13, 16, v12
    s_barrier
    s_mul_i32 s46, s61, 20480
    s_mul_i32 s47, s63, 10240
    s_add_u32 s46, s46, s47
    s_add_u32 s46, s46, 9867264
    s_add_u32 s52, s22, s46
    s_addc_u32 s53, s23, 0
    v_add_u32 v7, 8192, v2
    s_waitcnt vmcnt(1)
    global_store_dwordx4 v2, v[40:43], s[52:53] offset:-4096 sc1
    global_store_dwordx4 v2, v[44:47], s[52:53] offset:-3072 sc1
    global_store_dwordx4 v2, v[48:51], s[52:53] offset:-2048 sc1
    global_store_dwordx4 v2, v[52:55], s[52:53] offset:-1024 sc1
    global_store_dwordx4 v2, v[56:59], s[52:53] offset:0 sc1
    global_store_dwordx4 v2, v[60:63], s[52:53] offset:1024 sc1
    global_store_dwordx4 v2, v[64:67], s[52:53] offset:2048 sc1
    global_store_dwordx4 v2, v[68:71], s[52:53] offset:3072 sc1
    global_store_dwordx4 v7, v[72:75], s[52:53] offset:-4096 sc1
    global_store_dwordx4 v7, v[76:79], s[52:53] offset:-3072 sc1
    v_mov_b32 v82, 0x3f803f80
    v_mov_b32 v80, 0
    v_mov_b32 v81, 0
    v_mov_b32 v86, 0
    v_mov_b32 v87, 0
    v_dot2c_f32_bf16 v80, v40, v82
    v_dot2c_f32_bf16 v81, v40, v40
    v_dot2c_f32_bf16 v86, v41, v82
    v_dot2c_f32_bf16 v87, v41, v41
    v_dot2c_f32_bf16 v80, v42, v82
    v_dot2c_f32_bf16 v81, v42, v42
    v_dot2c_f32_bf16 v86, v43, v82
    v_dot2c_f32_bf16 v87, v43, v43
    v_dot2c_f32_bf16 v80, v44, v82
    v_dot2c_f32_bf16 v81, v44, v44
    v_dot2c_f32_bf16 v86, v45, v82
    v_dot2c_f32_bf16 v87, v45, v45
    v_dot2c_f32_bf16 v80, v46, v82
    v_dot2c_f32_bf16 v81, v46, v46
    v_dot2c_f32_bf16 v86, v47, v82
    v_dot2c_f32_bf16 v87, v47, v47
    v_dot2c_f32_bf16 v80, v48, v82
    v_dot2c_f32_bf16 v81, v48, v48
    v_dot2c_f32_bf16 v86, v49, v82
    v_dot2c_f32_bf16 v87, v49, v49
    v_dot2c_f32_bf16 v80, v50, v82
    v_dot2c_f32_bf16 v81, v50, v50
    v_dot2c_f32_bf16 v86, v51, v82
    v_dot2c_f32_bf16 v87, v51, v51
    v_dot2c_f32_bf16 v80, v52, v82
    v_dot2c_f32_bf16 v81, v52, v52
    v_dot2c_f32_bf16 v86, v53, v82
    v_dot2c_f32_bf16 v87, v53, v53
    v_dot2c_f32_bf16 v80, v54, v82
    v_dot2c_f32_bf16 v81, v54, v54
    v_dot2c_f32_bf16 v86, v55, v82
    v_dot2c_f32_bf16 v87, v55, v55
    v_dot2c_f32_bf16 v80, v56, v82
    v_dot2c_f32_bf16 v81, v56, v56
    v_dot2c_f32_bf16 v86, v57, v82
    v_dot2c_f32_bf16 v87, v57, v57
    v_dot2c_f32_bf16 v80, v58, v82
    v_dot2c_f32_bf16 v81, v58, v58
    v_dot2c_f32_bf16 v86, v59, v82
    v_dot2c_f32_bf16 v87, v59, v59
    v_dot2c_f32_bf16 v80, v60, v82
    v_dot2c_f32_bf16 v81, v60, v60
    v_dot2c_f32_bf16 v86, v61, v82
    v_dot2c_f32_bf16 v87, v61, v61
    v_dot2c_f32_bf16 v80, v62, v82
    v_dot2c_f32_bf16 v81, v62, v62
    v_dot2c_f32_bf16 v86, v63, v82
    v_dot2c_f32_bf16 v87, v63, v63
    v_dot2c_f32_bf16 v80, v64, v82
    v_dot2c_f32_bf16 v81, v64, v64
    v_dot2c_f32_bf16 v86, v65, v82
    v_dot2c_f32_bf16 v87, v65, v65
    v_dot2c_f32_bf16 v80, v66, v82
    v_dot2c_f32_bf16 v81, v66, v66
    v_dot2c_f32_bf16 v86, v67, v82
    v_dot2c_f32_bf16 v87, v67, v67
    v_dot2c_f32_bf16 v80, v68, v82
    v_dot2c_f32_bf16 v81, v68, v68
    v_dot2c_f32_bf16 v86, v69, v82
    v_dot2c_f32_bf16 v87, v69, v69
    v_dot2c_f32_bf16 v80, v70, v82
    v_dot2c_f32_bf16 v81, v70, v70
    v_dot2c_f32_bf16 v86, v71, v82
    v_dot2c_f32_bf16 v87, v71, v71
    v_dot2c_f32_bf16 v80, v72, v82
    v_dot2c_f32_bf16 v81, v72, v72
    v_dot2c_f32_bf16 v86, v73, v82
    v_dot2c_f32_bf16 v87, v73, v73
    v_dot2c_f32_bf16 v80, v74, v82
    v_dot2c_f32_bf16 v81, v74, v74
    v_dot2c_f32_bf16 v86, v75, v82
    v_dot2c_f32_bf16 v87, v75, v75
    v_dot2c_f32_bf16 v80, v76, v82
    v_dot2c_f32_bf16 v81, v76, v76
    v_dot2c_f32_bf16 v86, v77, v82
    v_dot2c_f32_bf16 v87, v77, v77
    v_dot2c_f32_bf16 v80, v78, v82
    v_dot2c_f32_bf16 v81, v78, v78
    v_dot2c_f32_bf16 v86, v79, v82
    v_dot2c_f32_bf16 v87, v79, v79
    s_nop 3
    v_add_f32 v80, v80, v86
    v_add_f32 v81, v81, v87
    v_mov_b32 v88, v80
    v_mov_b32 v89, v81
    s_nop 0
    v_permlane16_swap_b32 v80, v88
    v_permlane16_swap_b32 v81, v89
    v_add_f32 v80, v80, v88
    v_add_f32 v81, v81, v89
    v_mov_b32 v88, v80
    v_mov_b32 v89, v81
    s_nop 0
    v_permlane32_swap_b32 v80, v88
    v_permlane32_swap_b32 v81, v89
    v_add_f32 v80, v80, v88
    v_add_f32 v81, v81, v89
    s_lshl_b32 s46, s61, 10
    s_add_u32 s46, s46, 12484608
    s_add_u32 s52, s22, s46
    s_addc_u32 s53, s23, 0
    s_lshl_b32 s48, s63, 3
    v_add_u32 v90, s48, v2
    s_mov_b64 exec, 0xffff
    global_store_dwordx2 v90, v[80:81], s[52:53] sc1
    s_mov_b64 exec, -1
    v_mov_b32 v92, 0
    v_mov_b32 v93, 0
    v_mov_b32 v94, 0
    v_mov_b32 v95, 0
    s_mul_i32 s47, s63, 384
    v_add_u32 v91, s47, v2
    s_mov_b64 exec, 0xffffff
    global_store_dwordx4 v91, v[92:95], s[52:53] offset:256 sc1
    s_mov_b64 exec, -1
    s_mov_b32 s46, 0
    s_mov_b32 s47, 0
    v_add_u32 v10, s46, v1
    s_add_u32 s47, s47, 98304
    v_add_u32 v11, 0, v10
    v_min_u32 v11, s35, v11
    v_mul_u32_u24 v12, s34, v11
    v_lshrrev_b32 v12, 16, v12
    v_mul_u32_u24 v13, s33, v12
    v_sub_u32 v13, v11, v13
    v_lshlrev_b32 v13, 4, v13
    v_mad_u32_u24 v14, v12, s32, v13
    s_add_u32 m0, s47, 0
    s_nop 0
    global_load_lds_dwordx4 v14, s[30:31]
    v_add_u32 v11, 64, v10
    v_min_u32 v11, s35, v11
    v_mul_u32_u24 v12, s34, v11
    v_lshrrev_b32 v12, 16, v12
    v_mul_u32_u24 v13, s33, v12
    v_sub_u32 v13, v11, v13
    v_lshlrev_b32 v13, 4, v13
    v_mad_u32_u24 v15, v12, s32, v13
    s_add_u32 m0, s47, 1024
    s_nop 0
    global_load_lds_dwordx4 v15, s[30:31]
    v_add_u32 v11, 128, v10
    v_min_u32 v11, s35, v11
    v_mul_u32_u24 v12, s34, v11
    v_lshrrev_b32 v12, 16, v12
    v_mul_u32_u24 v13, s33, v12
    v_sub_u32 v13, v11, v13
    v_lshlrev_b32 v13, 4, v13
    v_mad_u32_u24 v16, v12, s32, v13
    s_add_u32 m0, s47, 2048
    s_nop 0
    global_load_lds_dwordx4 v16, s[30:31]
    v_add_u32 v11, 192, v10
    v_min_u32 v11, s35, v11
    v_mul_u32_u24 v12, s34, v11
    v_lshrrev_b32 v12, 16, v12
    v_mul_u32_u24 v13, s33, v12
    v_sub_u32 v13, v11, v13
    v_lshlrev_b32 v13, 4, v13
    v_mad_u32_u24 v17, v12, s32, v13
    s_add_u32 m0, s47, 3072
    s_nop 0
    global_load_lds_dwordx4 v17, s[30:31]
    v_add_u32 v11, 256, v10
    v_min_u32 v11, s35, v11
    v_mul_u32_u24 v12, s34, v11
    v_lshrrev_b32 v12, 16, v12
    v_mul_u32_u24 v13, s33, v12
    v_sub_u32 v13, v11, v13
    v_lshlrev_b32 v13, 4, v13
    v_mad_u32_u24 v18, v12, s32, v13
    s_add_u32 m0, s47, 4096
    s_nop 0
    global_load_lds_dwordx4 v18, s[30:31]
    v_add_u32 v11, 320, v10
    v_min_u32 v11, s35, v11
    v_mul_u32_u24 v12, s34, v11
    v_lshrrev_b32 v12, 16, v12
    v_mul_u32_u24 v13, s33, v12
    v_sub_u32 v13, v11, v13
    v_lshlrev_b32 v13, 4, v13
    v_mad_u32_u24 v19, v12, s32, v13
    s_add_u32 m0, s47, 5120
    s_nop 0
    global_load_lds_dwordx4 v19, s[30:31]
    v_add_u32 v11, 384, v10
    v_min_u32 v11, s35, v11
    v_mul_u32_u24 v12, s34, v11
    v_lshrrev_b32 v12, 16, v12
    v_mul_u32_u24 v13, s33, v12
    v_sub_u32 v13, v11, v13
    v_lshlrev_b32 v13, 4, v13
    v_mad_u32_u24 v20, v12, s32, v13
    s_add_u32 m0, s47, 6144
    s_nop 0
    global_load_lds_dwordx4 v20, s[30:31]
    v_add_u32 v11, 448, v10
    v_min_u32 v11, s35, v11
    v_mul_u32_u24 v12, s34, v11
    v_lshrrev_b32 v12, 16, v12
    v_mul_u32_u24 v13, s33, v12
    v_sub_u32 v13, v11, v13
    v_lshlrev_b32 v13, 4, v13
    v_mad_u32_u24 v21, v12, s32, v13
    s_add_u32 m0, s47, 7168
    s_nop 0
    global_load_lds_dwordx4 v21, s[30:31]
    v_add_u32 v11, 512, v10
    v_min_u32 v11, s35, v11
    v_mul_u32_u24 v12, s34, v11
    v_lshrrev_b32 v12, 16, v12
    v_mul_u32_u24 v13, s33, v12
    v_sub_u32 v13, v11, v13
    v_lshlrev_b32 v13, 4, v13
    v_mad_u32_u24 v14, v12, s32, v13
    s_add_u32 m0, s47, 8192
    s_nop 0
    global_load_lds_dwordx4 v14, s[30:31]
    v_add_u32 v11, 576, v10
    v_min_u32 v11, s35, v11
    v_mul_u32_u24 v12, s34, v11
    v_lshrrev_b32 v12, 16, v12
    v_mul_u32_u24 v13, s33, v12
    v_sub_u32 v13, v11, v13
    v_lshlrev_b32 v13, 4, v13
    v_mad_u32_u24 v15, v12, s32, v13
    s_add_u32 m0, s47, 9216
    s_nop 0
    global_load_lds_dwordx4 v15, s[30:31]
    v_add_u32 v11, 640, v10
    v_min_u32 v11, s35, v11
    v_mul_u32_u24 v12, s34, v11
    v_lshrrev_b32 v12, 16, v12
    v_mul_u32_u24 v13, s33, v12
    v_sub_u32 v13, v11, v13
    v_lshlrev_b32 v13, 4, v13
    v_mad_u32_u24 v16, v12, s32, v13
    s_add_u32 m0, s47, 10240
    s_nop 0
    global_load_lds_dwordx4 v16, s[30:31]
    v_add_u32 v11, 704, v10
    v_min_u32 v11, s35, v11
    v_mul_u32_u24 v12, s34, v11
    v_lshrrev_b32 v12, 16, v12
    v_mul_u32_u24 v13, s33, v12
    v_sub_u32 v13, v11, v13
    v_lshlrev_b32 v13, 4, v13
    v_mad_u32_u24 v17, v12, s32, v13
    s_add_u32 m0, s47, 11264
    s_nop 0
    global_load_lds_dwordx4 v17, s[30:31]
    v_add_u32 v11, 768, v10
    v_min_u32 v11, s35, v11
    v_mul_u32_u24 v12, s34, v11
    v_lshrrev_b32 v12, 16, v12
    v_mul_u32_u24 v13, s33, v12
    v_sub_u32 v13, v11, v13
    v_lshlrev_b32 v13, 4, v13
    v_mad_u32_u24 v18, v12, s32, v13
    s_add_u32 m0, s47, 12288
    s_nop 0
    global_load_lds_dwordx4 v18, s[30:31]
    v_add_u32 v11, 832, v10
    v_min_u32 v11, s35, v11
    v_mul_u32_u24 v12, s34, v11
    v_lshrrev_b32 v12, 16, v12
    v_mul_u32_u24 v13, s33, v12
    v_sub_u32 v13, v11, v13
    v_lshlrev_b32 v13, 4, v13
    v_mad_u32_u24 v19, v12, s32, v13
    s_add_u32 m0, s47, 13312
    s_nop 0
    global_load_lds_dwordx4 v19, s[30:31]
    v_add_u32 v11, 896, v10
    v_min_u32 v11, s35, v11
    v_mul_u32_u24 v12, s34, v11
    v_lshrrev_b32 v12, 16, v12
    v_mul_u32_u24 v13, s33, v12
    v_sub_u32 v13, v11, v13
    v_lshlrev_b32 v13, 4, v13
    v_mad_u32_u24 v20, v12, s32, v13
    s_add_u32 m0, s47, 14336
    s_nop 0
    global_load_lds_dwordx4 v20, s[30:31]
    v_add_u32 v11, 960, v10
    v_min_u32 v11, s35, v11
    v_mul_u32_u24 v12, s34, v11
    v_lshrrev_b32 v12, 16, v12
    v_mul_u32_u24 v13, s33, v12
    v_sub_u32 v13, v11, v13
    v_lshlrev_b32 v13, 4, v13
    v_mad_u32_u24 v21, v12, s32, v13
    s_add_u32 m0, s47, 15360
    s_nop 0
    global_load_lds_dwordx4 v21, s[30:31]
    v_add_u32 v11, 1024, v10
    v_min_u32 v11, s35, v11
    v_mul_u32_u24 v12, s34, v11
    v_lshrrev_b32 v12, 16, v12
    v_mul_u32_u24 v13, s33, v12
    v_sub_u32 v13, v11, v13
    v_lshlrev_b32 v13, 4, v13
    v_mad_u32_u24 v14, v12, s32, v13
    s_add_u32 m0, s47, 16384
    s_nop 0
    global_load_lds_dwordx4 v14, s[30:31]
    v_add_u32 v11, 1088, v10
    v_min_u32 v11, s35, v11
    v_mul_u32_u24 v12, s34, v11
    v_lshrrev_b32 v12, 16, v12
    v_mul_u32_u24 v13, s33, v12
    v_sub_u32 v13, v11, v13
    v_lshlrev_b32 v13, 4, v13
    v_mad_u32_u24 v15, v12, s32, v13
    s_add_u32 m0, s47, 17408
    s_nop 0
    global_load_lds_dwordx4 v15, s[30:31]
    v_add_u32 v11, 1152, v10
    v_min_u32 v11, s35, v11
    v_mul_u32_u24 v12, s34, v11
    v_lshrrev_b32 v12, 16, v12
    v_mul_u32_u24 v13, s33, v12
    v_sub_u32 v13, v11, v13
    v_lshlrev_b32 v13, 4, v13
    v_mad_u32_u24 v16, v12, s32, v13
    s_add_u32 m0, s47, 18432
    s_nop 0
    global_load_lds_dwordx4 v16, s[30:31]
    v_add_u32 v11, 1216, v10
    v_min_u32 v11, s35, v11
    v_mul_u32_u24 v12, s34, v11
    v_lshrrev_b32 v12, 16, v12
    v_mul_u32_u24 v13, s33, v12
    v_sub_u32 v13, v11, v13
    v_lshlrev_b32 v13, 4, v13
    v_mad_u32_u24 v17, v12, s32, v13
    s_add_u32 m0, s47, 19456
    s_nop 0
    global_load_lds_dwordx4 v17, s[30:31]
    v_add_u32 v11, 1280, v10
    v_min_u32 v11, s35, v11
    v_mul_u32_u24 v12, s34, v11
    v_lshrrev_b32 v12, 16, v12
    v_mul_u32_u24 v13, s33, v12
    v_sub_u32 v13, v11, v13
    v_lshlrev_b32 v13, 4, v13
    v_mad_u32_u24 v18, v12, s32, v13
    s_add_u32 m0, s47, 20480
    s_nop 0
    global_load_lds_dwordx4 v18, s[30:31]
    v_add_u32 v11, 1344, v10
    v_min_u32 v11, s35, v11
    v_mul_u32_u24 v12, s34, v11
    v_lshrrev_b32 v12, 16, v12
    v_mul_u32_u24 v13, s33, v12
    v_sub_u32 v13, v11, v13
    v_lshlrev_b32 v13, 4, v13
    v_mad_u32_u24 v19, v12, s32, v13
    s_add_u32 m0, s47, 21504
    s_nop 0
    global_load_lds_dwordx4 v19, s[30:31]
    v_add_u32 v11, 1408, v10
    v_min_u32 v11, s35, v11
    v_mul_u32_u24 v12, s34, v11
    v_lshrrev_b32 v12, 16, v12
    v_mul_u32_u24 v13, s33, v12
    v_sub_u32 v13, v11, v13
    v_lshlrev_b32 v13, 4, v13
    v_mad_u32_u24 v20, v12, s32, v13
    s_add_u32 m0, s47, 22528
    s_nop 0
    global_load_lds_dwordx4 v20, s[30:31]
    v_add_u32 v11, 1472, v10
    v_min_u32 v11, s35, v11
    v_mul_u32_u24 v12, s34, v11
    v_lshrrev_b32 v12, 16, v12
    v_mul_u32_u24 v13, s33, v12
    v_sub_u32 v13, v11, v13
    v_lshlrev_b32 v13, 4, v13
    v_mad_u32_u24 v21, v12, s32, v13
    s_add_u32 m0, s47, 23552
    s_nop 0
    global_load_lds_dwordx4 v21, s[30:31]
    v_add_u32 v11, 1536, v10
    v_min_u32 v11, s35, v11
    v_mul_u32_u24 v12, s34, v11
    v_lshrrev_b32 v12, 16, v12
    v_mul_u32_u24 v13, s33, v12
    v_sub_u32 v13, v11, v13
    v_lshlrev_b32 v13, 4, v13
    v_mad_u32_u24 v14, v12, s32, v13
    s_add_u32 m0, s47, 24576
    s_nop 0
    global_load_lds_dwordx4 v14, s[30:31]
    v_add_u32 v11, 1600, v10
    v_min_u32 v11, s35, v11
    v_mul_u32_u24 v12, s34, v11
    v_lshrrev_b32 v12, 16, v12
    v_mul_u32_u24 v13, s33, v12
    v_sub_u32 v13, v11, v13
    v_lshlrev_b32 v13, 4, v13
    v_mad_u32_u24 v15, v12, s32, v13
    s_add_u32 m0, s47, 25600
    s_nop 0
    global_load_lds_dwordx4 v15, s[30:31]
    v_add_u32 v11, 1664, v10
    v_min_u32 v11, s35, v11
    v_mul_u32_u24 v12, s34, v11
    v_lshrrev_b32 v12, 16, v12
    v_mul_u32_u24 v13, s33, v12
    v_sub_u32 v13, v11, v13
    v_lshlrev_b32 v13, 4, v13
    v_mad_u32_u24 v16, v12, s32, v13
    s_add_u32 m0, s47, 26624
    s_nop 0
    global_load_lds_dwordx4 v16, s[30:31]
    v_add_u32 v11, 1728, v10
    v_min_u32 v11, s35, v11
    v_mul_u32_u24 v12, s34, v11
    v_lshrrev_b32 v12, 16, v12
    v_mul_u32_u24 v13, s33, v12
    v_sub_u32 v13, v11, v13
    v_lshlrev_b32 v13, 4, v13
    v_mad_u32_u24 v17, v12, s32, v13
    s_add_u32 m0, s47, 27648
    s_nop 0
    global_load_lds_dwordx4 v17, s[30:31]
    v_add_u32 v11, 1792, v10
    v_min_u32 v11, s35, v11
    v_mul_u32_u24 v12, s34, v11
    v_lshrrev_b32 v12, 16, v12
    v_mul_u32_u24 v13, s33, v12
    v_sub_u32 v13, v11, v13
    v_lshlrev_b32 v13, 4, v13
    v_mad_u32_u24 v18, v12, s32, v13
    s_add_u32 m0, s47, 28672
    s_nop 0
    global_load_lds_dwordx4 v18, s[30:31]
    v_add_u32 v11, 1856, v10
    v_min_u32 v11, s35, v11
    v_mul_u32_u24 v12, s34, v11
    v_lshrrev_b32 v12, 16, v12
    v_mul_u32_u24 v13, s33, v12
    v_sub_u32 v13, v11, v13
    v_lshlrev_b32 v13, 4, v13
    v_mad_u32_u24 v19, v12, s32, v13
    s_add_u32 m0, s47, 29696
    s_nop 0
    global_load_lds_dwordx4 v19, s[30:31]
    s_nop 1
L_a_join_4:
    s_cmp_lg_u32 s24, 0
    s_cbranch_scc1 L_fa_o_24
    s_waitcnt vmcnt(0)
    s_barrier
    s_lshr_b32 s72, s2, 4
    s_lshl_b32 s72, s72, 7
    s_and_b32 s46, s2, 15
    s_lshl_b32 s46, s46, 2
    s_add_u32 s72, s72, s46
    s_add_u32 s72, s72, 16384
    s_mov_b32 s46, 0
    v_cmp_ne_u32 vcc, 0, v125
    s_nop 4
    s_cbranch_vccnz L_sigzb_28
    v_mov_b32 v5, 128
    s_nop 4
L_sigz_27:
    global_load_dword v6, v5, s[20:21] sc1
    s_waitcnt vmcnt(0)
    v_cmp_eq_u32 vcc, 0, v6
    s_add_u32 s46, s46, 1
    s_cmp_gt_u32 s46, 4000000
    s_nop 2
    s_cbranch_scc1 L_sigzb_28
    s_cbranch_vccnz L_sigz_27
L_sigzb_28:
    v_mov_b32 v5, s58
    v_mov_b32 v6, 1
    v_mov_b32 v7, s72
    s_mov_b64 exec, 1
    global_store_dword v7, v6, s[22:23] sc1
    s_cmp_lg_u32 s58, 0
    s_cselect_b64 exec, 1, 0
    global_store_dword v5, v6, s[22:23] sc1
    s_mov_b64 exec, -1
L_siga_26:
    v_lshlrev_b32 v5, 2, v1
    s_mov_b32 s46, 0
    s_mov_b64 exec, 0xff
    s_nop 2
L_w1poll_29:
    global_load_dword v6, v5, s[20:21] sc1
    s_mov_b32 s47, 0
    s_mov_b32 s48, 0
    s_waitcnt vmcnt(0)
    v_readlane_b32 s49, v6, 0
    s_nop 0
    s_add_u32 s47, s47, s49
    s_xor_b32 s49, s49, 32
    s_or_b32 s48, s48, s49
    v_readlane_b32 s49, v6, 1
    s_nop 0
    s_add_u32 s47, s47, s49
    s_xor_b32 s49, s49, 32
    s_or_b32 s48, s48, s49
    v_readlane_b32 s49, v6, 2
    s_nop 0
    s_add_u32 s47, s47, s49
    s_xor_b32 s49, s49, 32
    s_or_b32 s48, s48, s49
    v_readlane_b32 s49, v6, 3
    s_nop 0
    s_add_u32 s47, s47, s49
    s_xor_b32 s49, s49, 32
    s_or_b32 s48, s48, s49
    v_readlane_b32 s49, v6, 4
    s_nop 0
    s_add_u32 s47, s47, s49
    s_xor_b32 s49, s49, 32
    s_or_b32 s48, s48, s49
    v_readlane_b32 s49, v6, 5
    s_nop 0
    s_add_u32 s47, s47, s49
    s_xor_b32 s49, s49, 32
    s_or_b32 s48, s48, s49
    v_readlane_b32 s49, v6, 6
    s_nop 0
    s_add_u32 s47, s47, s49
    s_xor_b32 s49, s49, 32
    s_or_b32 s48, s48, s49
    v_readlane_b32 s49, v6, 7
    s_nop 0
    s_add_u32 s47, s47, s49
    s_xor_b32 s49, s49, 32
    s_or_b32 s48, s48, s49
    s_add_u32 s46, s46, 1
    s_cmp_gt_u32 s46, 4000000
    s_cbranch_scc1 L_w1bail_30
    s_cmp_lt_u32 s47, 256
    s_cbranch_scc1 L_w1poll_29
L_w1bail_30:
    s_mov_b64 exec, -1
    s_cmp_lg_u32 s48, 0
    s_cselect_b32 s27, 1, 0
    s_getreg_b32 s46, hwreg(HW_REG_XCC_ID, 0, 4)
    s_and_b32 s46, s46, 7
    v_readfirstlane_b32 s47, v124
    s_lshl_b32 s46, s46, 5
    s_add_u32 s46, s46, s47
    s_cmp_eq_u32 s27, 0
    s_cselect_b32 s46, s46, s2
    s_lshr_b32 s25, s46, 4
    s_and_b32 s26, s46, 15
    s_lshl_b32 s46, s25, 7
    s_lshl_b32 s47, s26, 7
    s_add_u32 s47, s47, 1984
    v_lshlrev_b32 v5, 2, v1
    v_add_u32 v6, s46, v5
    v_add_u32 v7, s47, v5
    v_cmp_gt_u32 vcc, 16, v1
    s_nop 1
    v_cndmask_b32 v6, v7, v6, vcc
    s_add_u32 s52, s22, 16384
    s_addc_u32 s53, s23, 0
    s_mov_b32 s46, 0
    s_mov_b64 exec, 0x1fffffff
    s_nop 0
L_w2poll_31:
    global_load_dword v7, v6, s[52:53] sc1
    s_waitcnt vmcnt(0)
    v_cmp_eq_u32 vcc, 0, v7
    s_add_u32 s46, s46, 1
    s_cmp_gt_u32 s46, 4000000
    s_nop 2
    s_cbranch_scc1 L_w2bail_32
    s_cbranch_vccnz L_w2poll_31
L_w2bail_32:
    s_mov_b64 exec, -1
    v_mov_b32 v8, s25
    v_mov_b32 v9, s26
    v_mov_b32 v10, s27
    v_mov_b32 v11, 0
    v_mov_b32 v5, 140000
    ds_write_b128 v5, v[8:11]
    s_waitcnt lgkmcnt(0)
    s_nop 2
    s_branch L_fa_j_25
L_fa_o_24:
    v_mov_b32 v5, 140032
    s_cmp_lg_u32 s24, 3
    s_nop 3
    s_cbranch_scc1 L_fa_w12_33
    s_waitcnt vmcnt(30)
    s_barrier
    s_waitcnt vmcnt(0)
    v_mov_b32 v6, 1
    ds_write_b32 v5, v6
    s_waitcnt lgkmcnt(0)
    s_nop 2
    s_branch L_fa_land_34
L_fa_w12_33:
    s_waitcnt vmcnt(0)
    s_barrier
    s_mov_b32 s46, 0
L_fa_spin_35:
    ds_read_b32 v6, v5
    s_waitcnt lgkmcnt(0)
    v_cmp_eq_u32 vcc, 0, v6
    s_add_u32 s46, s46, 1
    s_cmp_gt_u32 s46, 4000000
    s_nop 2
    s_cbranch_scc1 L_fa_land_34
    s_cbranch_vccnz L_fa_spin_35
L_fa_land_34:
    s_cmp_ge_u32 s2, 224
    s_cbranch_scc1 L_b_end_38
    s_cmp_eq_u32 s36, 2
    s_cbranch_scc1 L_b_d_37
    s_cmp_eq_u32 s36, 1
    s_cbranch_scc1 L_b_o_36
    v_mov_b32 v24, 0x3f803f80
    v_mov_b32 v25, 0x3f803f80
    v_mov_b32 v26, 0x3f803f80
    v_mov_b32 v27, 0x3f803f80
    s_sub_u32 s55, s24, 1
    v_lshrrev_b32 v5, 2, v3
    v_and_b32 v6, 3, v3
    s_lshr_b32 s46, s55, 1
    s_lshl_b32 s47, s46, 5
    s_and_b32 s48, s55, 1
    s_lshl_b32 s49, s48, 2
    s_add_u32 s47, s47, s49
    v_lshlrev_b32 v7, 3, v5
    v_add3_u32 v7, v7, v6, s47
    v_lshlrev_b32 v7, 1, v7
    v_mul_u32_u24 v8, 1536, v4
    v_add3_u32 v28, v7, v8, s59
    v_bfe_u32 v9, v28, 1, 1
    v_and_b32 v28, -4, v28
    v_mul_u32_u24 v9, 0x0202, v9
    v_lshl_or_b32 v9, v9, 16, v9
    v_add_u32 v109, 0x05040100, v9
    v_add_u32 v110, 0, v28
    v_add_u32 v111, 768, v28
    v_add_u32 v112, 6144, v28
    v_add_u32 v113, 6912, v28
    v_add_u32 v114, 12288, v28
    v_add_u32 v115, 13056, v28
    v_add_u32 v116, 18432, v28
    v_add_u32 v117, 19200, v28
    v_add_u32 v118, 24576, v28
    v_add_u32 v119, 25344, v28
    ds_read2_b32 v[32:33], v110 offset0:0 offset1:48
    ds_read2_b32 v[34:35], v110 offset0:96 offset1:144
    ds_read2_b32 v[36:37], v111 offset0:0 offset1:48
    ds_read2_b32 v[38:39], v111 offset0:96 offset1:144
    ds_read2_b32 v[40:41], v112 offset0:0 offset1:48
    ds_read2_b32 v[42:43], v112 offset0:96 offset1:144
    ds_read2_b32 v[44:45], v113 offset0:0 offset1:48
    ds_read2_b32 v[46:47], v113 offset0:96 offset1:144
    ds_read2_b32 v[48:49], v114 offset0:0 offset1:48
    ds_read2_b32 v[50:51], v114 offset0:96 offset1:144
    ds_read2_b32 v[52:53], v115 offset0:0 offset1:48
    ds_read2_b32 v[54:55], v115 offset0:96 offset1:144
    ds_read2_b32 v[56:57], v116 offset0:0 offset1:48
    ds_read2_b32 v[58:59], v116 offset0:96 offset1:144
    ds_read2_b32 v[60:61], v117 offset0:0 offset1:48
    ds_read2_b32 v[62:63], v117 offset0:96 offset1:144
    ds_read2_b32 v[64:65], v118 offset0:0 offset1:48
    ds_read2_b32 v[66:67], v118 offset0:96 offset1:144
    ds_read2_b32 v[68:69], v119 offset0:0 offset1:48
    ds_read2_b32 v[70:71], v119 offset0:96 offset1:144
    s_waitcnt lgkmcnt(15)
    v_perm_b32 v80, v33, v32, v109
    v_perm_b32 v81, v35, v34, v109
    v_perm_b32 v82, v37, v36, v109
    v_perm_b32 v83, v39, v38, v109
    v_perm_b32 v84, v41, v40, v109
    s_waitcnt lgkmcnt(14)
    v_perm_b32 v85, v43, v42, v109
    s_waitcnt lgkmcnt(13)
    v_perm_b32 v86, v45, v44, v109
    s_waitcnt lgkmcnt(12)
    v_perm_b32 v87, v47, v46, v109
    s_waitcnt lgkmcnt(11)
    v_perm_b32 v88, v49, v48, v109
    s_waitcnt lgkmcnt(10)
    v_perm_b32 v89, v51, v50, v109
    s_waitcnt lgkmcnt(9)
    v_perm_b32 v90, v53, v52, v109
    s_waitcnt lgkmcnt(8)
    v_perm_b32 v91, v55, v54, v109
    s_waitcnt lgkmcnt(7)
    v_perm_b32 v92, v57, v56, v109
    s_waitcnt lgkmcnt(6)
    v_perm_b32 v93, v59, v58, v109
    s_waitcnt lgkmcnt(5)
    v_perm_b32 v94, v61, v60, v109
    s_waitcnt lgkmcnt(4)
    v_perm_b32 v95, v63, v62, v109
    s_waitcnt lgkmcnt(3)
    v_perm_b32 v96, v65, v64, v109
    s_waitcnt lgkmcnt(2)
    v_perm_b32 v97, v67, v66, v109
    s_waitcnt lgkmcnt(1)
    v_perm_b32 v98, v69, v68, v109
    s_waitcnt lgkmcnt(0)
    v_perm_b32 v99, v71, v70, v109
    v_mfma_f32_16x16x32_bf16 v[104:107], v[24:27], v[80:83], 0
    v_mfma_f32_16x16x32_bf16 v[104:107], v[24:27], v[84:87], v[104:107]
    v_mfma_f32_16x16x32_bf16 v[104:107], v[24:27], v[88:91], v[104:107]
    v_mfma_f32_16x16x32_bf16 v[104:107], v[24:27], v[92:95], v[104:107]
    v_mfma_f32_16x16x32_bf16 v[104:107], v[24:27], v[96:99], v[104:107]
    s_mul_i32 s49, s37, 3
    s_add_u32 s49, s49, s46
    s_mul_i32 s49, s49, 86016
    s_lshl_b32 s48, s48, 1
    s_add_u32 s48, s48, s39
    s_lshl_b32 s48, s48, 10
    s_add_u32 s49, s49, s48
    s_add_u32 s49, s49, 3768320
    s_lshl_b32 s50, s38, 8
    s_add_u32 s50, s50, s49
    s_add_u32 s50, s50, 81920
    s_add_u32 s56, s22, s50
    s_addc_u32 s57, s23, 0
    s_mul_i32 s50, s38, 20480
    s_add_u32 s49, s49, s50
    s_add_u32 s52, s22, s49
    s_addc_u32 s53, s23, 0
    global_store_dwordx4 v2, v[80:83], s[52:53] sc1
    s_add_u32 s52, s52, 4096
    s_addc_u32 s53, s53, 0
    global_store_dwordx4 v2, v[84:87], s[52:53] sc1
    s_add_u32 s52, s52, 4096
    s_addc_u32 s53, s53, 0
    global_store_dwordx4 v2, v[88:91], s[52:53] sc1
    s_add_u32 s52, s52, 4096
    s_addc_u32 s53, s53, 0
    global_store_dwordx4 v2, v[92:95], s[52:53] sc1
    s_add_u32 s52, s52, 4096
    s_addc_u32 s53, s53, 0
    global_store_dwordx4 v2, v[96:99], s[52:53] sc1
    v_cvt_pk_bf16_f32 v32, v104, v104
    v_and_b32 v36, 0xffff0000, v32
    v_sub_f32 v36, v104, v36
    v_mov_b32 v34, 0
    v_mov_b32 v35, 0
    v_cvt_pk_bf16_f32 v33, v36, v34
    s_mov_b64 exec, 0xffff
    global_store_dwordx4 v2, v[32:35], s[56:57] sc1
    s_mov_b64 exec, -1
    s_add_u32 s55, s24, 2
    s_cmp_ge_u32 s55, 6
    s_cbranch_scc1 L_tile_end_39
    v_lshrrev_b32 v5, 2, v3
    v_and_b32 v6, 3, v3
    s_lshr_b32 s46, s55, 1
    s_lshl_b32 s47, s46, 5
    s_and_b32 s48, s55, 1
    s_lshl_b32 s49, s48, 2
    s_add_u32 s47, s47, s49
    v_lshlrev_b32 v7, 3, v5
    v_add3_u32 v7, v7, v6, s47
    v_lshlrev_b32 v7, 1, v7
    v_mul_u32_u24 v8, 1536, v4
    v_add3_u32 v28, v7, v8, s59
    v_bfe_u32 v9, v28, 1, 1
    v_and_b32 v28, -4, v28
    v_mul_u32_u24 v9, 0x0202, v9
    v_lshl_or_b32 v9, v9, 16, v9
    v_add_u32 v109, 0x05040100, v9
    v_add_u32 v110, 0, v28
    v_add_u32 v111, 768, v28
    v_add_u32 v112, 6144, v28
    v_add_u32 v113, 6912, v28
    v_add_u32 v114, 12288, v28
    v_add_u32 v115, 13056, v28
    v_add_u32 v116, 18432, v28
    v_add_u32 v117, 19200, v28
    v_add_u32 v118, 24576, v28
    v_add_u32 v119, 25344, v28
    ds_read2_b32 v[32:33], v110 offset0:0 offset1:48
    ds_read2_b32 v[34:35], v110 offset0:96 offset1:144
    ds_read2_b32 v[36:37], v111 offset0:0 offset1:48
    ds_read2_b32 v[38:39], v111 offset0:96 offset1:144
    ds_read2_b32 v[40:41], v112 offset0:0 offset1:48
    ds_read2_b32 v[42:43], v112 offset0:96 offset1:144
    ds_read2_b32 v[44:45], v113 offset0:0 offset1:48
    ds_read2_b32 v[46:47], v113 offset0:96 offset1:144
    ds_read2_b32 v[48:49], v114 offset0:0 offset1:48
    ds_read2_b32 v[50:51], v114 offset0:96 offset1:144
    ds_read2_b32 v[52:53], v115 offset0:0 offset1:48
    ds_read2_b32 v[54:55], v115 offset0:96 offset1:144
    ds_read2_b32 v[56:57], v116 offset0:0 offset1:48
    ds_read2_b32 v[58:59], v116 offset0:96 offset1:144
    ds_read2_b32 v[60:61], v117 offset0:0 offset1:48
    ds_read2_b32 v[62:63], v117 offset0:96 offset1:144
    ds_read2_b32 v[64:65], v118 offset0:0 offset1:48
    ds_read2_b32 v[66:67], v118 offset0:96 offset1:144
    ds_read2_b32 v[68:69], v119 offset0:0 offset1:48
    ds_read2_b32 v[70:71], v119 offset0:96 offset1:144
    s_waitcnt lgkmcnt(15)
    v_perm_b32 v80, v33, v32, v109
    v_perm_b32 v81, v35, v34, v109
    v_perm_b32 v82, v37, v36, v109
    v_perm_b32 v83, v39, v38, v109
    v_perm_b32 v84, v41, v40, v109
    s_waitcnt lgkmcnt(14)
    v_perm_b32 v85, v43, v42, v109
    s_waitcnt lgkmcnt(13)
    v_perm_b32 v86, v45, v44, v109
    s_waitcnt lgkmcnt(12)
    v_perm_b32 v87, v47, v46, v109
    s_waitcnt lgkmcnt(11)
    v_perm_b32 v88, v49, v48, v109
    s_waitcnt lgkmcnt(10)
    v_perm_b32 v89, v51, v50, v109
    s_waitcnt lgkmcnt(9)
    v_perm_b32 v90, v53, v52, v109
    s_waitcnt lgkmcnt(8)
    v_perm_b32 v91, v55, v54, v109
    s_waitcnt lgkmcnt(7)
    v_perm_b32 v92, v57, v56, v109
    s_waitcnt lgkmcnt(6)
    v_perm_b32 v93, v59, v58, v109
    s_waitcnt lgkmcnt(5)
    v_perm_b32 v94, v61, v60, v109
    s_waitcnt lgkmcnt(4)
    v_perm_b32 v95, v63, v62, v109
    s_waitcnt lgkmcnt(3)
    v_perm_b32 v96, v65, v64, v109
    s_waitcnt lgkmcnt(2)
    v_perm_b32 v97, v67, v66, v109
    s_waitcnt lgkmcnt(1)
    v_perm_b32 v98, v69, v68, v109
    s_waitcnt lgkmcnt(0)
    v_perm_b32 v99, v71, v70, v109
    v_mfma_f32_16x16x32_bf16 v[104:107], v[24:27], v[80:83], 0
    v_mfma_f32_16x16x32_bf16 v[104:107], v[24:27], v[84:87], v[104:107]
    v_mfma_f32_16x16x32_bf16 v[104:107], v[24:27], v[88:91], v[104:107]
    v_mfma_f32_16x16x32_bf16 v[104:107], v[24:27], v[92:95], v[104:107]
    v_mfma_f32_16x16x32_bf16 v[104:107], v[24:27], v[96:99], v[104:107]
    s_mul_i32 s49, s37, 3
    s_add_u32 s49, s49, s46
    s_mul_i32 s49, s49, 86016
    s_lshl_b32 s48, s48, 1
    s_add_u32 s48, s48, s39
    s_lshl_b32 s48, s48, 10
    s_add_u32 s49, s49, s48
    s_add_u32 s49, s49, 3768320
    s_lshl_b32 s50, s38, 8
    s_add_u32 s50, s50, s49
    s_add_u32 s50, s50, 81920
    s_add_u32 s56, s22, s50
    s_addc_u32 s57, s23, 0
    s_mul_i32 s50, s38, 20480
    s_add_u32 s49, s49, s50
    s_add_u32 s52, s22, s49
    s_addc_u32 s53, s23, 0
    global_store_dwordx4 v2, v[80:83], s[52:53] sc1
    s_add_u32 s52, s52, 4096
    s_addc_u32 s53, s53, 0
    global_store_dwordx4 v2, v[84:87], s[52:53] sc1
    s_add_u32 s52, s52, 4096
    s_addc_u32 s53, s53, 0
    global_store_dwordx4 v2, v[88:91], s[52:53] sc1
    s_add_u32 s52, s52, 4096
    s_addc_u32 s53, s53, 0
    global_store_dwordx4 v2, v[92:95], s[52:53] sc1
    s_add_u32 s52, s52, 4096
    s_addc_u32 s53, s53, 0
    global_store_dwordx4 v2, v[96:99], s[52:53] sc1
    v_cvt_pk_bf16_f32 v32, v104, v104
    v_and_b32 v36, 0xffff0000, v32
    v_sub_f32 v36, v104, v36
    v_mov_b32 v34, 0
    v_mov_b32 v35, 0
    v_cvt_pk_bf16_f32 v33, v36, v34
    s_mov_b64 exec, 0xffff
    global_store_dwordx4 v2, v[32:35], s[56:57] sc1
    s_mov_b64 exec, -1
    s_nop 1
L_tile_end_39:
    s_branch L_b_end_38
L_b_o_36:
    s_sub_u32 s55, s24, 1
    v_lshrrev_b32 v5, 2, v3
    v_and_b32 v6, 3, v3
    s_and_b32 s46, s37, 1
    s_lshl_b32 s47, s46, 4
    s_lshr_b32 s48, s55, 1
    s_lshl_b32 s48, s48, 5
    s_add_u32 s47, s47, s48
    s_and_b32 s48, s55, 1
    s_lshl_b32 s48, s48, 2
    s_add_u32 s47, s47, s48
    v_lshlrev_b32 v7, 3, v5
    v_add3_u32 v7, v7, v6, s47
    s_cmp_eq_u32 s46, 0
    s_cselect_b32 s48, 64, 0
    v_add_u32 v8, s48, v3
    s_cmp_eq_u32 s55, 4
    s_cselect_b64 vcc, -1, 0
    v_cndmask_b32 v7, v7, v8, vcc
    v_lshlrev_b32 v7, 1, v7
    v_lshrrev_b32 v8, 1, v4
    v_mul_u32_u24 v8, 10, v8
    v_and_b32 v9, 1, v4
    v_lshlrev_b32 v10, 2, v9
    v_add_u32 v10, v10, v8
    v_add3_u32 v11, v8, v9, 8
    v_mul_u32_u24 v10, 160, v10
    v_mul_u32_u24 v11, 160, v11
    v_add3_u32 v28, v7, v10, s59
    v_add3_u32 v29, v7, v11, s59
    ds_read_u16 v32, v28 offset:0
    ds_read_u16_d16_hi v33, v28 offset:160
    ds_read_u16 v34, v28 offset:320
    ds_read_u16_d16_hi v35, v28 offset:480
    ds_read_u16 v36, v29 offset:0
    ds_read_u16_d16_hi v37, v28 offset:3200
    ds_read_u16 v38, v28 offset:3360
    ds_read_u16_d16_hi v39, v28 offset:3520
    ds_read_u16 v40, v28 offset:6400
    ds_read_u16_d16_hi v41, v28 offset:6560
    ds_read_u16 v42, v28 offset:6720
    ds_read_u16_d16_hi v43, v28 offset:6880
    ds_read_u16 v44, v29 offset:6400
    ds_read_u16_d16_hi v45, v28 offset:9600
    ds_read_u16 v46, v28 offset:9760
    ds_read_u16_d16_hi v47, v28 offset:9920
    ds_read_u16 v48, v28 offset:12800
    ds_read_u16_d16_hi v49, v28 offset:12960
    ds_read_u16 v50, v28 offset:13120
    ds_read_u16_d16_hi v51, v28 offset:13280
    ds_read_u16 v52, v29 offset:12800
    ds_read_u16_d16_hi v53, v28 offset:16000
    ds_read_u16 v54, v28 offset:16160
    ds_read_u16_d16_hi v55, v28 offset:16320
    ds_read_u16 v56, v28 offset:19200
    ds_read_u16_d16_hi v57, v28 offset:19360
    ds_read_u16 v58, v28 offset:19520
    ds_read_u16_d16_hi v59, v28 offset:19680
    ds_read_u16 v60, v29 offset:19200
    ds_read_u16_d16_hi v61, v28 offset:22400
    ds_read_u16 v62, v28 offset:22560
    ds_read_u16_d16_hi v63, v28 offset:22720
    ds_read_u16 v64, v28 offset:3680
    ds_read_u16_d16_hi v65, v29 offset:3200
    ds_read_u16 v66, v28 offset:10080
    ds_read_u16_d16_hi v67, v29 offset:9600
    ds_read_u16 v68, v28 offset:16480
    ds_read_u16_d16_hi v69, v29 offset:16000
    ds_read_u16 v70, v28 offset:22880
    ds_read_u16_d16_hi v71, v29 offset:22400
    s_waitcnt lgkmcnt(15)
    v_or_b32 v80, v32, v33
    v_or_b32 v81, v34, v35
    v_or_b32 v82, v36, v37
    v_or_b32 v83, v38, v39
    v_or_b32 v84, v40, v41
    v_or_b32 v85, v42, v43
    v_or_b32 v86, v44, v45
    v_or_b32 v87, v46, v47
    v_or_b32 v88, v48, v49
    v_or_b32 v89, v50, v51
    v_or_b32 v90, v52, v53
    v_or_b32 v91, v54, v55
    s_waitcnt lgkmcnt(14)
    v_or_b32 v92, v56, v57
    s_waitcnt lgkmcnt(12)
    v_or_b32 v93, v58, v59
    s_waitcnt lgkmcnt(10)
    v_or_b32 v94, v60, v61
    s_waitcnt lgkmcnt(8)
    v_or_b32 v95, v62, v63
    s_waitcnt lgkmcnt(6)
    v_or_b32 v96, v64, v65
    s_waitcnt lgkmcnt(4)
    v_or_b32 v97, v66, v67
    s_waitcnt lgkmcnt(2)
    v_or_b32 v98, v68, v69
    s_waitcnt lgkmcnt(0)
    v_or_b32 v99, v70, v71
    s_mul_i32 s49, s37, 102400
    s_lshl_b32 s48, s55, 10
    s_add_u32 s49, s49, s48
    s_add_u32 s49, s49, 2949120
    s_lshl_b32 s65, s38, 2
    s_add_u32 s50, s65, 0
    s_mul_i32 s51, s50, 5
    s_lshl_b32 s51, s51, 10
    s_add_u32 s51, s51, s49
    s_add_u32 s52, s22, s51
    s_addc_u32 s53, s23, 0
    global_store_dwordx4 v2, v[80:83], s[52:53] sc1
    s_add_u32 s50, s65, 1
    s_mul_i32 s51, s50, 5
    s_lshl_b32 s51, s51, 10
    s_add_u32 s51, s51, s49
    s_add_u32 s52, s22, s51
    s_addc_u32 s53, s23, 0
    global_store_dwordx4 v2, v[84:87], s[52:53] sc1
    s_add_u32 s50, s65, 2
    s_mul_i32 s51, s50, 5
    s_lshl_b32 s51, s51, 10
    s_add_u32 s51, s51, s49
    s_add_u32 s52, s22, s51
    s_addc_u32 s53, s23, 0
    global_store_dwordx4 v2, v[88:91], s[52:53] sc1
    s_add_u32 s50, s65, 3
    s_mul_i32 s51, s50, 5
    s_lshl_b32 s51, s51, 10
    s_add_u32 s51, s51, s49
    s_add_u32 s52, s22, s51
    s_addc_u32 s53, s23, 0
    global_store_dwordx4 v2, v[92:95], s[52:53] sc1
    s_add_u32 s50, s38, 16
    s_mul_i32 s51, s50, 5
    s_lshl_b32 s51, s51, 10
    s_add_u32 s51, s51, s49
    s_add_u32 s52, s22, s51
    s_addc_u32 s53, s23, 0
    global_store_dwordx4 v2, v[96:99], s[52:53] sc1
    s_add_u32 s55, s24, 2
    s_cmp_ge_u32 s55, 5
    s_cbranch_scc1 L_tile_end_40
    v_lshrrev_b32 v5, 2, v3
    v_and_b32 v6, 3, v3
    s_and_b32 s46, s37, 1
    s_lshl_b32 s47, s46, 4
    s_lshr_b32 s48, s55, 1
    s_lshl_b32 s48, s48, 5
    s_add_u32 s47, s47, s48
    s_and_b32 s48, s55, 1
    s_lshl_b32 s48, s48, 2
    s_add_u32 s47, s47, s48
    v_lshlrev_b32 v7, 3, v5
    v_add3_u32 v7, v7, v6, s47
    s_cmp_eq_u32 s46, 0
    s_cselect_b32 s48, 64, 0
    v_add_u32 v8, s48, v3
    s_cmp_eq_u32 s55, 4
    s_cselect_b64 vcc, -1, 0
    v_cndmask_b32 v7, v7, v8, vcc
    v_lshlrev_b32 v7, 1, v7
    v_lshrrev_b32 v8, 1, v4
    v_mul_u32_u24 v8, 10, v8
    v_and_b32 v9, 1, v4
    v_lshlrev_b32 v10, 2, v9
    v_add_u32 v10, v10, v8
    v_add3_u32 v11, v8, v9, 8
    v_mul_u32_u24 v10, 160, v10
    v_mul_u32_u24 v11, 160, v11
    v_add3_u32 v28, v7, v10, s59
    v_add3_u32 v29, v7, v11, s59
    ds_read_u16 v32, v28 offset:0
    ds_read_u16_d16_hi v33, v28 offset:160
    ds_read_u16 v34, v28 offset:320
    ds_read_u16_d16_hi v35, v28 offset:480
    ds_read_u16 v36, v29 offset:0
    ds_read_u16_d16_hi v37, v28 offset:3200
    ds_read_u16 v38, v28 offset:3360
    ds_read_u16_d16_hi v39, v28 offset:3520
    ds_read_u16 v40, v28 offset:6400
    ds_read_u16_d16_hi v41, v28 offset:6560
    ds_read_u16 v42, v28 offset:6720
    ds_read_u16_d16_hi v43, v28 offset:6880
    ds_read_u16 v44, v29 offset:6400
    ds_read_u16_d16_hi v45, v28 offset:9600
    ds_read_u16 v46, v28 offset:9760
    ds_read_u16_d16_hi v47, v28 offset:9920
    ds_read_u16 v48, v28 offset:12800
    ds_read_u16_d16_hi v49, v28 offset:12960
    ds_read_u16 v50, v28 offset:13120
    ds_read_u16_d16_hi v51, v28 offset:13280
    ds_read_u16 v52, v29 offset:12800
    ds_read_u16_d16_hi v53, v28 offset:16000
    ds_read_u16 v54, v28 offset:16160
    ds_read_u16_d16_hi v55, v28 offset:16320
    ds_read_u16 v56, v28 offset:19200
    ds_read_u16_d16_hi v57, v28 offset:19360
    ds_read_u16 v58, v28 offset:19520
    ds_read_u16_d16_hi v59, v28 offset:19680
    ds_read_u16 v60, v29 offset:19200
    ds_read_u16_d16_hi v61, v28 offset:22400
    ds_read_u16 v62, v28 offset:22560
    ds_read_u16_d16_hi v63, v28 offset:22720
    ds_read_u16 v64, v28 offset:3680
    ds_read_u16_d16_hi v65, v29 offset:3200
    ds_read_u16 v66, v28 offset:10080
    ds_read_u16_d16_hi v67, v29 offset:9600
    ds_read_u16 v68, v28 offset:16480
    ds_read_u16_d16_hi v69, v29 offset:16000
    ds_read_u16 v70, v28 offset:22880
    ds_read_u16_d16_hi v71, v29 offset:22400
    s_waitcnt lgkmcnt(15)
    v_or_b32 v80, v32, v33
    v_or_b32 v81, v34, v35
    v_or_b32 v82, v36, v37
    v_or_b32 v83, v38, v39
    v_or_b32 v84, v40, v41
    v_or_b32 v85, v42, v43
    v_or_b32 v86, v44, v45
    v_or_b32 v87, v46, v47
    v_or_b32 v88, v48, v49
    v_or_b32 v89, v50, v51
    v_or_b32 v90, v52, v53
    v_or_b32 v91, v54, v55
    s_waitcnt lgkmcnt(14)
    v_or_b32 v92, v56, v57
    s_waitcnt lgkmcnt(12)
    v_or_b32 v93, v58, v59
    s_waitcnt lgkmcnt(10)
    v_or_b32 v94, v60, v61
    s_waitcnt lgkmcnt(8)
    v_or_b32 v95, v62, v63
    s_waitcnt lgkmcnt(6)
    v_or_b32 v96, v64, v65
    s_waitcnt lgkmcnt(4)
    v_or_b32 v97, v66, v67
    s_waitcnt lgkmcnt(2)
    v_or_b32 v98, v68, v69
    s_waitcnt lgkmcnt(0)
    v_or_b32 v99, v70, v71
    s_mul_i32 s49, s37, 102400
    s_lshl_b32 s48, s55, 10
    s_add_u32 s49, s49, s48
    s_add_u32 s49, s49, 2949120
    s_lshl_b32 s65, s38, 2
    s_add_u32 s50, s65, 0
    s_mul_i32 s51, s50, 5
    s_lshl_b32 s51, s51, 10
    s_add_u32 s51, s51, s49
    s_add_u32 s52, s22, s51
    s_addc_u32 s53, s23, 0
    global_store_dwordx4 v2, v[80:83], s[52:53] sc1
    s_add_u32 s50, s65, 1
    s_mul_i32 s51, s50, 5
    s_lshl_b32 s51, s51, 10
    s_add_u32 s51, s51, s49
    s_add_u32 s52, s22, s51
    s_addc_u32 s53, s23, 0
    global_store_dwordx4 v2, v[84:87], s[52:53] sc1
    s_add_u32 s50, s65, 2
    s_mul_i32 s51, s50, 5
    s_lshl_b32 s51, s51, 10
    s_add_u32 s51, s51, s49
    s_add_u32 s52, s22, s51
    s_addc_u32 s53, s23, 0
    global_store_dwordx4 v2, v[88:91], s[52:53] sc1
    s_add_u32 s50, s65, 3
    s_mul_i32 s51, s50, 5
    s_lshl_b32 s51, s51, 10
    s_add_u32 s51, s51, s49
    s_add_u32 s52, s22, s51
    s_addc_u32 s53, s23, 0
    global_store_dwordx4 v2, v[92:95], s[52:53] sc1
    s_add_u32 s50, s38, 16
    s_mul_i32 s51, s50, 5
    s_lshl_b32 s51, s51, 10
    s_add_u32 s51, s51, s49
    s_add_u32 s52, s22, s51
    s_addc_u32 s53, s23, 0
    global_store_dwordx4 v2, v[96:99], s[52:53] sc1
    s_nop 1
L_tile_end_40:
    s_branch L_b_end_38
L_b_d_37:
    s_sub_u32 s55, s24, 1
    v_lshrrev_b32 v5, 2, v3
    v_and_b32 v6, 3, v3
    s_and_b32 s46, s37, 1
    s_lshl_b32 s47, s46, 4
    s_lshr_b32 s48, s55, 1
    s_lshl_b32 s48, s48, 5
    s_add_u32 s47, s47, s48
    s_and_b32 s48, s55, 1
    s_lshl_b32 s48, s48, 2
    s_add_u32 s47, s47, s48
    v_lshlrev_b32 v7, 3, v5
    v_add3_u32 v7, v7, v6, s47
    s_cmp_eq_u32 s46, 0
    s_cselect_b32 s48, 64, 0
    v_add_u32 v8, s48, v3
    s_cmp_eq_u32 s55, 4
    s_cselect_b64 vcc, -1, 0
    v_cndmask_b32 v7, v7, v8, vcc
    v_lshlrev_b32 v7, 1, v7
    v_mul_u32_u24 v8, 1280, v4
    v_add3_u32 v28, v7, v8, s59
    v_bfe_u32 v9, v28, 1, 1
    v_and_b32 v28, -4, v28
    v_mul_u32_u24 v9, 0x0202, v9
    v_lshl_or_b32 v9, v9, 16, v9
    v_add_u32 v109, 0x05040100, v9
    v_add_u32 v110, 0, v28
    v_add_u32 v111, 640, v28
    v_add_u32 v112, 5120, v28
    v_add_u32 v113, 5760, v28
    v_add_u32 v114, 10240, v28
    v_add_u32 v115, 10880, v28
    v_add_u32 v116, 15360, v28
    v_add_u32 v117, 16000, v28
    v_add_u32 v118, 20480, v28
    v_add_u32 v119, 21120, v28
    v_add_u32 v120, 25600, v28
    v_add_u32 v121, 26240, v28
    ds_read2_b32 v[32:33], v110 offset0:0 offset1:40
    ds_read2_b32 v[34:35], v110 offset0:80 offset1:120
    ds_read2_b32 v[36:37], v111 offset0:0 offset1:40
    ds_read2_b32 v[38:39], v111 offset0:80 offset1:120
    ds_read2_b32 v[40:41], v112 offset0:0 offset1:40
    ds_read2_b32 v[42:43], v112 offset0:80 offset1:120
    ds_read2_b32 v[44:45], v113 offset0:0 offset1:40
    ds_read2_b32 v[46:47], v113 offset0:80 offset1:120
    ds_read2_b32 v[48:49], v114 offset0:0 offset1:40
    ds_read2_b32 v[50:51], v114 offset0:80 offset1:120
    ds_read2_b32 v[52:53], v115 offset0:0 offset1:40
    ds_read2_b32 v[54:55], v115 offset0:80 offset1:120
    ds_read2_b32 v[56:57], v116 offset0:0 offset1:40
    ds_read2_b32 v[58:59], v116 offset0:80 offset1:120
    ds_read2_b32 v[60:61], v117 offset0:0 offset1:40
    ds_read2_b32 v[62:63], v117 offset0:80 offset1:120
    ds_read2_b32 v[64:65], v118 offset0:0 offset1:40
    ds_read2_b32 v[66:67], v118 offset0:80 offset1:120
    ds_read2_b32 v[68:69], v119 offset0:0 offset1:40
    ds_read2_b32 v[70:71], v119 offset0:80 offset1:120
    ds_read2_b32 v[72:73], v120 offset0:0 offset1:40
    ds_read2_b32 v[74:75], v120 offset0:80 offset1:120
    ds_read2_b32 v[76:77], v121 offset0:0 offset1:40
    ds_read2_b32 v[78:79], v121 offset0:80 offset1:120
    s_waitcnt lgkmcnt(15)
    v_perm_b32 v80, v33, v32, v109
    v_perm_b32 v81, v35, v34, v109
    v_perm_b32 v82, v37, v36, v109
    v_perm_b32 v83, v39, v38, v109
    v_perm_b32 v84, v41, v40, v109
    v_perm_b32 v85, v43, v42, v109
    v_perm_b32 v86, v45, v44, v109
    v_perm_b32 v87, v47, v46, v109
    v_perm_b32 v88, v49, v48, v109
    s_waitcnt lgkmcnt(14)
    v_perm_b32 v89, v51, v50, v109
    s_waitcnt lgkmcnt(13)
    v_perm_b32 v90, v53, v52, v109
    s_waitcnt lgkmcnt(12)
    v_perm_b32 v91, v55, v54, v109
    s_waitcnt lgkmcnt(11)
    v_perm_b32 v92, v57, v56, v109
    s_waitcnt lgkmcnt(10)
    v_perm_b32 v93, v59, v58, v109
    s_waitcnt lgkmcnt(9)
    v_perm_b32 v94, v61, v60, v109
    s_waitcnt lgkmcnt(8)
    v_perm_b32 v95, v63, v62, v109
    s_waitcnt lgkmcnt(7)
    v_perm_b32 v96, v65, v64, v109
    s_waitcnt lgkmcnt(6)
    v_perm_b32 v97, v67, v66, v109
    s_waitcnt lgkmcnt(5)
    v_perm_b32 v98, v69, v68, v109
    s_waitcnt lgkmcnt(4)
    v_perm_b32 v99, v71, v70, v109
    s_waitcnt lgkmcnt(3)
    v_perm_b32 v100, v73, v72, v109
    s_waitcnt lgkmcnt(2)
    v_perm_b32 v101, v75, v74, v109
    s_waitcnt lgkmcnt(1)
    v_perm_b32 v102, v77, v76, v109
    s_waitcnt lgkmcnt(0)
    v_perm_b32 v103, v79, v78, v109
    s_mul_i32 s49, s37, 245760
    s_lshl_b32 s48, s55, 10
    s_add_u32 s49, s49, s48
    s_add_u32 s49, s49, 7897088
    s_mul_i32 s65, s38, 6
    s_add_u32 s50, s65, 0
    s_mul_i32 s51, s50, 5
    s_lshl_b32 s51, s51, 10
    s_add_u32 s51, s51, s49
    s_add_u32 s52, s22, s51
    s_addc_u32 s53, s23, 0
    global_store_dwordx4 v2, v[80:83], s[52:53] sc1
    s_add_u32 s50, s65, 1
    s_mul_i32 s51, s50, 5
    s_lshl_b32 s51, s51, 10
    s_add_u32 s51, s51, s49
    s_add_u32 s52, s22, s51
    s_addc_u32 s53, s23, 0
    global_store_dwordx4 v2, v[84:87], s[52:53] sc1
    s_add_u32 s50, s65, 2
    s_mul_i32 s51, s50, 5
    s_lshl_b32 s51, s51, 10
    s_add_u32 s51, s51, s49
    s_add_u32 s52, s22, s51
    s_addc_u32 s53, s23, 0
    global_store_dwordx4 v2, v[88:91], s[52:53] sc1
    s_add_u32 s50, s65, 3
    s_mul_i32 s51, s50, 5
    s_lshl_b32 s51, s51, 10
    s_add_u32 s51, s51, s49
    s_add_u32 s52, s22, s51
    s_addc_u32 s53, s23, 0
    global_store_dwordx4 v2, v[92:95], s[52:53] sc1
    s_add_u32 s50, s65, 4
    s_mul_i32 s51, s50, 5
    s_lshl_b32 s51, s51, 10
    s_add_u32 s51, s51, s49
    s_add_u32 s52, s22, s51
    s_addc_u32 s53, s23, 0
    global_store_dwordx4 v2, v[96:99], s[52:53] sc1
    s_add_u32 s50, s65, 5
    s_mul_i32 s51, s50, 5
    s_lshl_b32 s51, s51, 10
    s_add_u32 s51, s51, s49
    s_add_u32 s52, s22, s51
    s_addc_u32 s53, s23, 0
    global_store_dwordx4 v2, v[100:103], s[52:53] sc1
    s_add_u32 s55, s24, 2
    s_cmp_ge_u32 s55, 5
    s_cbranch_scc1 L_tile_end_41
    v_lshrrev_b32 v5, 2, v3
    v_and_b32 v6, 3, v3
    s_and_b32 s46, s37, 1
    s_lshl_b32 s47, s46, 4
    s_lshr_b32 s48, s55, 1
    s_lshl_b32 s48, s48, 5
    s_add_u32 s47, s47, s48
    s_and_b32 s48, s55, 1
    s_lshl_b32 s48, s48, 2
    s_add_u32 s47, s47, s48
    v_lshlrev_b32 v7, 3, v5
    v_add3_u32 v7, v7, v6, s47
    s_cmp_eq_u32 s46, 0
    s_cselect_b32 s48, 64, 0
    v_add_u32 v8, s48, v3
    s_cmp_eq_u32 s55, 4
    s_cselect_b64 vcc, -1, 0
    v_cndmask_b32 v7, v7, v8, vcc
    v_lshlrev_b32 v7, 1, v7
    v_mul_u32_u24 v8, 1280, v4
    v_add3_u32 v28, v7, v8, s59
    v_bfe_u32 v9, v28, 1, 1
    v_and_b32 v28, -4, v28
    v_mul_u32_u24 v9, 0x0202, v9
    v_lshl_or_b32 v9, v9, 16, v9
    v_add_u32 v109, 0x05040100, v9
    v_add_u32 v110, 0, v28
    v_add_u32 v111, 640, v28
    v_add_u32 v112, 5120, v28
    v_add_u32 v113, 5760, v28
    v_add_u32 v114, 10240, v28
    v_add_u32 v115, 10880, v28
    v_add_u32 v116, 15360, v28
    v_add_u32 v117, 16000, v28
    v_add_u32 v118, 20480, v28
    v_add_u32 v119, 21120, v28
    v_add_u32 v120, 25600, v28
    v_add_u32 v121, 26240, v28
    ds_read2_b32 v[32:33], v110 offset0:0 offset1:40
    ds_read2_b32 v[34:35], v110 offset0:80 offset1:120
    ds_read2_b32 v[36:37], v111 offset0:0 offset1:40
    ds_read2_b32 v[38:39], v111 offset0:80 offset1:120
    ds_read2_b32 v[40:41], v112 offset0:0 offset1:40
    ds_read2_b32 v[42:43], v112 offset0:80 offset1:120
    ds_read2_b32 v[44:45], v113 offset0:0 offset1:40
    ds_read2_b32 v[46:47], v113 offset0:80 offset1:120
    ds_read2_b32 v[48:49], v114 offset0:0 offset1:40
    ds_read2_b32 v[50:51], v114 offset0:80 offset1:120
    ds_read2_b32 v[52:53], v115 offset0:0 offset1:40
    ds_read2_b32 v[54:55], v115 offset0:80 offset1:120
    ds_read2_b32 v[56:57], v116 offset0:0 offset1:40
    ds_read2_b32 v[58:59], v116 offset0:80 offset1:120
    ds_read2_b32 v[60:61], v117 offset0:0 offset1:40
    ds_read2_b32 v[62:63], v117 offset0:80 offset1:120
    ds_read2_b32 v[64:65], v118 offset0:0 offset1:40
    ds_read2_b32 v[66:67], v118 offset0:80 offset1:120
    ds_read2_b32 v[68:69], v119 offset0:0 offset1:40
    ds_read2_b32 v[70:71], v119 offset0:80 offset1:120
    ds_read2_b32 v[72:73], v120 offset0:0 offset1:40
    ds_read2_b32 v[74:75], v120 offset0:80 offset1:120
    ds_read2_b32 v[76:77], v121 offset0:0 offset1:40
    ds_read2_b32 v[78:79], v121 offset0:80 offset1:120
    s_waitcnt lgkmcnt(15)
    v_perm_b32 v80, v33, v32, v109
    v_perm_b32 v81, v35, v34, v109
    v_perm_b32 v82, v37, v36, v109
    v_perm_b32 v83, v39, v38, v109
    v_perm_b32 v84, v41, v40, v109
    v_perm_b32 v85, v43, v42, v109
    v_perm_b32 v86, v45, v44, v109
    v_perm_b32 v87, v47, v46, v109
    v_perm_b32 v88, v49, v48, v109
    s_waitcnt lgkmcnt(14)
    v_perm_b32 v89, v51, v50, v109
    s_waitcnt lgkmcnt(13)
    v_perm_b32 v90, v53, v52, v109
    s_waitcnt lgkmcnt(12)
    v_perm_b32 v91, v55, v54, v109
    s_waitcnt lgkmcnt(11)
    v_perm_b32 v92, v57, v56, v109
    s_waitcnt lgkmcnt(10)
    v_perm_b32 v93, v59, v58, v109
    s_waitcnt lgkmcnt(9)
    v_perm_b32 v94, v61, v60, v109
    s_waitcnt lgkmcnt(8)
    v_perm_b32 v95, v63, v62, v109
    s_waitcnt lgkmcnt(7)
    v_perm_b32 v96, v65, v64, v109
    s_waitcnt lgkmcnt(6)
    v_perm_b32 v97, v67, v66, v109
    s_waitcnt lgkmcnt(5)
    v_perm_b32 v98, v69, v68, v109
    s_waitcnt lgkmcnt(4)
    v_perm_b32 v99, v71, v70, v109
    s_waitcnt lgkmcnt(3)
    v_perm_b32 v100, v73, v72, v109
    s_waitcnt lgkmcnt(2)
    v_perm_b32 v101, v75, v74, v109
    s_waitcnt lgkmcnt(1)
    v_perm_b32 v102, v77, v76, v109
    s_waitcnt lgkmcnt(0)
    v_perm_b32 v103, v79, v78, v109
    s_mul_i32 s49, s37, 245760
    s_lshl_b32 s48, s55, 10
    s_add_u32 s49, s49, s48
    s_add_u32 s49, s49, 7897088
    s_mul_i32 s65, s38, 6
    s_add_u32 s50, s65, 0
    s_mul_i32 s51, s50, 5
    s_lshl_b32 s51, s51, 10
    s_add_u32 s51, s51, s49
    s_add_u32 s52, s22, s51
    s_addc_u32 s53, s23, 0
    global_store_dwordx4 v2, v[80:83], s[52:53] sc1
    s_add_u32 s50, s65, 1
    s_mul_i32 s51, s50, 5
    s_lshl_b32 s51, s51, 10
    s_add_u32 s51, s51, s49
    s_add_u32 s52, s22, s51
    s_addc_u32 s53, s23, 0
    global_store_dwordx4 v2, v[84:87], s[52:53] sc1
    s_add_u32 s50, s65, 2
    s_mul_i32 s51, s50, 5
    s_lshl_b32 s51, s51, 10
    s_add_u32 s51, s51, s49
    s_add_u32 s52, s22, s51
    s_addc_u32 s53, s23, 0
    global_store_dwordx4 v2, v[88:91], s[52:53] sc1
    s_add_u32 s50, s65, 3
    s_mul_i32 s51, s50, 5
    s_lshl_b32 s51, s51, 10
    s_add_u32 s51, s51, s49
    s_add_u32 s52, s22, s51
    s_addc_u32 s53, s23, 0
    global_store_dwordx4 v2, v[92:95], s[52:53] sc1
    s_add_u32 s50, s65, 4
    s_mul_i32 s51, s50, 5
    s_lshl_b32 s51, s51, 10
    s_add_u32 s51, s51, s49
    s_add_u32 s52, s22, s51
    s_addc_u32 s53, s23, 0
    global_store_dwordx4 v2, v[96:99], s[52:53] sc1
    s_add_u32 s50, s65, 5
    s_mul_i32 s51, s50, 5
    s_lshl_b32 s51, s51, 10
    s_add_u32 s51, s51, s49
    s_add_u32 s52, s22, s51
    s_addc_u32 s53, s23, 0
    global_store_dwordx4 v2, v[100:103], s[52:53] sc1
    s_nop 1
L_tile_end_41:
L_b_end_38:
L_fa_j_25:
    s_barrier
    v_mov_b32 v5, 140000
    ds_read_b128 v[8:11], v5
    s_waitcnt lgkmcnt(0)
    v_readfirstlane_b32 s25, v8
    v_readfirstlane_b32 s26, v9
    v_readfirstlane_b32 s27, v10
    s_barrier
    s_mul_i32 s98, s24, 6144
    s_mul_i32 s99, s24, 7168
    s_mul_i32 s83, s24, 4096
    s_mul_i32 s100, s24, 3072
    s_mul_i32 s101, s24, 2048
    s_mul_i32 s30, s26, 110592
    s_add_u32 s30, s30, 32768
    s_add_u32 s36, s22, s30
    s_addc_u32 s37, s23, 0
    s_cselect_b32 s82, 1, 0
    s_add_u32 s79, s98, 4096
    s_add_u32 m0, s98, 135168
    s_add_u32 s80, s36, s79
    s_addc_u32 s81, s37, 0
    s_cmp_lg_u32 s82, 0
    global_load_lds_dwordx4 v2, s[80:81] offset:-4096
    global_load_lds_dwordx4 v2, s[80:81] offset:-3072
    global_load_lds_dwordx4 v2, s[80:81] offset:-2048
    global_load_lds_dwordx4 v2, s[80:81] offset:-1024
    global_load_lds_dwordx4 v2, s[80:81] offset:0
    global_load_lds_dwordx4 v2, s[80:81] offset:1024
    s_cselect_b32 s82, 1, 0
    s_add_u32 s79, s83, 28672
    s_add_u32 m0, s83, 118784
    s_add_u32 s80, s36, s79
    s_addc_u32 s81, s37, 0
    s_cmp_lg_u32 s82, 0
    global_load_lds_dwordx4 v2, s[80:81] offset:-4096
    global_load_lds_dwordx4 v2, s[80:81] offset:-3072
    global_load_lds_dwordx4 v2, s[80:81] offset:-2048
    global_load_lds_dwordx4 v2, s[80:81] offset:-1024
    s_cselect_b32 s82, 1, 0
    s_add_u32 s79, s101, 45056
    s_add_u32 m0, s101, 159744
    s_add_u32 s80, s36, s79
    s_addc_u32 s81, s37, 0
    s_cmp_lg_u32 s82, 0
    global_load_lds_dwordx4 v2, s[80:81] offset:-4096
    global_load_lds_dwordx4 v2, s[80:81] offset:-3072
    v_add_u32 v5, 0, v2
    v_add_u32 v6, 8192, v2
    v_add_u32 v7, 16384, v2
    v_add_u32 v8, 24576, v2
    v_add_u32 v9, 32768, v2
    v_add_u32 v10, 65536, v2
    v_add_u32 v15, 131072, v2
    s_mov_b64 s[52:53], s[94:95]
    s_mov_b64 s[54:55], s[96:97]
    s_mov_b32 s48, 0x3fb8aa3b
    s_mov_b32 s49, 0x3fb8aa3b
    s_mov_b32 s64, 0xbdd2d3e8
    s_mov_b32 s65, 0xbdd2d3e8
    s_mov_b32 s29, 0
    s_mov_b32 s28, 0
    s_and_b32 s75, s26, 7
    s_mul_i32 s30, s26, 65536
    s_add_u32 s30, s30, 1802240
    s_add_u32 s38, s22, s30
    s_addc_u32 s39, s23, 0
    s_mul_i32 s30, s75, 102400
    s_add_u32 s30, s30, 2949120
    s_add_u32 s40, s22, s30
    s_addc_u32 s41, s23, 0
    s_mul_i32 s30, s26, 258048
    s_add_u32 s30, s30, 3768320
    s_add_u32 s42, s22, s30
    s_addc_u32 s43, s23, 0
    s_mul_i32 s30, s75, 245760
    s_add_u32 s30, s30, 7897088
    s_add_u32 s44, s22, s30
    s_addc_u32 s45, s23, 0
    s_lshl_b32 s34, s25, 3
    s_lshr_b32 s31, s26, 3
    s_lshl_b32 s31, s31, 2
    s_add_u32 s74, s34, s31
    s_add_u32 s74, s74, s24
    s_lshl_b32 s31, s24, 1
    s_add_u32 s34, s34, s31
    s_mul_i32 s30, s34, 20480
    s_add_u32 s30, s30, 9867264
    s_add_u32 s4, s22, s30
    s_addc_u32 s5, s23, 0
    s_mul_i32 s30, s34, 1024
    s_add_u32 s30, s30, 12488704
    s_add_u32 s6, s22, s30
    s_addc_u32 s7, s23, 0
    s_mul_i32 s30, s26, 6144
    s_add_u32 s30, s30, 2854912
    s_add_u32 s8, s22, s30
    s_addc_u32 s9, s23, 0
    s_mul_i32 s30, s74, 20480
    s_add_u32 s30, s30, 14716928
    s_add_u32 s10, s22, s30
    s_addc_u32 s11, s23, 0
    s_mul_i32 s30, s74, 49152
    s_add_u32 s30, s30, 25464832
    s_add_u32 s12, s22, s30
    s_addc_u32 s13, s23, 0
    s_mul_i32 s30, s34, 20480
    s_add_u32 s30, s30, 14712832
    s_add_u32 s70, s22, s30
    s_addc_u32 s71, s23, 0
    s_add_u32 s14, s12, 40960
    s_addc_u32 s15, s13, 0
    s_add_u32 s68, s22, 20480
    s_addc_u32 s69, s23, 0
    s_lshr_b32 s32, s75, 1
    s_mul_i32 s32, s32, 5
    s_and_b32 s33, s75, 1
    s_mul_i32 s35, s74, 20
    s_add_u32 s32, s32, s35
    s_mul_i32 s31, s33, 3
    s_add_u32 s31, s31, s32
    s_lshl_b32 s30, s31, 10
    s_add_u32 s30, s30, 9863168
    s_add_u32 s16, s22, s30
    s_addc_u32 s17, s23, 0
    s_add_u32 s31, s32, 2
    s_lshl_b32 s30, s31, 10
    s_lshl_b32 s31, s33, 9
    s_add_u32 s30, s30, s31
    s_add_u32 s30, s30, 9863168
    s_add_u32 s20, s22, s30
    s_addc_u32 s21, s23, 0
    s_lshl_b32 s30, s74, 10
    s_lshr_b32 s31, s75, 1
    s_lshl_b32 s31, s31, 8
    s_add_u32 s30, s30, s31
    s_lshl_b32 s31, s33, 3
    s_add_u32 s30, s30, s31
    s_add_u32 s30, s30, 12484608
    s_add_u32 s46, s22, s30
    s_addc_u32 s47, s23, 0
    s_mul_i32 s32, s34, 20480
    s_lshl_b32 s31, s26, 10
    s_add_u32 s30, s32, s31
    s_add_u32 s30, s30, 14716928
    s_add_u32 s50, s22, s30
    s_addc_u32 s51, s23, 0
    s_lshr_b32 s31, s26, 2
    s_add_u32 s31, s31, 16
    s_lshl_b32 s31, s31, 10
    s_add_u32 s30, s32, s31
    s_and_b32 s33, s26, 3
    s_lshl_b32 s33, s33, 2
    s_add_u32 s30, s30, s33
    s_add_u32 s30, s30, 14716928
    s_add_u32 s56, s22, s30
    s_addc_u32 s57, s23, 0
    v_and_b32 v248, 7, v1
    v_lshlrev_b32 v248, 7, v248
    v_bfe_u32 v11, v1, 3, 1
    v_mul_u32_u24 v11, 20480, v11
    v_add_u32 v248, v248, v11
    s_lshl_b32 s33, s26, 10
    s_sub_u32 s31, s31, s33
    v_bfe_u32 v11, v1, 4, 1
    v_mul_lo_u32 v11, v11, s31
    v_add3_u32 v248, v248, v11, s33
    s_mul_i32 s30, s34, 49152
    s_mul_i32 s31, s26, 3072
    s_add_u32 s30, s30, s31
    s_add_u32 s30, s30, 25460736
    s_add_u32 s58, s22, s30
    s_addc_u32 s59, s23, 0
    s_add_u32 s72, s22, s30
    s_addc_u32 s73, s23, 0
    v_lshrrev_b32 v11, 5, v1
    v_mul_u32_u24 v11, 49152, v11
    v_and_b32 v12, 31, v1
    v_min_u32 v12, 23, v12
    v_lshl_add_u32 v249, v12, 7, v11
    s_lshl_b32 s30, s26, 16
    s_add_u32 s30, s30, 12615680
    s_add_u32 s86, s22, s30
    s_addc_u32 s87, s23, 0
    s_lshl_b32 s31, s25, 12
    s_add_u32 s30, s30, s31
    s_lshr_b32 s32, s24, 1
    s_mul_i32 s31, s32, 1920
    s_add_u32 s30, s30, s31
    s_add_u32 s88, s22, s30
    s_addc_u32 s89, s23, 0
    s_lshl_b32 s30, s25, 8
    s_add_u32 s30, s30, 0
    s_add_u32 s0, s22, s30
    s_addc_u32 s1, s23, 0
    s_lshl_b32 s30, s26, 2
    v_mov_b32 v247, s30
    v_lshlrev_b32 v14, 2, v3
    global_load_dwordx4 a[0:3], v5, s[4:5] offset:-4096 sc1
    global_load_dwordx4 a[80:83], v7, s[4:5] offset:0 sc1
    global_load_dwordx4 a[4:7], v5, s[4:5] offset:-3072 sc1
    global_load_dwordx4 a[84:87], v7, s[4:5] offset:1024 sc1
    global_load_dwordx4 a[8:11], v5, s[4:5] offset:-2048 sc1
    global_load_dwordx4 a[88:91], v7, s[4:5] offset:2048 sc1
    s_cselect_b32 s82, 1, 0
    s_add_u32 s79, s98, 53248
    s_add_u32 m0, s98, 69632
    s_add_u32 s80, s36, s79
    s_addc_u32 s81, s37, 0
    s_cmp_lg_u32 s82, 0
    global_load_lds_dwordx4 v2, s[80:81] offset:-4096
    global_load_lds_dwordx4 v2, s[80:81] offset:-3072
    global_load_lds_dwordx4 v2, s[80:81] offset:-2048
    global_load_lds_dwordx4 v2, s[80:81] offset:-1024
    global_load_lds_dwordx4 v2, s[80:81] offset:0
    global_load_lds_dwordx4 v2, s[80:81] offset:1024
    s_lshl_b32 s30, s28, 20
    s_add_u32 s60, s86, s30
    s_addc_u32 s61, s87, 0
    s_add_u32 s62, s88, s30
    s_addc_u32 s63, s89, 0
    s_lshl_b32 s30, s28, 4
    s_add_u32 s30, s30, s26
    s_lshl_b32 s30, s30, 8
    s_add_u32 s67, s30, 8192
    s_lshl_b32 s30, s25, 2
    s_add_u32 s66, s67, s30
    s_waitcnt vmcnt(18)
    s_barrier
    global_load_dwordx4 a[12:15], v5, s[4:5] offset:-1024 sc1
    global_load_dwordx4 a[92:95], v7, s[4:5] offset:3072 sc1
    ds_read_b128 a[160:163], v15 offset:0
    ds_read_b128 a[164:167], v15 offset:1024
    ds_read_b128 a[168:171], v15 offset:2048
    ds_read_b128 a[172:175], v15 offset:3072
    ds_read_b128 a[176:179], v15 offset:4096
    global_load_dwordx4 a[16:19], v5, s[4:5] offset:0 sc1
    ds_read_b128 a[180:183], v15 offset:5120
    ds_read_b128 a[184:187], v15 offset:6144
    ds_read_b128 a[188:191], v15 offset:7168
    ds_read_b128 a[192:195], v15 offset:8192
    ds_read_b128 a[196:199], v15 offset:9216
    s_waitcnt lgkmcnt(5)
    s_waitcnt vmcnt(14)
    v_mfma_f32_16x16x32_bf16 v[32:35], a[160:163], a[0:3], 0
    ds_read_b128 a[200:203], v15 offset:10240
    s_waitcnt vmcnt(13)
    v_mfma_f32_16x16x32_bf16 v[52:55], a[160:163], a[80:83], 0
    global_load_dwordx4 a[96:99], v8, s[4:5] offset:-4096 sc1
    ds_read_b128 a[204:207], v15 offset:11264
    v_mfma_f32_16x16x32_bf16 v[36:39], a[164:167], a[0:3], 0
    ds_read_b128 a[208:211], v15 offset:12288
    v_mfma_f32_16x16x32_bf16 v[56:59], a[164:167], a[80:83], 0
    ds_read_b128 a[212:215], v15 offset:13312
    v_mfma_f32_16x16x32_bf16 v[40:43], a[168:171], a[0:3], 0
    global_load_dwordx4 a[20:23], v5, s[4:5] offset:1024 sc1
    ds_read_b128 a[216:219], v15 offset:14336
    v_mfma_f32_16x16x32_bf16 v[60:63], a[168:171], a[80:83], 0
    v_mfma_f32_16x16x32_bf16 v[44:47], a[172:175], a[0:3], 0
    v_mfma_f32_16x16x32_bf16 v[64:67], a[172:175], a[80:83], 0
    global_load_dwordx4 a[100:103], v8, s[4:5] offset:-3072 sc1
    v_mfma_f32_16x16x32_bf16 v[48:51], a[176:179], a[0:3], 0
    v_mfma_f32_16x16x32_bf16 v[68:71], a[176:179], a[80:83], 0
    s_waitcnt lgkmcnt(5)
    s_waitcnt vmcnt(15)
    v_mfma_f32_16x16x32_bf16 v[32:35], a[180:183], a[4:7], v[32:35]
    ds_read_b128 a[160:163], v15 offset:15360
    s_waitcnt vmcnt(14)
    v_mfma_f32_16x16x32_bf16 v[52:55], a[180:183], a[84:87], v[52:55]
    global_load_dwordx4 a[24:27], v5, s[4:5] offset:2048 sc1
    ds_read_b128 a[164:167], v15 offset:16384
    v_mfma_f32_16x16x32_bf16 v[36:39], a[184:187], a[4:7], v[36:39]
    ds_read_b128 a[168:171], v15 offset:17408
    v_mfma_f32_16x16x32_bf16 v[56:59], a[184:187], a[84:87], v[56:59]
    ds_read_b128 a[172:175], v15 offset:18432
    global_load_dwordx4 a[104:107], v8, s[4:5] offset:-2048 sc1
    v_mfma_f32_16x16x32_bf16 v[40:43], a[188:191], a[4:7], v[40:43]
    ds_read_b128 a[176:179], v15 offset:19456
    v_mfma_f32_16x16x32_bf16 v[60:63], a[188:191], a[84:87], v[60:63]
    s_add_u32 s79, s98, 77824
    s_add_u32 m0, s98, 94208
    s_add_u32 s80, s36, s79
    s_addc_u32 s81, s37, 0
    global_load_lds_dwordx4 v2, s[80:81] offset:-4096
    global_load_lds_dwordx4 v2, s[80:81] offset:-3072
    global_load_lds_dwordx4 v2, s[80:81] offset:-2048
    global_load_lds_dwordx4 v2, s[80:81] offset:-1024
    global_load_lds_dwordx4 v2, s[80:81] offset:0
    global_load_lds_dwordx4 v2, s[80:81] offset:1024
    global_load_dwordx4 a[28:31], v5, s[4:5] offset:3072 sc1
    v_mfma_f32_16x16x32_bf16 v[44:47], a[192:195], a[4:7], v[44:47]
    v_mfma_f32_16x16x32_bf16 v[64:67], a[192:195], a[84:87], v[64:67]
    v_mfma_f32_16x16x32_bf16 v[48:51], a[196:199], a[4:7], v[48:51]
    global_load_dwordx4 a[108:111], v8, s[4:5] offset:-1024 sc1
    v_mfma_f32_16x16x32_bf16 v[68:71], a[196:199], a[84:87], v[68:71]
    s_barrier
    s_barrier
    s_lshl_b32 s30, s2, 2
    s_add_u32 s30, s30, 20480
    v_mov_b32 v11, s30
    v_mov_b32 v12, 1
    s_cmp_eq_u32 s24, 0
    s_cselect_b64 exec, 1, 0
    global_store_dword v11, v12, s[22:23] sc1
    s_mov_b64 exec, -1
    s_waitcnt lgkmcnt(5)
    global_load_dwordx4 a[32:35], v6, s[4:5] offset:-4096 sc1
    s_waitcnt vmcnt(25)
    v_mfma_f32_16x16x32_bf16 v[32:35], a[200:203], a[8:11], v[32:35]
    ds_read_b128 a[180:183], v15 offset:20480
    s_waitcnt vmcnt(24)
    v_mfma_f32_16x16x32_bf16 v[52:55], a[200:203], a[88:91], v[52:55]
    ds_read_b128 a[184:187], v15 offset:21504
    v_mfma_f32_16x16x32_bf16 v[36:39], a[204:207], a[8:11], v[36:39]
    global_load_dwordx4 a[112:115], v8, s[4:5] offset:0 sc1
    ds_read_b128 a[188:191], v15 offset:22528
    v_mfma_f32_16x16x32_bf16 v[56:59], a[204:207], a[88:91], v[56:59]
    ds_read_b128 a[192:195], v15 offset:23552
    v_mfma_f32_16x16x32_bf16 v[40:43], a[208:211], a[8:11], v[40:43]
    ds_read_b128 a[196:199], v10 offset:49152
    v_mfma_f32_16x16x32_bf16 v[60:63], a[208:211], a[88:91], v[60:63]
    global_load_dwordx4 v[16:19], v5, s[6:7] offset:-4096 sc1
    v_mfma_f32_16x16x32_bf16 v[44:47], a[212:215], a[8:11], v[44:47]
    v_mfma_f32_16x16x32_bf16 v[64:67], a[212:215], a[88:91], v[64:67]
    v_mfma_f32_16x16x32_bf16 v[48:51], a[216:219], a[8:11], v[48:51]
    global_load_dwordx4 v[20:23], v5, s[6:7] offset:-3072 sc1
    v_mfma_f32_16x16x32_bf16 v[68:71], a[216:219], a[88:91], v[68:71]
    s_waitcnt lgkmcnt(5)
    s_waitcnt vmcnt(20)
    v_mfma_f32_16x16x32_bf16 v[32:35], a[160:163], a[12:15], v[32:35]
    ds_read_b128 a[200:203], v10 offset:50176
    s_waitcnt vmcnt(19)
    v_mfma_f32_16x16x32_bf16 v[52:55], a[160:163], a[92:95], v[52:55]
    ds_read_b128 a[204:207], v10 offset:51200
    global_load_dwordx4 a[36:39], v6, s[4:5] offset:-3072 sc1
    v_mfma_f32_16x16x32_bf16 v[36:39], a[164:167], a[12:15], v[36:39]
    ds_read_b128 a[208:211], v10 offset:52224
    v_mfma_f32_16x16x32_bf16 v[56:59], a[164:167], a[92:95], v[56:59]
    ds_read_b128 a[212:215], v10 offset:53248
    v_mfma_f32_16x16x32_bf16 v[40:43], a[168:171], a[12:15], v[40:43]
    global_load_dwordx4 a[116:119], v8, s[4:5] offset:1024 sc1
    ds_read_b128 a[216:219], v10 offset:54272
    v_mfma_f32_16x16x32_bf16 v[60:63], a[168:171], a[92:95], v[60:63]
    v_mfma_f32_16x16x32_bf16 v[44:47], a[172:175], a[12:15], v[44:47]
    v_mfma_f32_16x16x32_bf16 v[64:67], a[172:175], a[92:95], v[64:67]
    v_mfma_f32_16x16x32_bf16 v[48:51], a[176:179], a[12:15], v[48:51]
    global_load_dwordx4 a[40:43], v6, s[4:5] offset:-2048 sc1
    v_mfma_f32_16x16x32_bf16 v[68:71], a[176:179], a[92:95], v[68:71]
    s_waitcnt lgkmcnt(5)
    s_waitcnt vmcnt(21)
    v_mfma_f32_16x16x32_bf16 v[32:35], a[180:183], a[16:19], v[32:35]
    ds_read_b128 a[160:163], v10 offset:55296
    s_waitcnt vmcnt(20)
    v_mfma_f32_16x16x32_bf16 v[52:55], a[180:183], a[96:99], v[52:55]
    global_load_dwordx4 a[120:123], v8, s[4:5] offset:2048 sc1
    ds_read_b128 a[164:167], v10 offset:56320
    v_mfma_f32_16x16x32_bf16 v[36:39], a[184:187], a[16:19], v[36:39]
    ds_read_b128 a[168:171], v10 offset:57344
    v_mfma_f32_16x16x32_bf16 v[56:59], a[184:187], a[96:99], v[56:59]
    ds_read_b128 a[172:175], v10 offset:58368
    v_mfma_f32_16x16x32_bf16 v[40:43], a[188:191], a[16:19], v[40:43]
    global_load_dwordx4 a[44:47], v6, s[4:5] offset:-1024 sc1
    ds_read_b128 a[176:179], v10 offset:59392
    v_mfma_f32_16x16x32_bf16 v[60:63], a[188:191], a[96:99], v[60:63]
    v_mfma_f32_16x16x32_bf16 v[44:47], a[192:195], a[16:19], v[44:47]
    v_mfma_f32_16x16x32_bf16 v[64:67], a[192:195], a[96:99], v[64:67]
    global_load_dwordx4 a[124:127], v8, s[4:5] offset:3072 sc1
    v_mfma_f32_16x16x32_bf16 v[48:51], a[196:199], a[16:19], v[48:51]
    v_mfma_f32_16x16x32_bf16 v[68:71], a[196:199], a[96:99], v[68:71]
    s_waitcnt lgkmcnt(5)
    s_waitcnt vmcnt(22)
    v_mfma_f32_16x16x32_bf16 v[32:35], a[200:203], a[20:23], v[32:35]
    global_load_dwordx4 a[48:51], v6, s[4:5] offset:0 sc1
    ds_read_b128 a[180:183], v10 offset:60416
    s_waitcnt vmcnt(22)
    v_mfma_f32_16x16x32_bf16 v[52:55], a[200:203], a[100:103], v[52:55]
    ds_read_b128 a[184:187], v10 offset:61440
    v_mfma_f32_16x16x32_bf16 v[36:39], a[204:207], a[20:23], v[36:39]
    ds_read_b128 a[188:191], v10 offset:62464
    v_mfma_f32_16x16x32_bf16 v[56:59], a[204:207], a[100:103], v[56:59]
    global_load_dwordx4 a[128:131], v9, s[4:5] offset:-4096 sc1
    ds_read_b128 a[192:195], v10 offset:63488
    v_mfma_f32_16x16x32_bf16 v[40:43], a[208:211], a[20:23], v[40:43]
    ds_read_b128 a[196:199], v10 offset:64512
    v_mfma_f32_16x16x32_bf16 v[60:63], a[208:211], a[100:103], v[60:63]
    s_add_u32 s79, s100, 102400
    s_add_u32 m0, s100, 4096
    s_add_u32 s80, s36, s79
    s_addc_u32 s81, s37, 0
    global_load_lds_dwordx4 v2, s[80:81] offset:-4096
    global_load_lds_dwordx4 v2, s[80:81] offset:-3072
    global_load_lds_dwordx4 v2, s[80:81] offset:-2048
    global_load_dwordx4 a[52:55], v6, s[4:5] offset:1024 sc1
    v_mfma_f32_16x16x32_bf16 v[44:47], a[212:215], a[20:23], v[44:47]
    v_mfma_f32_16x16x32_bf16 v[64:67], a[212:215], a[100:103], v[64:67]
    v_mfma_f32_16x16x32_bf16 v[48:51], a[216:219], a[20:23], v[48:51]
    global_load_dwordx4 a[132:135], v9, s[4:5] offset:-3072 sc1
    v_mfma_f32_16x16x32_bf16 v[68:71], a[216:219], a[100:103], v[68:71]
    s_barrier
    s_waitcnt lgkmcnt(5)
    s_waitcnt vmcnt(27)
    v_mfma_f32_16x16x32_bf16 v[32:35], a[160:163], a[24:27], v[32:35]
    ds_read_b128 a[200:203], v15 offset:24576
    s_waitcnt vmcnt(26)
    v_mfma_f32_16x16x32_bf16 v[52:55], a[160:163], a[104:107], v[52:55]
    global_load_dwordx4 a[56:59], v6, s[4:5] offset:2048 sc1
    ds_read_b128 a[204:207], v15 offset:25600
    v_mfma_f32_16x16x32_bf16 v[36:39], a[164:167], a[24:27], v[36:39]
    ds_read_b128 a[208:211], v15 offset:26624
    v_mfma_f32_16x16x32_bf16 v[56:59], a[164:167], a[104:107], v[56:59]
    ds_read_b128 a[212:215], v15 offset:27648
    v_mfma_f32_16x16x32_bf16 v[40:43], a[168:171], a[24:27], v[40:43]
    global_load_dwordx4 a[136:139], v9, s[4:5] offset:-2048 sc1
    ds_read_b128 a[216:219], v15 offset:28672
    v_mfma_f32_16x16x32_bf16 v[60:63], a[168:171], a[104:107], v[60:63]
    v_mfma_f32_16x16x32_bf16 v[44:47], a[172:175], a[24:27], v[44:47]
    v_mfma_f32_16x16x32_bf16 v[64:67], a[172:175], a[104:107], v[64:67]
    global_load_dwordx4 a[60:63], v6, s[4:5] offset:3072 sc1
    v_mfma_f32_16x16x32_bf16 v[48:51], a[176:179], a[24:27], v[48:51]
    v_mfma_f32_16x16x32_bf16 v[68:71], a[176:179], a[104:107], v[68:71]
    s_waitcnt lgkmcnt(5)
    s_waitcnt vmcnt(22)
    v_mfma_f32_16x16x32_bf16 v[32:35], a[180:183], a[28:31], v[32:35]
    ds_read_b128 a[160:163], v15 offset:29696
    global_load_dwordx4 a[140:143], v9, s[4:5] offset:-1024 sc1
    s_waitcnt vmcnt(22)
    v_mfma_f32_16x16x32_bf16 v[52:55], a[180:183], a[108:111], v[52:55]
    ds_read_b128 a[164:167], v15 offset:30720
    v_mfma_f32_16x16x32_bf16 v[36:39], a[184:187], a[28:31], v[36:39]
    ds_read_b128 a[168:171], v15 offset:31744
    v_mfma_f32_16x16x32_bf16 v[56:59], a[184:187], a[108:111], v[56:59]
    global_load_dwordx4 a[64:67], v7, s[4:5] offset:-4096 sc1
    ds_read_b128 a[172:175], v10 offset:0
    v_mfma_f32_16x16x32_bf16 v[40:43], a[188:191], a[28:31], v[40:43]
    ds_read_b128 a[176:179], v10 offset:1024
    v_mfma_f32_16x16x32_bf16 v[60:63], a[188:191], a[108:111], v[60:63]
    v_mfma_f32_16x16x32_bf16 v[44:47], a[192:195], a[28:31], v[44:47]
    global_load_dwordx4 a[144:147], v9, s[4:5] offset:0 sc1
    v_mfma_f32_16x16x32_bf16 v[64:67], a[192:195], a[108:111], v[64:67]
    v_mfma_f32_16x16x32_bf16 v[48:51], a[196:199], a[28:31], v[48:51]
    v_mfma_f32_16x16x32_bf16 v[68:71], a[196:199], a[108:111], v[68:71]
    s_waitcnt lgkmcnt(5)
    s_waitcnt vmcnt(22)
    v_mfma_f32_16x16x32_bf16 v[32:35], a[200:203], a[32:35], v[32:35]
    global_load_dwordx4 a[68:71], v7, s[4:5] offset:-3072 sc1
    ds_read_b128 a[180:183], v10 offset:2048
    s_waitcnt vmcnt(22)
    v_mfma_f32_16x16x32_bf16 v[52:55], a[200:203], a[112:115], v[52:55]
    ds_read_b128 a[184:187], v10 offset:3072
    v_mfma_f32_16x16x32_bf16 v[36:39], a[204:207], a[32:35], v[36:39]
    ds_read_b128 a[188:191], v10 offset:4096
    v_mfma_f32_16x16x32_bf16 v[56:59], a[204:207], a[112:115], v[56:59]
    global_load_dwordx4 a[148:151], v9, s[4:5] offset:1024 sc1
    ds_read_b128 a[192:195], v10 offset:5120
    v_mfma_f32_16x16x32_bf16 v[40:43], a[208:211], a[32:35], v[40:43]
    ds_read_b128 a[196:199], v10 offset:6144
    v_mfma_f32_16x16x32_bf16 v[60:63], a[208:211], a[112:115], v[60:63]
    v_mfma_f32_16x16x32_bf16 v[44:47], a[212:215], a[32:35], v[44:47]
    global_load_dwordx4 a[232:235], v5, s[8:9] offset:-4096
    v_mfma_f32_16x16x32_bf16 v[64:67], a[212:215], a[112:115], v[64:67]
    v_mfma_f32_16x16x32_bf16 v[48:51], a[216:219], a[32:35], v[48:51]
    v_mfma_f32_16x16x32_bf16 v[68:71], a[216:219], a[112:115], v[68:71]
    s_waitcnt lgkmcnt(5)
    global_load_dwordx4 a[236:239], v5, s[8:9] offset:-3072
    s_waitcnt vmcnt(22)
    v_mfma_f32_16x16x32_bf16 v[32:35], a[160:163], a[36:39], v[32:35]
    ds_read_b128 a[200:203], v10 offset:7168
    s_waitcnt vmcnt(21)
    v_mfma_f32_16x16x32_bf16 v[52:55], a[160:163], a[116:119], v[52:55]
    ds_read_b128 a[204:207], v10 offset:8192
    v_mfma_f32_16x16x32_bf16 v[36:39], a[164:167], a[36:39], v[36:39]
    global_load_dwordx4 a[240:243], v5, s[8:9] offset:-2048
    ds_read_b128 a[208:211], v10 offset:9216
    v_mfma_f32_16x16x32_bf16 v[56:59], a[164:167], a[116:119], v[56:59]
    ds_read_b128 a[212:215], v10 offset:10240
    v_mfma_f32_16x16x32_bf16 v[40:43], a[168:171], a[36:39], v[40:43]
    ds_read_b128 a[216:219], v10 offset:11264
    v_mfma_f32_16x16x32_bf16 v[60:63], a[168:171], a[116:119], v[60:63]
    global_load_dwordx4 a[244:247], v5, s[8:9] offset:-1024
    v_mfma_f32_16x16x32_bf16 v[44:47], a[172:175], a[36:39], v[44:47]
    v_mfma_f32_16x16x32_bf16 v[64:67], a[172:175], a[116:119], v[64:67]
    v_mfma_f32_16x16x32_bf16 v[48:51], a[176:179], a[36:39], v[48:51]
    global_load_dwordx4 a[248:251], v5, s[8:9] offset:0
    v_mfma_f32_16x16x32_bf16 v[68:71], a[176:179], a[116:119], v[68:71]
    s_waitcnt lgkmcnt(5)
    s_waitcnt vmcnt(23)
    v_mfma_f32_16x16x32_bf16 v[32:35], a[180:183], a[40:43], v[32:35]
    ds_read_b128 a[160:163], v10 offset:12288
    s_waitcnt vmcnt(22)
    v_mfma_f32_16x16x32_bf16 v[52:55], a[180:183], a[120:123], v[52:55]
    ds_read_b128 a[164:167], v10 offset:13312
    global_load_dwordx4 a[252:255], v5, s[8:9] offset:1024
    v_mfma_f32_16x16x32_bf16 v[36:39], a[184:187], a[40:43], v[36:39]
    ds_read_b128 a[168:171], v10 offset:14336
    v_mfma_f32_16x16x32_bf16 v[56:59], a[184:187], a[120:123], v[56:59]
    ds_read_b128 a[172:175], v10 offset:15360
    v_mfma_f32_16x16x32_bf16 v[40:43], a[188:191], a[40:43], v[40:43]
    global_load_dwordx4 a[72:75], v7, s[4:5] offset:-2048 sc1
    ds_read_b128 a[176:179], v10 offset:16384
    v_mfma_f32_16x16x32_bf16 v[60:63], a[188:191], a[120:123], v[60:63]
    v_mfma_f32_16x16x32_bf16 v[44:47], a[192:195], a[40:43], v[44:47]
    v_mfma_f32_16x16x32_bf16 v[64:67], a[192:195], a[120:123], v[64:67]
    v_mfma_f32_16x16x32_bf16 v[48:51], a[196:199], a[40:43], v[48:51]
    global_load_dwordx4 a[152:155], v9, s[4:5] offset:2048 sc1
    v_mfma_f32_16x16x32_bf16 v[68:71], a[196:199], a[120:123], v[68:71]
    s_waitcnt lgkmcnt(5)
    s_waitcnt vmcnt(24)
    v_mfma_f32_16x16x32_bf16 v[32:35], a[200:203], a[44:47], v[32:35]
    ds_read_b128 a[180:183], v10 offset:17408
    s_waitcnt vmcnt(23)
    v_mfma_f32_16x16x32_bf16 v[52:55], a[200:203], a[124:127], v[52:55]
    global_load_dwordx4 a[76:79], v7, s[4:5] offset:-1024 sc1
    ds_read_b128 a[184:187], v10 offset:18432
    v_mfma_f32_16x16x32_bf16 v[36:39], a[204:207], a[44:47], v[36:39]
    ds_read_b128 a[188:191], v10 offset:19456
    v_mfma_f32_16x16x32_bf16 v[56:59], a[204:207], a[124:127], v[56:59]
    ds_read_b128 a[192:195], v10 offset:20480
    v_mfma_f32_16x16x32_bf16 v[40:43], a[208:211], a[44:47], v[40:43]
    global_load_dwordx4 a[156:159], v9, s[4:5] offset:3072 sc1
    ds_read_b128 a[196:199], v10 offset:21504
    v_mfma_f32_16x16x32_bf16 v[60:63], a[208:211], a[124:127], v[60:63]
    v_mfma_f32_16x16x32_bf16 v[44:47], a[212:215], a[44:47], v[44:47]
    v_mfma_f32_16x16x32_bf16 v[64:67], a[212:215], a[124:127], v[64:67]
    global_load_dword v250, v248, s[70:71]
    v_mfma_f32_16x16x32_bf16 v[48:51], a[216:219], a[44:47], v[48:51]
    v_mfma_f32_16x16x32_bf16 v[68:71], a[216:219], a[124:127], v[68:71]
    s_barrier
    s_waitcnt lgkmcnt(5)
    s_waitcnt vmcnt(25)
    v_mfma_f32_16x16x32_bf16 v[32:35], a[160:163], a[48:51], v[32:35]
    global_load_dword v250, v249, s[72:73]
    ds_read_b128 a[200:203], v10 offset:22528
    s_waitcnt vmcnt(25)
    v_mfma_f32_16x16x32_bf16 v[52:55], a[160:163], a[128:131], v[52:55]
    ds_read_b128 a[204:207], v10 offset:23552
    v_mfma_f32_16x16x32_bf16 v[36:39], a[164:167], a[48:51], v[36:39]
    ds_read_b128 a[208:211], v10 offset:24576
    v_mfma_f32_16x16x32_bf16 v[56:59], a[164:167], a[128:131], v[56:59]
    ds_read_b128 a[212:215], v10 offset:25600
    v_mfma_f32_16x16x32_bf16 v[40:43], a[168:171], a[48:51], v[40:43]
    ds_read_b128 a[216:219], v10 offset:26624
    v_mfma_f32_16x16x32_bf16 v[60:63], a[168:171], a[128:131], v[60:63]
    v_mfma_f32_16x16x32_bf16 v[44:47], a[172:175], a[48:51], v[44:47]
    v_mfma_f32_16x16x32_bf16 v[64:67], a[172:175], a[128:131], v[64:67]
    v_mfma_f32_16x16x32_bf16 v[48:51], a[176:179], a[48:51], v[48:51]
    v_mfma_f32_16x16x32_bf16 v[68:71], a[176:179], a[128:131], v[68:71]
    s_waitcnt lgkmcnt(5)
    s_waitcnt vmcnt(21)
    v_mfma_f32_16x16x32_bf16 v[32:35], a[180:183], a[52:55], v[32:35]
    ds_read_b128 a[160:163], v10 offset:27648
    v_add_f32 v16, v16, v18
    s_waitcnt vmcnt(20)
    v_mfma_f32_16x16x32_bf16 v[52:55], a[180:183], a[132:135], v[52:55]
    ds_read_b128 a[164:167], v10 offset:28672
    v_add_f32 v20, v20, v22
    v_mfma_f32_16x16x32_bf16 v[36:39], a[184:187], a[52:55], v[36:39]
    ds_read_b128 a[168:171], v10 offset:29696
    v_add_f32 v17, v17, v19
    v_mfma_f32_16x16x32_bf16 v[56:59], a[184:187], a[132:135], v[56:59]
    ds_read_b128 a[172:175], v10 offset:30720
    v_add_f32 v21, v21, v23
    v_mfma_f32_16x16x32_bf16 v[40:43], a[188:191], a[52:55], v[40:43]
    ds_read_b128 a[176:179], v10 offset:31744
    v_mfma_f32_16x16x32_bf16 v[60:63], a[188:191], a[132:135], v[60:63]
    v_mov_b32 v28, v16
    v_mfma_f32_16x16x32_bf16 v[44:47], a[192:195], a[52:55], v[44:47]
    v_mov_b32 v30, v20
    v_mfma_f32_16x16x32_bf16 v[64:67], a[192:195], a[132:135], v[64:67]
    v_mov_b32 v29, v17
    v_mfma_f32_16x16x32_bf16 v[48:51], a[196:199], a[52:55], v[48:51]
    v_mov_b32 v31, v21
    v_mfma_f32_16x16x32_bf16 v[68:71], a[196:199], a[132:135], v[68:71]
    v_permlane16_swap_b32 v16, v28
    s_waitcnt lgkmcnt(5)
    s_waitcnt vmcnt(19)
    v_mfma_f32_16x16x32_bf16 v[32:35], a[200:203], a[56:59], v[32:35]
    ds_read_b128 a[180:183], v10 offset:32768
    v_permlane16_swap_b32 v20, v30
    s_waitcnt vmcnt(18)
    v_mfma_f32_16x16x32_bf16 v[52:55], a[200:203], a[136:139], v[52:55]
    ds_read_b128 a[184:187], v10 offset:33792
    v_permlane16_swap_b32 v17, v29
    v_mfma_f32_16x16x32_bf16 v[36:39], a[204:207], a[56:59], v[36:39]
    ds_read_b128 a[188:191], v10 offset:34816
    v_permlane16_swap_b32 v21, v31
    v_mfma_f32_16x16x32_bf16 v[56:59], a[204:207], a[136:139], v[56:59]
    ds_read_b128 a[192:195], v10 offset:35840
    v_add_f32 v16, v16, v28
    v_mfma_f32_16x16x32_bf16 v[40:43], a[208:211], a[56:59], v[40:43]
    ds_read_b128 a[196:199], v10 offset:36864
    v_mfma_f32_16x16x32_bf16 v[60:63], a[208:211], a[136:139], v[60:63]
    v_add_f32 v20, v20, v30
    v_mfma_f32_16x16x32_bf16 v[44:47], a[212:215], a[56:59], v[44:47]
    v_add_f32 v17, v17, v29
    v_mfma_f32_16x16x32_bf16 v[64:67], a[212:215], a[136:139], v[64:67]
    v_add_f32 v21, v21, v31
    v_mfma_f32_16x16x32_bf16 v[48:51], a[216:219], a[56:59], v[48:51]
    v_mov_b32 v28, v16
    v_mfma_f32_16x16x32_bf16 v[68:71], a[216:219], a[136:139], v[68:71]
    v_mov_b32 v30, v20
    s_waitcnt lgkmcnt(5)
    s_waitcnt vmcnt(17)
    v_mfma_f32_16x16x32_bf16 v[32:35], a[160:163], a[60:63], v[32:35]
    ds_read_b128 a[200:203], v10 offset:37888
    v_mov_b32 v29, v17
    s_waitcnt vmcnt(16)
    v_mfma_f32_16x16x32_bf16 v[52:55], a[160:163], a[140:143], v[52:55]
    ds_read_b128 a[204:207], v10 offset:38912
    v_mov_b32 v31, v21
    v_mfma_f32_16x16x32_bf16 v[36:39], a[164:167], a[60:63], v[36:39]
    ds_read_b128 a[208:211], v10 offset:39936
    v_permlane32_swap_b32 v16, v28
    v_mfma_f32_16x16x32_bf16 v[56:59], a[164:167], a[140:143], v[56:59]
    ds_read_b128 a[212:215], v10 offset:40960
    v_permlane32_swap_b32 v20, v30
    v_mfma_f32_16x16x32_bf16 v[40:43], a[168:171], a[60:63], v[40:43]
    ds_read_b128 a[216:219], v10 offset:41984
    v_mfma_f32_16x16x32_bf16 v[60:63], a[168:171], a[140:143], v[60:63]
    v_permlane32_swap_b32 v17, v29
    v_mfma_f32_16x16x32_bf16 v[44:47], a[172:175], a[60:63], v[44:47]
    v_permlane32_swap_b32 v21, v31
    v_mfma_f32_16x16x32_bf16 v[64:67], a[172:175], a[140:143], v[64:67]
    v_add_f32 v16, v16, v28
    v_mfma_f32_16x16x32_bf16 v[48:51], a[176:179], a[60:63], v[48:51]
    v_add_f32 v20, v20, v30
    v_mfma_f32_16x16x32_bf16 v[68:71], a[176:179], a[140:143], v[68:71]
    v_add_f32 v17, v17, v29
    s_waitcnt lgkmcnt(5)
    s_waitcnt vmcnt(15)
    v_mfma_f32_16x16x32_bf16 v[32:35], a[180:183], a[64:67], v[32:35]
    ds_read_b128 a[160:163], v10 offset:43008
    v_add_f32 v21, v21, v31
    s_waitcnt vmcnt(14)
    v_mfma_f32_16x16x32_bf16 v[52:55], a[180:183], a[144:147], v[52:55]
    ds_read_b128 a[164:167], v10 offset:44032
    v_mul_f32 v16, 0xbacccccd, v16
    v_mfma_f32_16x16x32_bf16 v[36:39], a[184:187], a[64:67], v[36:39]
    ds_read_b128 a[168:171], v10 offset:45056
    v_mul_f32 v20, 0xbacccccd, v20
    v_mfma_f32_16x16x32_bf16 v[56:59], a[184:187], a[144:147], v[56:59]
    ds_read_b128 a[172:175], v10 offset:46080
    v_mul_f32 v17, 0x3acccccd, v17
    v_mfma_f32_16x16x32_bf16 v[40:43], a[188:191], a[64:67], v[40:43]
    ds_read_b128 a[176:179], v10 offset:47104
    v_mfma_f32_16x16x32_bf16 v[60:63], a[188:191], a[144:147], v[60:63]
    v_mul_f32 v21, 0x3acccccd, v21
    v_mfma_f32_16x16x32_bf16 v[44:47], a[192:195], a[64:67], v[44:47]
    v_fma_f32 v17, -v16, v16, v17
    v_mfma_f32_16x16x32_bf16 v[64:67], a[192:195], a[144:147], v[64:67]
    v_fma_f32 v21, -v20, v20, v21
    v_mfma_f32_16x16x32_bf16 v[48:51], a[196:199], a[64:67], v[48:51]
    v_max_f32 v17, 0, v17
    v_mfma_f32_16x16x32_bf16 v[68:71], a[196:199], a[144:147], v[68:71]
    v_max_f32 v21, 0, v21
    s_barrier
    s_waitcnt lgkmcnt(5)
    s_waitcnt vmcnt(13)
    v_mfma_f32_16x16x32_bf16 v[32:35], a[200:203], a[68:71], v[32:35]
    ds_read_b128 a[180:183], v10 offset:48128
    v_add_f32 v17, 0x3727c5ac, v17
    s_waitcnt vmcnt(12)
    v_mfma_f32_16x16x32_bf16 v[52:55], a[200:203], a[148:151], v[52:55]
    ds_read_b128 a[184:187], v2 offset:0
    v_add_f32 v21, 0x3727c5ac, v21
    v_mfma_f32_16x16x32_bf16 v[36:39], a[204:207], a[68:71], v[36:39]
    ds_read_b128 a[188:191], v2 offset:1024
    v_rsq_f32 v24, v17
    v_mfma_f32_16x16x32_bf16 v[56:59], a[204:207], a[148:151], v[56:59]
    ds_read_b128 a[192:195], v2 offset:2048
    v_rsq_f32 v26, v21
    v_mfma_f32_16x16x32_bf16 v[40:43], a[208:211], a[68:71], v[40:43]
    ds_read_b128 a[196:199], v2 offset:3072
    v_mfma_f32_16x16x32_bf16 v[60:63], a[208:211], a[148:151], v[60:63]
    v_cvt_pk_bf16_f32 v28, v16, v16
    v_mfma_f32_16x16x32_bf16 v[44:47], a[212:215], a[68:71], v[44:47]
    v_cvt_pk_bf16_f32 v30, v20, v20
    v_mfma_f32_16x16x32_bf16 v[64:67], a[212:215], a[148:151], v[64:67]
    v_and_b32 v28, 0xffff0000, v28
    v_mfma_f32_16x16x32_bf16 v[48:51], a[216:219], a[68:71], v[48:51]
    v_and_b32 v30, 0xffff0000, v30
    v_mfma_f32_16x16x32_bf16 v[68:71], a[216:219], a[148:151], v[68:71]
    v_sub_f32 v28, v16, v28
    s_waitcnt lgkmcnt(5)
    s_waitcnt vmcnt(5)
    v_mfma_f32_16x16x32_bf16 v[32:35], a[160:163], a[72:75], v[32:35]
    ds_read_b128 a[200:203], v2 offset:4096
    v_sub_f32 v30, v20, v30
    s_waitcnt vmcnt(4)
    v_mfma_f32_16x16x32_bf16 v[52:55], a[160:163], a[152:155], v[52:55]
    ds_read_b128 a[204:207], v2 offset:5120
    v_cvt_pk_bf16_f32 v104, v16, v28
    v_mfma_f32_16x16x32_bf16 v[36:39], a[164:167], a[72:75], v[36:39]
    ds_read_b128 a[208:211], v2 offset:6144
    v_cvt_pk_bf16_f32 v108, v20, v30
    v_mfma_f32_16x16x32_bf16 v[56:59], a[164:167], a[152:155], v[56:59]
    ds_read_b128 a[212:215], v2 offset:7168
    v_mov_b32 v106, 0
    v_mfma_f32_16x16x32_bf16 v[40:43], a[168:171], a[72:75], v[40:43]
    ds_read_b128 a[216:219], v2 offset:8192
    v_mfma_f32_16x16x32_bf16 v[60:63], a[168:171], a[152:155], v[60:63]
    v_mov_b32 v110, 0
    v_mfma_f32_16x16x32_bf16 v[44:47], a[172:175], a[72:75], v[44:47]
    v_cvt_pk_bf16_f32 v105, v16, v106
    v_mfma_f32_16x16x32_bf16 v[64:67], a[172:175], a[152:155], v[64:67]
    v_cvt_pk_bf16_f32 v109, v20, v110
    v_mfma_f32_16x16x32_bf16 v[48:51], a[176:179], a[72:75], v[48:51]
    v_mov_b32 v107, 0
    v_mfma_f32_16x16x32_bf16 v[68:71], a[176:179], a[152:155], v[68:71]
    v_mov_b32 v111, 0
    s_waitcnt lgkmcnt(5)
    s_waitcnt vmcnt(3)
    v_mfma_f32_16x16x32_bf16 v[32:35], a[180:183], a[76:79], v[32:35]
    s_waitcnt vmcnt(2)
    v_mfma_f32_16x16x32_bf16 v[52:55], a[180:183], a[156:159], v[52:55]
    v_mfma_f32_16x16x32_bf16 v[36:39], a[184:187], a[76:79], v[36:39]
    v_mfma_f32_16x16x32_bf16 v[56:59], a[184:187], a[156:159], v[56:59]
    v_mfma_f32_16x16x32_bf16 v[40:43], a[188:191], a[76:79], v[40:43]
    v_mfma_f32_16x16x32_bf16 v[60:63], a[188:191], a[156:159], v[60:63]
    v_mfma_f32_16x16x32_bf16 v[44:47], a[192:195], a[76:79], v[44:47]
    v_mfma_f32_16x16x32_bf16 v[64:67], a[192:195], a[156:159], v[64:67]
    v_mfma_f32_16x16x32_bf16 v[48:51], a[196:199], a[76:79], v[48:51]
    v_mfma_f32_16x16x32_bf16 v[68:71], a[196:199], a[156:159], v[68:71]
    s_waitcnt lgkmcnt(0)
    v_mfma_f32_16x16x32_bf16 v[32:35], a[200:203], v[104:107], v[32:35]
    v_mfma_f32_16x16x32_bf16 v[52:55], a[200:203], v[108:111], v[52:55]
    v_mfma_f32_16x16x32_bf16 v[36:39], a[204:207], v[104:107], v[36:39]
    v_mfma_f32_16x16x32_bf16 v[56:59], a[204:207], v[108:111], v[56:59]
    v_mfma_f32_16x16x32_bf16 v[40:43], a[208:211], v[104:107], v[40:43]
    v_mfma_f32_16x16x32_bf16 v[60:63], a[208:211], v[108:111], v[60:63]
    v_mfma_f32_16x16x32_bf16 v[44:47], a[212:215], v[104:107], v[44:47]
    v_mfma_f32_16x16x32_bf16 v[64:67], a[212:215], v[108:111], v[64:67]
    v_mfma_f32_16x16x32_bf16 v[48:51], a[216:219], v[104:107], v[48:51]
    v_mfma_f32_16x16x32_bf16 v[68:71], a[216:219], v[108:111], v[68:71]
    s_nop 7
L_layer:
    s_barrier
    global_load_dwordx4 v[100:103], v2, s[68:69] sc1
    s_cselect_b32 s82, 1, 0
    s_add_u32 s79, s99, 4096
    s_add_u32 m0, s99, 4096
    s_add_u32 s80, s38, s79
    s_addc_u32 s81, s39, 0
    s_cmp_lg_u32 s82, 0
    global_load_lds_dwordx4 v2, s[80:81] offset:-4096
    global_load_lds_dwordx4 v2, s[80:81] offset:-3072
    v_mul_f32 v166, s48, v24
    v_mul_f32 v222, s48, v26
    v_cvt_pk_bf16_f32 v112, v32, v33
    v_cvt_pk_bf16_f32 v168, v52, v53
    v_cvt_pk_bf16_f32 v113, v34, v35
    v_cvt_pk_bf16_f32 v169, v54, v55
    v_cvt_pk_bf16_f32 v114, v36, v37
    v_cvt_pk_bf16_f32 v170, v56, v57
    v_cvt_pk_bf16_f32 v115, v38, v39
    v_cvt_pk_bf16_f32 v171, v58, v59
    v_cvt_pk_bf16_f32 v116, v48, v49
    v_cvt_pk_bf16_f32 v172, v68, v69
    v_mov_b32 v117, 0
    v_mov_b32 v173, 0
    v_mov_b32 v118, 0
    v_mov_b32 v174, 0
    v_mov_b32 v119, 0
    v_mov_b32 v175, 0
    v_mfma_f32_16x16x32_bf16 v[120:123], a[232:235], v[112:115], 0
    v_mfma_f32_16x16x32_bf16 v[176:179], a[232:235], v[168:171], 0
    v_mfma_f32_16x16x32_bf16 v[124:127], a[236:239], v[112:115], 0
    global_load_lds_dwordx4 v2, s[80:81] offset:-2048
    v_mfma_f32_16x16x32_bf16 v[180:183], a[236:239], v[168:171], 0
    v_mfma_f32_16x16x32_bf16 v[128:131], a[240:243], v[112:115], 0
    v_mfma_f32_16x16x32_bf16 v[184:187], a[240:243], v[168:171], 0
    v_mfma_f32_16x16x32_bf16 v[120:123], a[244:247], v[116:119], v[120:123]
    v_mfma_f32_16x16x32_bf16 v[176:179], a[244:247], v[172:175], v[176:179]
    v_mfma_f32_16x16x32_bf16 v[124:127], a[248:251], v[116:119], v[124:127]
    v_mfma_f32_16x16x32_bf16 v[180:183], a[248:251], v[172:175], v[180:183]
    v_mfma_f32_16x16x32_bf16 v[128:131], a[252:255], v[116:119], v[128:131]
    global_load_lds_dwordx4 v2, s[80:81] offset:-1024
    v_mfma_f32_16x16x32_bf16 v[184:187], a[252:255], v[172:175], v[184:187]
    s_nop 1
    v_max3_f32 v152, v120, v121, v122
    v_max3_f32 v208, v176, v177, v178
    v_max3_f32 v152, v152, v123, v124
    v_max3_f32 v208, v208, v179, v180
    v_max3_f32 v152, v152, v125, v126
    v_max3_f32 v208, v208, v181, v182
    v_max3_f32 v152, v152, v127, v128
    v_max3_f32 v208, v208, v183, v184
    v_max_f32 v152, v152, v129
    v_max_f32 v208, v208, v185
    v_min3_f32 v154, v120, v121, v122
    v_min3_f32 v210, v176, v177, v178
    v_min3_f32 v154, v154, v123, v124
    v_min3_f32 v210, v210, v179, v180
    v_min3_f32 v154, v154, v125, v126
    v_min3_f32 v210, v210, v181, v182
    v_min3_f32 v154, v154, v127, v128
    v_min3_f32 v210, v210, v183, v184
    v_min_f32 v154, v154, v129
    v_min_f32 v210, v210, v185
    v_mov_b32 v156, v152
    v_mov_b32 v212, v208
    v_mov_b32 v157, v154
    v_mov_b32 v213, v210
    v_permlane16_swap_b32 v152, v156
    v_permlane16_swap_b32 v208, v212
    global_load_lds_dwordx4 v2, s[80:81] offset:0
    v_permlane16_swap_b32 v154, v157
    v_permlane16_swap_b32 v210, v213
    v_max_f32 v152, v152, v156
    v_max_f32 v208, v208, v212
    v_min_f32 v154, v154, v157
    v_min_f32 v210, v210, v213
    v_mul_f32 v152, v166, v152
    v_mul_f32 v208, v222, v208
    v_mul_f32 v154, v166, v154
    v_mul_f32 v210, v222, v210
    v_pk_fma_f32 v[132:133], v[120:121], v[166:167], v[152:153] op_sel_hi:[1,0,0] neg_lo:[0,0,1] neg_hi:[0,0,1]
    v_pk_fma_f32 v[188:189], v[176:177], v[222:223], v[208:209] op_sel_hi:[1,0,0] neg_lo:[0,0,1] neg_hi:[0,0,1]
    v_pk_fma_f32 v[142:143], v[120:121], v[166:167], v[154:155] op_sel_hi:[1,0,0] neg_lo:[0,1,0] neg_hi:[0,1,0]
    v_pk_fma_f32 v[198:199], v[176:177], v[222:223], v[210:211] op_sel_hi:[1,0,0] neg_lo:[0,1,0] neg_hi:[0,1,0]
    v_pk_fma_f32 v[134:135], v[122:123], v[166:167], v[152:153] op_sel_hi:[1,0,0] neg_lo:[0,0,1] neg_hi:[0,0,1]
    v_pk_fma_f32 v[190:191], v[178:179], v[222:223], v[208:209] op_sel_hi:[1,0,0] neg_lo:[0,0,1] neg_hi:[0,0,1]
    v_pk_fma_f32 v[144:145], v[122:123], v[166:167], v[154:155] op_sel_hi:[1,0,0] neg_lo:[0,1,0] neg_hi:[0,1,0]
    v_pk_fma_f32 v[200:201], v[178:179], v[222:223], v[210:211] op_sel_hi:[1,0,0] neg_lo:[0,1,0] neg_hi:[0,1,0]
    v_pk_fma_f32 v[136:137], v[124:125], v[166:167], v[152:153] op_sel_hi:[1,0,0] neg_lo:[0,0,1] neg_hi:[0,0,1]
    v_pk_fma_f32 v[192:193], v[180:181], v[222:223], v[208:209] op_sel_hi:[1,0,0] neg_lo:[0,0,1] neg_hi:[0,0,1]
    v_pk_fma_f32 v[146:147], v[124:125], v[166:167], v[154:155] op_sel_hi:[1,0,0] neg_lo:[0,1,0] neg_hi:[0,1,0]
    v_pk_fma_f32 v[202:203], v[180:181], v[222:223], v[210:211] op_sel_hi:[1,0,0] neg_lo:[0,1,0] neg_hi:[0,1,0]
    v_pk_fma_f32 v[138:139], v[126:127], v[166:167], v[152:153] op_sel_hi:[1,0,0] neg_lo:[0,0,1] neg_hi:[0,0,1]
    v_pk_fma_f32 v[194:195], v[182:183], v[222:223], v[208:209] op_sel_hi:[1,0,0] neg_lo:[0,0,1] neg_hi:[0,0,1]
    v_pk_fma_f32 v[148:149], v[126:127], v[166:167], v[154:155] op_sel_hi:[1,0,0] neg_lo:[0,1,0] neg_hi:[0,1,0]
    v_pk_fma_f32 v[204:205], v[182:183], v[222:223], v[210:211] op_sel_hi:[1,0,0] neg_lo:[0,1,0] neg_hi:[0,1,0]
    v_pk_fma_f32 v[140:141], v[128:129], v[166:167], v[152:153] op_sel_hi:[1,0,0] neg_lo:[0,0,1] neg_hi:[0,0,1]
    v_pk_fma_f32 v[196:197], v[184:185], v[222:223], v[208:209] op_sel_hi:[1,0,0] neg_lo:[0,0,1] neg_hi:[0,0,1]
    v_pk_fma_f32 v[150:151], v[128:129], v[166:167], v[154:155] op_sel_hi:[1,0,0] neg_lo:[0,1,0] neg_hi:[0,1,0]
    v_pk_fma_f32 v[206:207], v[184:185], v[222:223], v[210:211] op_sel_hi:[1,0,0] neg_lo:[0,1,0] neg_hi:[0,1,0]
    v_exp_f32 v132, v132
    global_load_lds_dwordx4 v2, s[80:81] offset:1024
    v_exp_f32 v188, v188
    v_exp_f32 v142, v142
    v_exp_f32 v198, v198
    v_exp_f32 v133, v133
    v_exp_f32 v189, v189
    v_exp_f32 v143, v143
    v_exp_f32 v199, v199
    v_exp_f32 v134, v134
    v_exp_f32 v190, v190
    v_exp_f32 v144, v144
    v_exp_f32 v200, v200
    v_exp_f32 v135, v135
    v_exp_f32 v191, v191
    v_exp_f32 v145, v145
    v_exp_f32 v201, v201
    v_exp_f32 v136, v136
    global_load_lds_dwordx4 v2, s[80:81] offset:2048
    v_exp_f32 v192, v192
    v_exp_f32 v146, v146
    v_exp_f32 v202, v202
    v_exp_f32 v137, v137
    v_exp_f32 v193, v193
    v_exp_f32 v147, v147
    v_exp_f32 v203, v203
    v_exp_f32 v138, v138
    v_exp_f32 v194, v194
    v_exp_f32 v148, v148
    v_exp_f32 v204, v204
    v_exp_f32 v139, v139
    v_exp_f32 v195, v195
    v_exp_f32 v149, v149
    v_exp_f32 v205, v205
    v_exp_f32 v140, v140
    s_cselect_b32 s82, 1, 0
    s_add_u32 s79, s98, 32768
    s_add_u32 m0, s98, 32768
    s_add_u32 s80, s38, s79
    s_addc_u32 s81, s39, 0
    s_cmp_lg_u32 s82, 0
    global_load_lds_dwordx4 v2, s[80:81] offset:-4096
    v_exp_f32 v196, v196
    v_exp_f32 v150, v150
    v_exp_f32 v206, v206
    v_exp_f32 v141, v141
    v_exp_f32 v197, v197
    v_exp_f32 v151, v151
    v_exp_f32 v207, v207
    v_pk_add_f32 v[158:159], v[132:133], v[134:135]
    v_pk_add_f32 v[214:215], v[188:189], v[190:191]
    v_pk_add_f32 v[160:161], v[142:143], v[144:145]
    v_pk_add_f32 v[216:217], v[198:199], v[200:201]
    v_pk_add_f32 v[158:159], v[158:159], v[136:137]
    v_pk_add_f32 v[214:215], v[214:215], v[192:193]
    v_pk_add_f32 v[160:161], v[160:161], v[146:147]
    v_pk_add_f32 v[216:217], v[216:217], v[202:203]
    v_pk_add_f32 v[158:159], v[158:159], v[138:139]
    v_pk_add_f32 v[214:215], v[214:215], v[194:195]
    v_pk_add_f32 v[160:161], v[160:161], v[148:149]
    v_pk_add_f32 v[216:217], v[216:217], v[204:205]
    v_pk_add_f32 v[158:159], v[158:159], v[140:141]
    v_pk_add_f32 v[214:215], v[214:215], v[196:197]
    v_pk_add_f32 v[160:161], v[160:161], v[150:151]
    v_pk_add_f32 v[216:217], v[216:217], v[206:207]
    v_add_f32 v158, v158, v159
    v_add_f32 v214, v214, v215
    global_load_lds_dwordx4 v2, s[80:81] offset:-3072
    v_add_f32 v160, v160, v161
    v_add_f32 v216, v216, v217
    v_mov_b32 v156, v158
    v_mov_b32 v212, v214
    v_mov_b32 v157, v160
    v_mov_b32 v213, v216
    v_permlane16_swap_b32 v158, v156
    v_permlane16_swap_b32 v214, v212
    v_permlane16_swap_b32 v160, v157
    v_permlane16_swap_b32 v216, v213
    v_add_f32 v158, v158, v156
    v_add_f32 v214, v214, v212
    v_add_f32 v160, v160, v157
    v_add_f32 v216, v216, v213
    v_rcp_f32 v158, v158
    v_rcp_f32 v214, v214
    v_rcp_f32 v160, v160
    v_rcp_f32 v216, v216
    v_pk_mul_f32 v[132:133], v[132:133], v[158:159] op_sel_hi:[1,0]
    v_pk_mul_f32 v[188:189], v[188:189], v[214:215] op_sel_hi:[1,0]
    v_pk_mul_f32 v[142:143], v[142:143], v[160:161] op_sel_hi:[1,0]
    v_pk_mul_f32 v[198:199], v[198:199], v[216:217] op_sel_hi:[1,0]
    v_pk_mul_f32 v[134:135], v[134:135], v[158:159] op_sel_hi:[1,0]
    v_pk_mul_f32 v[190:191], v[190:191], v[214:215] op_sel_hi:[1,0]
    v_pk_mul_f32 v[144:145], v[144:145], v[160:161] op_sel_hi:[1,0]
    global_load_lds_dwordx4 v2, s[80:81] offset:-2048
    v_pk_mul_f32 v[200:201], v[200:201], v[216:217] op_sel_hi:[1,0]
    v_pk_mul_f32 v[136:137], v[136:137], v[158:159] op_sel_hi:[1,0]
    v_pk_mul_f32 v[192:193], v[192:193], v[214:215] op_sel_hi:[1,0]
    v_pk_mul_f32 v[146:147], v[146:147], v[160:161] op_sel_hi:[1,0]
    v_pk_mul_f32 v[202:203], v[202:203], v[216:217] op_sel_hi:[1,0]
    v_pk_mul_f32 v[138:139], v[138:139], v[158:159] op_sel_hi:[1,0]
    v_pk_mul_f32 v[194:195], v[194:195], v[214:215] op_sel_hi:[1,0]
    v_pk_mul_f32 v[148:149], v[148:149], v[160:161] op_sel_hi:[1,0]
    v_pk_mul_f32 v[204:205], v[204:205], v[216:217] op_sel_hi:[1,0]
    v_pk_mul_f32 v[140:141], v[140:141], v[158:159] op_sel_hi:[1,0]
    v_pk_mul_f32 v[196:197], v[196:197], v[214:215] op_sel_hi:[1,0]
    v_pk_mul_f32 v[150:151], v[150:151], v[160:161] op_sel_hi:[1,0]
    v_pk_mul_f32 v[206:207], v[206:207], v[216:217] op_sel_hi:[1,0]
    v_cvt_pk_bf16_f32 v158, v132, v133
    v_cvt_pk_bf16_f32 v214, v188, v189
    v_cvt_pk_bf16_f32 v159, v134, v135
    v_cvt_pk_bf16_f32 v215, v190, v191
    v_cvt_pk_bf16_f32 v160, v136, v137
    v_cvt_pk_bf16_f32 v216, v192, v193
    v_cvt_pk_bf16_f32 v161, v138, v139
    v_cvt_pk_bf16_f32 v217, v194, v195
    v_cvt_pk_bf16_f32 v162, v140, v141
    v_cvt_pk_bf16_f32 v218, v196, v197
    v_cvt_pk_bf16_f32 v163, v142, v143
    v_cvt_pk_bf16_f32 v219, v198, v199
    v_cvt_pk_bf16_f32 v164, v144, v145
    v_cvt_pk_bf16_f32 v220, v200, v201
    v_cvt_pk_bf16_f32 v165, v146, v147
    v_cvt_pk_bf16_f32 v221, v202, v203
    v_cvt_pk_bf16_f32 v166, v148, v149
    v_cvt_pk_bf16_f32 v222, v204, v205
    v_cvt_pk_bf16_f32 v167, v150, v151
    global_load_lds_dwordx4 v2, s[80:81] offset:-1024
    v_cvt_pk_bf16_f32 v223, v206, v207
    ds_write_b64 v224, v[158:159] offset:0
    ds_write_b64 v224, v[214:215] offset:1280
    ds_write_b64 v224, v[160:161] offset:8
    ds_write_b64 v224, v[216:217] offset:1288
    ds_write_b64 v224, v[162:163] offset:16
    ds_write_b64 v224, v[218:219] offset:1296
    ds_write_b64 v224, v[164:165] offset:24
    ds_write_b64 v224, v[220:221] offset:1304
    ds_write_b64 v224, v[166:167] offset:32
    ds_write_b64 v224, v[222:223] offset:1312
    v_pk_mul_f32 v[40:41], v[40:41], v[24:25] op_sel_hi:[1,0]
    v_pk_mul_f32 v[60:61], v[60:61], v[26:27] op_sel_hi:[1,0]
    v_pk_mul_f32 v[42:43], v[42:43], v[24:25] op_sel_hi:[1,0]
    v_pk_mul_f32 v[62:63], v[62:63], v[26:27] op_sel_hi:[1,0]
    v_pk_mul_f32 v[44:45], v[44:45], v[24:25] op_sel_hi:[1,0]
    v_pk_mul_f32 v[64:65], v[64:65], v[26:27] op_sel_hi:[1,0]
    v_pk_mul_f32 v[46:47], v[46:47], v[24:25] op_sel_hi:[1,0]
    v_pk_mul_f32 v[66:67], v[66:67], v[26:27] op_sel_hi:[1,0]
    v_pk_mul_f32 v[50:51], v[50:51], v[24:25] op_sel_hi:[1,0]
    v_pk_mul_f32 v[70:71], v[70:71], v[26:27] op_sel_hi:[1,0]
    v_cvt_pk_bf16_f32 v112, v40, v41
    v_cvt_pk_bf16_f32 v168, v60, v61
    v_cvt_pk_bf16_f32 v113, v42, v43
    v_cvt_pk_bf16_f32 v169, v62, v63
    v_cvt_pk_bf16_f32 v114, v44, v45
    v_cvt_pk_bf16_f32 v170, v64, v65
    v_cvt_pk_bf16_f32 v115, v46, v47
    v_cvt_pk_bf16_f32 v171, v66, v67
    v_mov_b32 v117, 1.0
    v_mov_b32 v173, 1.0
    v_cvt_pk_bf16_f32 v116, v50, v117
    v_cvt_pk_bf16_f32 v172, v70, v173
    global_load_lds_dwordx4 v2, s[80:81] offset:0
    v_cvt_pk_bf16_f32 v118, v51, v117
    v_cvt_pk_bf16_f32 v174, v71, v173
    v_mov_b32 v117, 0
    v_mov_b32 v173, 0
    v_mov_b32 v119, 0
    v_mov_b32 v175, 0
    ds_write_b128 v225, v[112:115] offset:0
    ds_write_b128 v225, v[168:171] offset:1024
    ds_write_b128 v225, v[116:119] offset:32
    ds_write_b128 v225, v[172:175] offset:1056
    s_waitcnt vmcnt(12)
    v_min_u32 v100, v100, v101
    v_min_u32 v102, v102, v103
    v_min_u32 v100, v100, v102
    v_cmp_eq_u32 vcc, 0, v100
    s_nop 4
    s_cbranch_vccz L_pb_ok_43
    s_mov_b32 s3, 0
L_pb_poll_42:
    global_load_dwordx4 v[100:103], v2, s[68:69] sc1
    s_waitcnt vmcnt(0)
    v_min_u32 v100, v100, v101
    v_min_u32 v102, v102, v103
    v_min_u32 v100, v100, v102
    v_cmp_eq_u32 vcc, 0, v100
    s_add_u32 s3, s3, 1
    s_cmp_gt_u32 s3, 4000000
    s_nop 2
    s_cbranch_scc1 L_pb_ok_43
    s_cbranch_vccnz L_pb_poll_42
L_pb_ok_43:
    s_waitcnt lgkmcnt(0)
    s_barrier
    ds_read_b64_tr_b16 v[160:161], v227 offset:0
    ds_read_b64_tr_b16 v[162:163], v227 offset:256
    ds_read_b64_tr_b16 v[112:113], v226 offset:0
    ds_read_b64_tr_b16 v[114:115], v226 offset:320
    ds_read_b64_tr_b16 v[116:117], v226 offset:32
    ds_read_b64_tr_b16 v[118:119], v226 offset:352
    ds_read_b64_tr_b16 v[120:121], v226 offset:64
    ds_read_b64_tr_b16 v[122:123], v226 offset:384
    ds_read_b64_tr_b16 v[164:165], v227 offset:2048
    ds_read_b64_tr_b16 v[166:167], v227 offset:2304
    s_cselect_b32 s82, 1, 0
    s_add_u32 s79, s98, 32768
    s_add_u32 m0, s98, 32768
    s_add_u32 s80, s38, s79
    s_addc_u32 s81, s39, 0
    s_cmp_lg_u32 s82, 0
    global_load_lds_dwordx4 v2, s[80:81] offset:1024
    ds_read_b64_tr_b16 v[124:125], v226 offset:2560
    ds_read_b64_tr_b16 v[126:127], v226 offset:2880
    ds_read_b64_tr_b16 v[128:129], v226 offset:2592
    ds_read_b64_tr_b16 v[130:131], v226 offset:2912
    ds_read_b64_tr_b16 v[132:133], v226 offset:2624
    ds_read_b64_tr_b16 v[134:135], v226 offset:2944
    ds_read_b64_tr_b16 v[168:169], v227 offset:4096
    ds_read_b64_tr_b16 v[170:171], v227 offset:4352
    ds_read_b64_tr_b16 v[136:137], v226 offset:5120
    ds_read_b64_tr_b16 v[138:139], v226 offset:5440
    ds_read_b64_tr_b16 v[140:141], v226 offset:5152
    ds_read_b64_tr_b16 v[142:143], v226 offset:5472
    ds_read_b64_tr_b16 v[144:145], v226 offset:5184
    ds_read_b64_tr_b16 v[146:147], v226 offset:5504
    ds_read_b64_tr_b16 v[172:173], v227 offset:6144
    ds_read_b64_tr_b16 v[174:175], v227 offset:6400
    ds_read_b64_tr_b16 v[148:149], v226 offset:7680
    ds_read_b64_tr_b16 v[150:151], v226 offset:8000
    ds_read_b64_tr_b16 v[152:153], v226 offset:7712
    ds_read_b64_tr_b16 v[154:155], v226 offset:8032
    ds_read_b64_tr_b16 v[156:157], v226 offset:7744
    ds_read_b64_tr_b16 v[158:159], v226 offset:8064
    s_waitcnt lgkmcnt(15)
    v_mfma_f32_16x16x32_bf16 v[176:179], v[112:115], v[160:163], 0
    v_mfma_f32_16x16x32_bf16 v[180:183], v[116:119], v[160:163], 0
    v_mfma_f32_16x16x32_bf16 v[184:187], v[120:123], v[160:163], 0
    s_cselect_b32 s82, 1, 0
    s_add_u32 s79, s100, 57344
    s_add_u32 m0, s100, 57344
    s_add_u32 s80, s38, s79
    s_addc_u32 s81, s39, 0
    s_cmp_lg_u32 s82, 0
    global_load_lds_dwordx4 v2, s[80:81] offset:-4096
    v_mfma_f32_16x16x32_bf16 v[176:179], v[124:127], v[164:167], v[176:179]
    v_mfma_f32_16x16x32_bf16 v[180:183], v[128:131], v[164:167], v[180:183]
    v_mfma_f32_16x16x32_bf16 v[184:187], v[132:135], v[164:167], v[184:187]
    s_waitcnt lgkmcnt(12)
    v_mfma_f32_16x16x32_bf16 v[176:179], v[136:139], v[168:171], v[176:179]
    s_waitcnt lgkmcnt(10)
    v_mfma_f32_16x16x32_bf16 v[180:183], v[140:143], v[168:171], v[180:183]
    s_waitcnt lgkmcnt(8)
    v_mfma_f32_16x16x32_bf16 v[184:187], v[144:147], v[168:171], v[184:187]
    s_waitcnt lgkmcnt(4)
    v_mfma_f32_16x16x32_bf16 v[176:179], v[148:151], v[172:175], v[176:179]
    s_waitcnt lgkmcnt(2)
    v_mfma_f32_16x16x32_bf16 v[180:183], v[152:155], v[172:175], v[180:183]
    global_load_lds_dwordx4 v2, s[80:81] offset:-3072
    s_waitcnt lgkmcnt(0)
    v_mfma_f32_16x16x32_bf16 v[184:187], v[156:159], v[172:175], v[184:187]
    s_nop 2
    v_cvt_pk_bf16_f32 v188, v176, v177
    v_cvt_pk_bf16_f32 v189, v178, v179
    v_cvt_pk_bf16_f32 v190, v180, v181
    v_cvt_pk_bf16_f32 v191, v182, v183
    s_nop 0
    v_cvt_pk_bf16_f32 v192, v184, v185
    v_cvt_pk_bf16_f32 v193, v186, v187
    s_mov_b64 exec, s[52:53]
    global_store_dwordx4 v228, v[188:191], s[62:63] sc1
    s_mov_b64 exec, s[54:55]
    global_store_dwordx2 v229, v[192:193], s[62:63] sc1
    s_mov_b64 exec, -1
    v_mov_b32 v11, s66
    v_mov_b32 v12, 1
    s_add_u32 s90, s22, s67
    s_addc_u32 s91, s23, 0
    s_waitcnt vmcnt(10)
    s_barrier
    ds_read_b128 a[160:163], v2 offset:0
    ds_read_b128 a[164:167], v2 offset:1024
    ds_read_b128 a[168:171], v2 offset:2048
    ds_read_b128 a[172:175], v2 offset:3072
    ds_read_b128 a[176:179], v2 offset:4096
    ds_read_b128 a[180:183], v2 offset:5120
    s_waitcnt lgkmcnt(3)
    v_mfma_f32_16x16x32_bf16 v[80:83], a[160:163], a[0:3], 0
    ds_read_b128 a[184:187], v2 offset:6144
    v_mfma_f32_16x16x32_bf16 v[92:95], a[160:163], a[80:83], 0
    global_load_lds_dwordx4 v2, s[80:81] offset:-2048
    ds_read_b128 a[188:191], v2 offset:7168
    v_mfma_f32_16x16x32_bf16 v[84:87], a[164:167], a[0:3], 0
    ds_read_b128 a[192:195], v2 offset:8192
    v_mfma_f32_16x16x32_bf16 v[96:99], a[164:167], a[80:83], 0
    v_mfma_f32_16x16x32_bf16 v[88:91], a[168:171], a[0:3], 0
    v_mfma_f32_16x16x32_bf16 v[100:103], a[168:171], a[80:83], 0
    s_waitcnt lgkmcnt(3)
    v_mfma_f32_16x16x32_bf16 v[80:83], a[172:175], a[4:7], v[80:83]
    ds_read_b128 a[160:163], v2 offset:9216
    v_mfma_f32_16x16x32_bf16 v[92:95], a[172:175], a[84:87], v[92:95]
    ds_read_b128 a[164:167], v2 offset:10240
    v_mfma_f32_16x16x32_bf16 v[84:87], a[176:179], a[4:7], v[84:87]
    s_add_u32 s79, s98, 4096
    s_add_u32 m0, s98, 69632
    s_add_u32 s80, s40, s79
    s_addc_u32 s81, s41, 0
    global_load_lds_dwordx4 v2, s[80:81] offset:-4096
    ds_read_b128 a[168:171], v2 offset:11264
    v_mfma_f32_16x16x32_bf16 v[96:99], a[176:179], a[84:87], v[96:99]
    v_mfma_f32_16x16x32_bf16 v[88:91], a[180:183], a[4:7], v[88:91]
    v_mfma_f32_16x16x32_bf16 v[100:103], a[180:183], a[84:87], v[100:103]
    s_waitcnt lgkmcnt(3)
    v_mfma_f32_16x16x32_bf16 v[80:83], a[184:187], a[8:11], v[80:83]
    global_load_lds_dwordx4 v2, s[80:81] offset:-3072
    ds_read_b128 a[172:175], v2 offset:12288
    v_mfma_f32_16x16x32_bf16 v[92:95], a[184:187], a[88:91], v[92:95]
    ds_read_b128 a[176:179], v2 offset:13312
    v_mfma_f32_16x16x32_bf16 v[84:87], a[188:191], a[8:11], v[84:87]
    ds_read_b128 a[180:183], v2 offset:14336
    v_mfma_f32_16x16x32_bf16 v[96:99], a[188:191], a[88:91], v[96:99]
    v_mfma_f32_16x16x32_bf16 v[88:91], a[192:195], a[8:11], v[88:91]
    global_load_lds_dwordx4 v2, s[80:81] offset:-2048
    v_mfma_f32_16x16x32_bf16 v[100:103], a[192:195], a[88:91], v[100:103]
    s_waitcnt lgkmcnt(3)
    v_mfma_f32_16x16x32_bf16 v[80:83], a[160:163], a[12:15], v[80:83]
    ds_read_b128 a[184:187], v2 offset:15360
    v_mfma_f32_16x16x32_bf16 v[92:95], a[160:163], a[92:95], v[92:95]
    ds_read_b128 a[188:191], v2 offset:16384
    v_mfma_f32_16x16x32_bf16 v[84:87], a[164:167], a[12:15], v[84:87]
    global_load_lds_dwordx4 v2, s[80:81] offset:-1024
    ds_read_b128 a[192:195], v2 offset:17408
    v_mfma_f32_16x16x32_bf16 v[96:99], a[164:167], a[92:95], v[96:99]
    v_mfma_f32_16x16x32_bf16 v[88:91], a[168:171], a[12:15], v[88:91]
    v_mfma_f32_16x16x32_bf16 v[100:103], a[168:171], a[92:95], v[100:103]
    s_waitcnt lgkmcnt(3)
    v_mfma_f32_16x16x32_bf16 v[80:83], a[172:175], a[16:19], v[80:83]
    global_load_lds_dwordx4 v2, s[80:81] offset:0
    ds_read_b128 a[160:163], v2 offset:18432
    v_mfma_f32_16x16x32_bf16 v[92:95], a[172:175], a[96:99], v[92:95]
    ds_read_b128 a[164:167], v2 offset:19456
    v_mfma_f32_16x16x32_bf16 v[84:87], a[176:179], a[16:19], v[84:87]
    ds_read_b128 a[168:171], v2 offset:20480
    v_mfma_f32_16x16x32_bf16 v[96:99], a[176:179], a[96:99], v[96:99]
    global_load_lds_dwordx4 v2, s[80:81] offset:1024
    v_mfma_f32_16x16x32_bf16 v[88:91], a[180:183], a[16:19], v[88:91]
    v_mfma_f32_16x16x32_bf16 v[100:103], a[180:183], a[96:99], v[100:103]
    s_waitcnt lgkmcnt(3)
    v_mfma_f32_16x16x32_bf16 v[80:83], a[184:187], a[20:23], v[80:83]
    ds_read_b128 a[172:175], v2 offset:21504
    v_mfma_f32_16x16x32_bf16 v[92:95], a[184:187], a[100:103], v[92:95]
    s_add_u32 s79, s98, 28672
    s_add_u32 m0, s98, 94208
    s_add_u32 s80, s40, s79
    s_addc_u32 s81, s41, 0
    global_load_lds_dwordx4 v2, s[80:81] offset:-4096
    ds_read_b128 a[176:179], v2 offset:22528
    v_mfma_f32_16x16x32_bf16 v[84:87], a[188:191], a[20:23], v[84:87]
    ds_read_b128 a[180:183], v2 offset:23552
    v_mfma_f32_16x16x32_bf16 v[96:99], a[188:191], a[100:103], v[96:99]
    v_mfma_f32_16x16x32_bf16 v[88:91], a[192:195], a[20:23], v[88:91]
    v_mfma_f32_16x16x32_bf16 v[100:103], a[192:195], a[100:103], v[100:103]
    s_waitcnt vmcnt(12)
    s_barrier
    s_waitcnt vmcnt(8)
    s_barrier
    s_cmp_eq_u32 s24, 0
    s_cselect_b64 exec, 1, 0
    global_store_dword v11, v12, s[22:23] sc1
    s_mov_b64 exec, -1
    s_waitcnt lgkmcnt(3)
    global_load_lds_dwordx4 v2, s[80:81] offset:-3072
    v_mfma_f32_16x16x32_bf16 v[80:83], a[160:163], a[24:27], v[80:83]
    ds_read_b128 a[184:187], v2 offset:24576
    v_mfma_f32_16x16x32_bf16 v[92:95], a[160:163], a[104:107], v[92:95]
    ds_read_b128 a[188:191], v2 offset:25600
    v_mfma_f32_16x16x32_bf16 v[84:87], a[164:167], a[24:27], v[84:87]
    global_load_lds_dwordx4 v2, s[80:81] offset:-2048
    ds_read_b128 a[192:195], v2 offset:26624
    v_mfma_f32_16x16x32_bf16 v[96:99], a[164:167], a[104:107], v[96:99]
    v_mfma_f32_16x16x32_bf16 v[88:91], a[168:171], a[24:27], v[88:91]
    v_mfma_f32_16x16x32_bf16 v[100:103], a[168:171], a[104:107], v[100:103]
    s_waitcnt lgkmcnt(3)
    v_mfma_f32_16x16x32_bf16 v[80:83], a[172:175], a[28:31], v[80:83]
    global_load_lds_dwordx4 v2, s[80:81] offset:-1024
    ds_read_b128 a[160:163], v2 offset:27648
    v_mfma_f32_16x16x32_bf16 v[92:95], a[172:175], a[108:111], v[92:95]
    ds_read_b128 a[164:167], v2 offset:28672
    v_mfma_f32_16x16x32_bf16 v[84:87], a[176:179], a[28:31], v[84:87]
    ds_read_b128 a[168:171], v2 offset:29696
    v_mfma_f32_16x16x32_bf16 v[96:99], a[176:179], a[108:111], v[96:99]
    v_mfma_f32_16x16x32_bf16 v[88:91], a[180:183], a[28:31], v[88:91]
    global_load_lds_dwordx4 v2, s[80:81] offset:0
    v_mfma_f32_16x16x32_bf16 v[100:103], a[180:183], a[108:111], v[100:103]
    s_waitcnt lgkmcnt(3)
    v_mfma_f32_16x16x32_bf16 v[80:83], a[184:187], a[32:35], v[80:83]
    ds_read_b128 a[172:175], v2 offset:30720
    v_mfma_f32_16x16x32_bf16 v[92:95], a[184:187], a[112:115], v[92:95]
    ds_read_b128 a[176:179], v2 offset:31744
    v_mfma_f32_16x16x32_bf16 v[84:87], a[188:191], a[32:35], v[84:87]
    global_load_lds_dwordx4 v2, s[80:81] offset:1024
    ds_read_b128 a[180:183], v2 offset:32768
    v_mfma_f32_16x16x32_bf16 v[96:99], a[188:191], a[112:115], v[96:99]
    v_mfma_f32_16x16x32_bf16 v[88:91], a[192:195], a[32:35], v[88:91]
    v_mfma_f32_16x16x32_bf16 v[100:103], a[192:195], a[112:115], v[100:103]
    s_waitcnt lgkmcnt(3)
    v_mfma_f32_16x16x32_bf16 v[80:83], a[160:163], a[36:39], v[80:83]
    s_add_u32 s79, s101, 4096
    s_add_u32 m0, s101, 159744
    s_add_u32 s80, s42, s79
    s_addc_u32 s81, s43, 0
    global_load_lds_dwordx4 v2, s[80:81] offset:-4096
    ds_read_b128 a[184:187], v2 offset:33792
    v_mfma_f32_16x16x32_bf16 v[92:95], a[160:163], a[116:119], v[92:95]
    ds_read_b128 a[188:191], v2 offset:34816
    v_mfma_f32_16x16x32_bf16 v[84:87], a[164:167], a[36:39], v[84:87]
    ds_read_b128 a[192:195], v2 offset:35840
    v_mfma_f32_16x16x32_bf16 v[96:99], a[164:167], a[116:119], v[96:99]
    v_mfma_f32_16x16x32_bf16 v[88:91], a[168:171], a[36:39], v[88:91]
    v_mfma_f32_16x16x32_bf16 v[100:103], a[168:171], a[116:119], v[100:103]
    s_waitcnt lgkmcnt(3)
    v_mfma_f32_16x16x32_bf16 v[80:83], a[172:175], a[40:43], v[80:83]
    ds_read_b128 a[160:163], v2 offset:36864
    v_mfma_f32_16x16x32_bf16 v[92:95], a[172:175], a[120:123], v[92:95]
    global_load_lds_dwordx4 v2, s[80:81] offset:-3072
    ds_read_b128 a[164:167], v2 offset:37888
    v_mfma_f32_16x16x32_bf16 v[84:87], a[176:179], a[40:43], v[84:87]
    ds_read_b128 a[168:171], v2 offset:38912
    v_mfma_f32_16x16x32_bf16 v[96:99], a[176:179], a[120:123], v[96:99]
    v_mfma_f32_16x16x32_bf16 v[88:91], a[180:183], a[40:43], v[88:91]
    v_mfma_f32_16x16x32_bf16 v[100:103], a[180:183], a[120:123], v[100:103]
    s_waitcnt lgkmcnt(3)
    v_mfma_f32_16x16x32_bf16 v[80:83], a[184:187], a[44:47], v[80:83]
    ds_read_b128 a[172:175], v2 offset:39936
    v_mfma_f32_16x16x32_bf16 v[92:95], a[184:187], a[124:127], v[92:95]
    ds_read_b128 a[176:179], v2 offset:40960
    v_mfma_f32_16x16x32_bf16 v[84:87], a[188:191], a[44:47], v[84:87]
    s_add_u32 s79, s83, 12288
    s_add_u32 m0, s83, 118784
    s_add_u32 s80, s42, s79
    s_addc_u32 s81, s43, 0
    global_load_lds_dwordx4 v2, s[80:81] offset:-4096
    ds_read_b128 a[180:183], v2 offset:41984
    v_mfma_f32_16x16x32_bf16 v[96:99], a[188:191], a[124:127], v[96:99]
    v_mfma_f32_16x16x32_bf16 v[88:91], a[192:195], a[44:47], v[88:91]
    v_mfma_f32_16x16x32_bf16 v[100:103], a[192:195], a[124:127], v[100:103]
    s_waitcnt lgkmcnt(3)
    v_mfma_f32_16x16x32_bf16 v[80:83], a[160:163], a[48:51], v[80:83]
    ds_read_b128 a[184:187], v2 offset:43008
    v_mfma_f32_16x16x32_bf16 v[92:95], a[160:163], a[128:131], v[92:95]
    ds_read_b128 a[188:191], v2 offset:44032
    v_mfma_f32_16x16x32_bf16 v[84:87], a[164:167], a[48:51], v[84:87]
    ds_read_b128 a[192:195], v2 offset:45056
    v_mfma_f32_16x16x32_bf16 v[96:99], a[164:167], a[128:131], v[96:99]
    global_load_lds_dwordx4 v2, s[80:81] offset:-3072
    v_mfma_f32_16x16x32_bf16 v[88:91], a[168:171], a[48:51], v[88:91]
    v_mfma_f32_16x16x32_bf16 v[100:103], a[168:171], a[128:131], v[100:103]
    s_waitcnt lgkmcnt(3)
    v_mfma_f32_16x16x32_bf16 v[80:83], a[172:175], a[52:55], v[80:83]
    ds_read_b128 a[160:163], v2 offset:46080
    v_mfma_f32_16x16x32_bf16 v[92:95], a[172:175], a[132:135], v[92:95]
    ds_read_b128 a[164:167], v2 offset:47104
    v_mfma_f32_16x16x32_bf16 v[84:87], a[176:179], a[52:55], v[84:87]
    ds_read_b128 a[168:171], v2 offset:48128
    v_mfma_f32_16x16x32_bf16 v[96:99], a[176:179], a[132:135], v[96:99]
    v_mfma_f32_16x16x32_bf16 v[88:91], a[180:183], a[52:55], v[88:91]
    v_mfma_f32_16x16x32_bf16 v[100:103], a[180:183], a[132:135], v[100:103]
    s_waitcnt lgkmcnt(3)
    global_load_lds_dwordx4 v2, s[80:81] offset:-2048
    v_mfma_f32_16x16x32_bf16 v[80:83], a[184:187], a[56:59], v[80:83]
    ds_read_b128 a[172:175], v2 offset:49152
    v_mfma_f32_16x16x32_bf16 v[92:95], a[184:187], a[136:139], v[92:95]
    ds_read_b128 a[176:179], v2 offset:50176
    v_mfma_f32_16x16x32_bf16 v[84:87], a[188:191], a[56:59], v[84:87]
    ds_read_b128 a[180:183], v2 offset:51200
    v_mfma_f32_16x16x32_bf16 v[96:99], a[188:191], a[136:139], v[96:99]
    v_mfma_f32_16x16x32_bf16 v[88:91], a[192:195], a[56:59], v[88:91]
    v_mfma_f32_16x16x32_bf16 v[100:103], a[192:195], a[136:139], v[100:103]
    s_waitcnt vmcnt(18)
    s_waitcnt lgkmcnt(0)
    s_barrier
    v_mfma_f32_16x16x32_bf16 v[80:83], a[160:163], a[60:63], v[80:83]
    global_load_lds_dwordx4 v2, s[80:81] offset:-1024
    ds_read_b128 a[184:187], v2 offset:52224
    v_mfma_f32_16x16x32_bf16 v[92:95], a[160:163], a[140:143], v[92:95]
    ds_read_b128 a[188:191], v2 offset:53248
    v_mfma_f32_16x16x32_bf16 v[84:87], a[164:167], a[60:63], v[84:87]
    ds_read_b128 a[192:195], v2 offset:54272
    v_mfma_f32_16x16x32_bf16 v[96:99], a[164:167], a[140:143], v[96:99]
    v_mfma_f32_16x16x32_bf16 v[88:91], a[168:171], a[60:63], v[88:91]
    v_mfma_f32_16x16x32_bf16 v[100:103], a[168:171], a[140:143], v[100:103]
    v_mfma_f32_16x16x32_bf16 v[80:83], a[172:175], a[64:67], v[80:83]
    ds_read_b128 a[160:163], v2 offset:55296
    v_mfma_f32_16x16x32_bf16 v[92:95], a[172:175], a[144:147], v[92:95]
    s_add_u32 s79, s99, 53248
    s_add_u32 m0, s99, 4096
    s_add_u32 s80, s40, s79
    s_addc_u32 s81, s41, 0
    global_load_lds_dwordx4 v2, s[80:81] offset:-4096
    ds_read_b128 a[164:167], v2 offset:56320
    v_mfma_f32_16x16x32_bf16 v[84:87], a[176:179], a[64:67], v[84:87]
    ds_read_b128 a[168:171], v2 offset:57344
    v_mfma_f32_16x16x32_bf16 v[96:99], a[176:179], a[144:147], v[96:99]
    v_mfma_f32_16x16x32_bf16 v[88:91], a[180:183], a[64:67], v[88:91]
    v_mfma_f32_16x16x32_bf16 v[100:103], a[180:183], a[144:147], v[100:103]
    s_waitcnt lgkmcnt(3)
    global_load_lds_dwordx4 v2, s[80:81] offset:-3072
    v_mfma_f32_16x16x32_bf16 v[80:83], a[184:187], a[68:71], v[80:83]
    ds_read_b128 a[172:175], v2 offset:58368
    v_mfma_f32_16x16x32_bf16 v[92:95], a[184:187], a[148:151], v[92:95]
    ds_read_b128 a[176:179], v2 offset:59392
    v_mfma_f32_16x16x32_bf16 v[84:87], a[188:191], a[68:71], v[84:87]
    ds_read_b128 a[180:183], v2 offset:60416
    v_mfma_f32_16x16x32_bf16 v[96:99], a[188:191], a[148:151], v[96:99]
    global_load_lds_dwordx4 v2, s[80:81] offset:-2048
    v_mfma_f32_16x16x32_bf16 v[88:91], a[192:195], a[68:71], v[88:91]
    v_mfma_f32_16x16x32_bf16 v[100:103], a[192:195], a[148:151], v[100:103]
    s_waitcnt lgkmcnt(3)
    v_mfma_f32_16x16x32_bf16 v[80:83], a[160:163], a[72:75], v[80:83]
    ds_read_b128 a[184:187], v2 offset:61440
    v_mfma_f32_16x16x32_bf16 v[92:95], a[160:163], a[152:155], v[92:95]
    global_load_lds_dwordx4 v2, s[80:81] offset:-1024
    ds_read_b128 a[188:191], v2 offset:62464
    v_mfma_f32_16x16x32_bf16 v[84:87], a[164:167], a[72:75], v[84:87]
    ds_read_b128 a[192:195], v2 offset:63488
    v_mfma_f32_16x16x32_bf16 v[96:99], a[164:167], a[152:155], v[96:99]
    global_load_dword v13, v14, s[90:91] sc1
    v_mfma_f32_16x16x32_bf16 v[88:91], a[168:171], a[72:75], v[88:91]
    global_load_lds_dwordx4 v2, s[80:81] offset:0
    v_mfma_f32_16x16x32_bf16 v[100:103], a[168:171], a[152:155], v[100:103]
    s_waitcnt lgkmcnt(3)
    v_mfma_f32_16x16x32_bf16 v[80:83], a[172:175], a[76:79], v[80:83]
    v_mfma_f32_16x16x32_bf16 v[92:95], a[172:175], a[156:159], v[92:95]
    v_mfma_f32_16x16x32_bf16 v[84:87], a[176:179], a[76:79], v[84:87]
    v_mfma_f32_16x16x32_bf16 v[96:99], a[176:179], a[156:159], v[96:99]
    global_load_lds_dwordx4 v2, s[80:81] offset:1024
    v_mfma_f32_16x16x32_bf16 v[88:91], a[180:183], a[76:79], v[88:91]
    v_mfma_f32_16x16x32_bf16 v[100:103], a[180:183], a[156:159], v[100:103]
    s_waitcnt lgkmcnt(0)
    v_mfma_f32_16x16x32_bf16 v[80:83], a[184:187], v[104:107], v[80:83]
    v_mfma_f32_16x16x32_bf16 v[92:95], a[184:187], v[108:111], v[92:95]
    global_load_lds_dwordx4 v2, s[80:81] offset:2048
    v_mfma_f32_16x16x32_bf16 v[84:87], a[188:191], v[104:107], v[84:87]
    v_mfma_f32_16x16x32_bf16 v[96:99], a[188:191], v[108:111], v[96:99]
    v_mfma_f32_16x16x32_bf16 v[88:91], a[192:195], v[104:107], v[88:91]
    v_mfma_f32_16x16x32_bf16 v[100:103], a[192:195], v[108:111], v[100:103]
    s_barrier
    s_waitcnt vmcnt(3)
    v_cmp_eq_u32 vcc, 0, v13
    s_nop 4
    s_cbranch_vccz L_pl_ok_44
    s_mov_b32 s3, 0
L_pl_top_45:
    global_load_dword v13, v14, s[90:91] sc1
    s_waitcnt vmcnt(0)
    v_cmp_eq_u32 vcc, 0, v13
    s_add_u32 s3, s3, 1
    s_cmp_gt_u32 s3, 4000000
    s_nop 2
    s_cbranch_scc1 L_pl_ok_44
    s_cbranch_vccnz L_pl_top_45
L_pl_ok_44:
    global_load_dwordx4 a[0:3], v230, s[60:61] offset:0 sc1
    global_load_dwordx4 a[16:19], v230, s[60:61] offset:1024 sc1
    global_load_dwordx4 a[32:35], v230, s[60:61] offset:2048 sc1
    global_load_dwordx4 a[48:51], v230, s[60:61] offset:3072 sc1
    global_load_dwordx4 a[4:7], v231, s[60:61] offset:0 sc1
    v_mul_f32 v166, s48, v24
    v_mul_f32 v222, s48, v26
    v_cvt_pk_bf16_f32 v112, v80, v81
    v_cvt_pk_bf16_f32 v168, v92, v93
    v_cvt_pk_bf16_f32 v113, v82, v83
    v_cvt_pk_bf16_f32 v169, v94, v95
    v_cvt_pk_bf16_f32 v114, v84, v85
    v_cvt_pk_bf16_f32 v170, v96, v97
    v_cvt_pk_bf16_f32 v115, v86, v87
    v_cvt_pk_bf16_f32 v171, v98, v99
    v_cvt_pk_bf16_f32 v116, v88, v89
    v_cvt_pk_bf16_f32 v172, v100, v101
    v_mov_b32 v117, 0
    v_mov_b32 v173, 0
    v_mov_b32 v118, 0
    v_mov_b32 v174, 0
    v_mov_b32 v119, 0
    v_mov_b32 v175, 0
    v_mfma_f32_16x16x32_bf16 v[120:123], a[232:235], v[112:115], 0
    v_mfma_f32_16x16x32_bf16 v[176:179], a[232:235], v[168:171], 0
    global_load_dwordx4 a[20:23], v231, s[60:61] offset:1024 sc1
    v_mfma_f32_16x16x32_bf16 v[124:127], a[236:239], v[112:115], 0
    v_mfma_f32_16x16x32_bf16 v[180:183], a[236:239], v[168:171], 0
    v_mfma_f32_16x16x32_bf16 v[128:131], a[240:243], v[112:115], 0
    v_mfma_f32_16x16x32_bf16 v[184:187], a[240:243], v[168:171], 0
    v_mfma_f32_16x16x32_bf16 v[120:123], a[244:247], v[116:119], v[120:123]
    global_load_dwordx4 a[36:39], v231, s[60:61] offset:2048 sc1
    v_mfma_f32_16x16x32_bf16 v[176:179], a[244:247], v[172:175], v[176:179]
    v_mfma_f32_16x16x32_bf16 v[124:127], a[248:251], v[116:119], v[124:127]
    v_mfma_f32_16x16x32_bf16 v[180:183], a[248:251], v[172:175], v[180:183]
    v_mfma_f32_16x16x32_bf16 v[128:131], a[252:255], v[116:119], v[128:131]
    v_mfma_f32_16x16x32_bf16 v[184:187], a[252:255], v[172:175], v[184:187]
    s_nop 1
    v_max3_f32 v152, v120, v121, v122
    s_nop 0
    v_max3_f32 v208, v176, v177, v178
    global_load_dwordx4 a[52:55], v231, s[60:61] offset:3072 sc1
    v_max3_f32 v152, v152, v123, v124
    v_max3_f32 v208, v208, v179, v180
    v_max3_f32 v152, v152, v125, v126
    v_max3_f32 v208, v208, v181, v182
    v_max3_f32 v152, v152, v127, v128
    v_max3_f32 v208, v208, v183, v184
    v_max_f32 v152, v152, v129
    v_max_f32 v208, v208, v185
    v_min3_f32 v154, v120, v121, v122
    v_min3_f32 v210, v176, v177, v178
    v_min3_f32 v154, v154, v123, v124
    v_min3_f32 v210, v210, v179, v180
    v_min3_f32 v154, v154, v125, v126
    v_min3_f32 v210, v210, v181, v182
    v_min3_f32 v154, v154, v127, v128
    v_min3_f32 v210, v210, v183, v184
    v_min_f32 v154, v154, v129
    v_min_f32 v210, v210, v185
    v_mov_b32 v156, v152
    v_mov_b32 v212, v208
    v_mov_b32 v157, v154
    v_mov_b32 v213, v210
    global_load_dwordx4 a[8:11], v232, s[60:61] offset:0 sc1
    v_permlane16_swap_b32 v152, v156
    v_permlane16_swap_b32 v208, v212
    v_permlane16_swap_b32 v154, v157
    v_permlane16_swap_b32 v210, v213
    v_max_f32 v152, v152, v156
    v_max_f32 v208, v208, v212
    v_min_f32 v154, v154, v157
    v_min_f32 v210, v210, v213
    v_mul_f32 v152, v166, v152
    v_mul_f32 v208, v222, v208
    v_mul_f32 v154, v166, v154
    v_mul_f32 v210, v222, v210
    v_pk_fma_f32 v[132:133], v[120:121], v[166:167], v[152:153] op_sel_hi:[1,0,0] neg_lo:[0,0,1] neg_hi:[0,0,1]
    v_pk_fma_f32 v[188:189], v[176:177], v[222:223], v[208:209] op_sel_hi:[1,0,0] neg_lo:[0,0,1] neg_hi:[0,0,1]
    v_pk_fma_f32 v[142:143], v[120:121], v[166:167], v[154:155] op_sel_hi:[1,0,0] neg_lo:[0,1,0] neg_hi:[0,1,0]
    v_pk_fma_f32 v[198:199], v[176:177], v[222:223], v[210:211] op_sel_hi:[1,0,0] neg_lo:[0,1,0] neg_hi:[0,1,0]
    v_pk_fma_f32 v[134:135], v[122:123], v[166:167], v[152:153] op_sel_hi:[1,0,0] neg_lo:[0,0,1] neg_hi:[0,0,1]
    v_pk_fma_f32 v[190:191], v[178:179], v[222:223], v[208:209] op_sel_hi:[1,0,0] neg_lo:[0,0,1] neg_hi:[0,0,1]
    v_pk_fma_f32 v[144:145], v[122:123], v[166:167], v[154:155] op_sel_hi:[1,0,0] neg_lo:[0,1,0] neg_hi:[0,1,0]
    global_load_dwordx4 a[24:27], v232, s[60:61] offset:1024 sc1
    v_pk_fma_f32 v[200:201], v[178:179], v[222:223], v[210:211] op_sel_hi:[1,0,0] neg_lo:[0,1,0] neg_hi:[0,1,0]
    v_pk_fma_f32 v[136:137], v[124:125], v[166:167], v[152:153] op_sel_hi:[1,0,0] neg_lo:[0,0,1] neg_hi:[0,0,1]
    v_pk_fma_f32 v[192:193], v[180:181], v[222:223], v[208:209] op_sel_hi:[1,0,0] neg_lo:[0,0,1] neg_hi:[0,0,1]
    v_pk_fma_f32 v[146:147], v[124:125], v[166:167], v[154:155] op_sel_hi:[1,0,0] neg_lo:[0,1,0] neg_hi:[0,1,0]
    v_pk_fma_f32 v[202:203], v[180:181], v[222:223], v[210:211] op_sel_hi:[1,0,0] neg_lo:[0,1,0] neg_hi:[0,1,0]
    v_pk_fma_f32 v[138:139], v[126:127], v[166:167], v[152:153] op_sel_hi:[1,0,0] neg_lo:[0,0,1] neg_hi:[0,0,1]
    v_pk_fma_f32 v[194:195], v[182:183], v[222:223], v[208:209] op_sel_hi:[1,0,0] neg_lo:[0,0,1] neg_hi:[0,0,1]
    v_pk_fma_f32 v[148:149], v[126:127], v[166:167], v[154:155] op_sel_hi:[1,0,0] neg_lo:[0,1,0] neg_hi:[0,1,0]
    v_pk_fma_f32 v[204:205], v[182:183], v[222:223], v[210:211] op_sel_hi:[1,0,0] neg_lo:[0,1,0] neg_hi:[0,1,0]
    v_pk_fma_f32 v[140:141], v[128:129], v[166:167], v[152:153] op_sel_hi:[1,0,0] neg_lo:[0,0,1] neg_hi:[0,0,1]
    v_pk_fma_f32 v[196:197], v[184:185], v[222:223], v[208:209] op_sel_hi:[1,0,0] neg_lo:[0,0,1] neg_hi:[0,0,1]
    v_pk_fma_f32 v[150:151], v[128:129], v[166:167], v[154:155] op_sel_hi:[1,0,0] neg_lo:[0,1,0] neg_hi:[0,1,0]
    v_pk_fma_f32 v[206:207], v[184:185], v[222:223], v[210:211] op_sel_hi:[1,0,0] neg_lo:[0,1,0] neg_hi:[0,1,0]
    v_exp_f32 v132, v132
    v_exp_f32 v188, v188
    v_exp_f32 v142, v142
    v_exp_f32 v198, v198
    v_exp_f32 v133, v133
    global_load_dwordx4 a[40:43], v232, s[60:61] offset:2048 sc1
    v_exp_f32 v189, v189
    v_exp_f32 v143, v143
    v_exp_f32 v199, v199
    v_exp_f32 v134, v134
    v_exp_f32 v190, v190
    v_exp_f32 v144, v144
    v_exp_f32 v200, v200
    v_exp_f32 v135, v135
    v_exp_f32 v191, v191
    v_exp_f32 v145, v145
    v_exp_f32 v201, v201
    global_load_dwordx4 a[56:59], v232, s[60:61] offset:3072 sc1
    v_exp_f32 v136, v136
    v_exp_f32 v192, v192
    v_exp_f32 v146, v146
    v_exp_f32 v202, v202
    v_exp_f32 v137, v137
    v_exp_f32 v193, v193
    v_exp_f32 v147, v147
    v_exp_f32 v203, v203
    v_exp_f32 v138, v138
    v_exp_f32 v194, v194
    v_exp_f32 v148, v148
    global_load_dwordx4 a[12:15], v233, s[60:61] offset:0 sc1
    v_exp_f32 v204, v204
    v_exp_f32 v139, v139
    v_exp_f32 v195, v195
    v_exp_f32 v149, v149
    v_exp_f32 v205, v205
    v_exp_f32 v140, v140
    v_exp_f32 v196, v196
    v_exp_f32 v150, v150
    v_exp_f32 v206, v206
    v_exp_f32 v141, v141
    v_exp_f32 v197, v197
    v_exp_f32 v151, v151
    global_load_dwordx4 a[28:31], v233, s[60:61] offset:1024 sc1
    v_exp_f32 v207, v207
    v_pk_add_f32 v[158:159], v[132:133], v[134:135]
    v_pk_add_f32 v[214:215], v[188:189], v[190:191]
    v_pk_add_f32 v[160:161], v[142:143], v[144:145]
    v_pk_add_f32 v[216:217], v[198:199], v[200:201]
    v_pk_add_f32 v[158:159], v[158:159], v[136:137]
    v_pk_add_f32 v[214:215], v[214:215], v[192:193]
    v_pk_add_f32 v[160:161], v[160:161], v[146:147]
    v_pk_add_f32 v[216:217], v[216:217], v[202:203]
    v_pk_add_f32 v[158:159], v[158:159], v[138:139]
    v_pk_add_f32 v[214:215], v[214:215], v[194:195]
    v_pk_add_f32 v[160:161], v[160:161], v[148:149]
    v_pk_add_f32 v[216:217], v[216:217], v[204:205]
    v_pk_add_f32 v[158:159], v[158:159], v[140:141]
    v_pk_add_f32 v[214:215], v[214:215], v[196:197]
    v_pk_add_f32 v[160:161], v[160:161], v[150:151]
    v_pk_add_f32 v[216:217], v[216:217], v[206:207]
    v_add_f32 v158, v158, v159
    v_add_f32 v214, v214, v215
    v_add_f32 v160, v160, v161
    global_load_dwordx4 a[44:47], v233, s[60:61] offset:2048 sc1
    v_add_f32 v216, v216, v217
    v_mov_b32 v156, v158
    v_mov_b32 v212, v214
    v_mov_b32 v157, v160
    v_mov_b32 v213, v216
    v_permlane16_swap_b32 v158, v156
    v_permlane16_swap_b32 v214, v212
    v_permlane16_swap_b32 v160, v157
    v_permlane16_swap_b32 v216, v213
    v_add_f32 v158, v158, v156
    v_add_f32 v214, v214, v212
    v_add_f32 v160, v160, v157
    v_add_f32 v216, v216, v213
    v_rcp_f32 v158, v158
    v_rcp_f32 v214, v214
    v_rcp_f32 v160, v160
    global_load_dwordx4 a[60:63], v233, s[60:61] offset:3072 sc1
    v_rcp_f32 v216, v216
    v_pk_mul_f32 v[132:133], v[132:133], v[158:159] op_sel_hi:[1,0]
    v_pk_mul_f32 v[188:189], v[188:189], v[214:215] op_sel_hi:[1,0]
    v_pk_mul_f32 v[142:143], v[142:143], v[160:161] op_sel_hi:[1,0]
    v_pk_mul_f32 v[198:199], v[198:199], v[216:217] op_sel_hi:[1,0]
    v_pk_mul_f32 v[134:135], v[134:135], v[158:159] op_sel_hi:[1,0]
    v_pk_mul_f32 v[190:191], v[190:191], v[214:215] op_sel_hi:[1,0]
    v_pk_mul_f32 v[144:145], v[144:145], v[160:161] op_sel_hi:[1,0]
    v_pk_mul_f32 v[200:201], v[200:201], v[216:217] op_sel_hi:[1,0]
    v_pk_mul_f32 v[136:137], v[136:137], v[158:159] op_sel_hi:[1,0]
    v_pk_mul_f32 v[192:193], v[192:193], v[214:215] op_sel_hi:[1,0]
    v_pk_mul_f32 v[146:147], v[146:147], v[160:161] op_sel_hi:[1,0]
    v_pk_mul_f32 v[202:203], v[202:203], v[216:217] op_sel_hi:[1,0]
    v_pk_mul_f32 v[138:139], v[138:139], v[158:159] op_sel_hi:[1,0]
    v_pk_mul_f32 v[194:195], v[194:195], v[214:215] op_sel_hi:[1,0]
    v_pk_mul_f32 v[148:149], v[148:149], v[160:161] op_sel_hi:[1,0]
    v_pk_mul_f32 v[204:205], v[204:205], v[216:217] op_sel_hi:[1,0]
    v_pk_mul_f32 v[140:141], v[140:141], v[158:159] op_sel_hi:[1,0]
    v_pk_mul_f32 v[196:197], v[196:197], v[214:215] op_sel_hi:[1,0]
    v_pk_mul_f32 v[150:151], v[150:151], v[160:161] op_sel_hi:[1,0]
    v_pk_mul_f32 v[206:207], v[206:207], v[216:217] op_sel_hi:[1,0]
    v_cvt_pk_bf16_f32 v158, v132, v133
    v_cvt_pk_bf16_f32 v214, v188, v189
    v_cvt_pk_bf16_f32 v159, v134, v135
    v_cvt_pk_bf16_f32 v215, v190, v191
    v_cvt_pk_bf16_f32 v160, v136, v137
    v_cvt_pk_bf16_f32 v216, v192, v193
    v_cvt_pk_bf16_f32 v161, v138, v139
    v_cvt_pk_bf16_f32 v217, v194, v195
    v_cvt_pk_bf16_f32 v162, v140, v141
    v_cvt_pk_bf16_f32 v218, v196, v197
    v_cvt_pk_bf16_f32 v163, v142, v143
    v_cvt_pk_bf16_f32 v219, v198, v199
    v_cvt_pk_bf16_f32 v164, v144, v145
    v_cvt_pk_bf16_f32 v220, v200, v201
    v_cvt_pk_bf16_f32 v165, v146, v147
    v_cvt_pk_bf16_f32 v221, v202, v203
    v_cvt_pk_bf16_f32 v166, v148, v149
    v_cvt_pk_bf16_f32 v222, v204, v205
    v_cvt_pk_bf16_f32 v167, v150, v151
    v_cvt_pk_bf16_f32 v223, v206, v207
    ds_write_b64 v224, v[158:159] offset:0
    ds_write_b64 v224, v[214:215] offset:1280
    ds_write_b64 v224, v[160:161] offset:8
    ds_write_b64 v224, v[216:217] offset:1288
    ds_write_b64 v224, v[162:163] offset:16
    ds_write_b64 v224, v[218:219] offset:1296
    ds_write_b64 v224, v[164:165] offset:24
    ds_write_b64 v224, v[220:221] offset:1304
    ds_write_b64 v224, v[166:167] offset:32
    ds_write_b64 v224, v[222:223] offset:1312
    s_cselect_b32 s82, 1, 0
    s_add_u32 s79, s98, 81920
    s_add_u32 m0, s98, 32768
    s_add_u32 s80, s40, s79
    s_addc_u32 s81, s41, 0
    s_cmp_lg_u32 s82, 0
    global_load_lds_dwordx4 v2, s[80:81] offset:-4096
    global_load_lds_dwordx4 v2, s[80:81] offset:-3072
    ds_read2_b64 v[144:147], v239 offset0:0 offset1:4
    ds_read_b64 v[148:149], v239 offset:64
    v_mov_b32 v150, 0
    v_mov_b32 v151, 0
    ds_read_b64 v[152:153], v239 offset:10240
    global_load_lds_dwordx4 v2, s[80:81] offset:-2048
    ds_read_b64 v[154:155], v239 offset:10272
    ds_read_b64 v[156:157], v239 offset:10304
    v_mov_b32 v158, 0
    v_mov_b32 v159, 0
    ds_read2_b64 v[160:163], v239 offset0:160 offset1:164
    ds_read_b64 v[164:165], v239 offset:1344
    v_mov_b32 v166, 0
    v_mov_b32 v167, 0
    ds_read_b64 v[168:169], v239 offset:11520
    ds_read_b64 v[170:171], v239 offset:11552
    ds_read_b64 v[172:173], v239 offset:11584
    v_mov_b32 v174, 0
    v_mov_b32 v175, 0
    s_waitcnt vmcnt(18)
    v_mfma_f32_16x16x32_bf16 v[176:179], v[240:243], a[0:3], 0
    s_waitcnt vmcnt(17)
    v_mfma_f32_16x16x32_bf16 v[180:183], v[240:243], a[16:19], 0
    global_load_lds_dwordx4 v2, s[80:81] offset:-1024
    s_waitcnt vmcnt(17)
    v_mfma_f32_16x16x32_bf16 v[184:187], v[240:243], a[32:35], 0
    s_waitcnt vmcnt(16)
    v_mfma_f32_16x16x32_bf16 v[188:191], v[240:243], a[48:51], 0
    s_waitcnt vmcnt(15)
    v_mfma_f32_16x16x32_bf16 v[176:179], v[240:243], a[4:7], v[176:179]
    s_waitcnt vmcnt(14)
    v_mfma_f32_16x16x32_bf16 v[180:183], v[240:243], a[20:23], v[180:183]
    global_load_lds_dwordx4 v2, s[80:81] offset:0
    s_waitcnt vmcnt(14)
    v_mfma_f32_16x16x32_bf16 v[184:187], v[240:243], a[36:39], v[184:187]
    s_waitcnt vmcnt(13)
    v_mfma_f32_16x16x32_bf16 v[188:191], v[240:243], a[52:55], v[188:191]
    s_waitcnt vmcnt(12)
    v_mfma_f32_16x16x32_bf16 v[176:179], v[240:243], a[8:11], v[176:179]
    s_waitcnt vmcnt(11)
    v_mfma_f32_16x16x32_bf16 v[180:183], v[240:243], a[24:27], v[180:183]
    global_load_lds_dwordx4 v2, s[80:81] offset:1024
    s_waitcnt vmcnt(11)
    v_mfma_f32_16x16x32_bf16 v[184:187], v[240:243], a[40:43], v[184:187]
    s_waitcnt vmcnt(10)
    v_mfma_f32_16x16x32_bf16 v[188:191], v[240:243], a[56:59], v[188:191]
    s_waitcnt vmcnt(9)
    v_mfma_f32_16x16x32_bf16 v[176:179], v[240:243], a[12:15], v[176:179]
    s_waitcnt vmcnt(8)
    v_mfma_f32_16x16x32_bf16 v[180:183], v[240:243], a[28:31], v[180:183]
    s_waitcnt vmcnt(7)
    v_mfma_f32_16x16x32_bf16 v[184:187], v[240:243], a[44:47], v[184:187]
    s_cselect_b32 s82, 1, 0
    s_add_u32 s79, s100, 28672
    s_add_u32 m0, s100, 57344
    s_add_u32 s80, s42, s79
    s_addc_u32 s81, s43, 0
    s_cmp_lg_u32 s82, 0
    global_load_lds_dwordx4 v2, s[80:81] offset:-4096
    s_waitcnt vmcnt(7)
    v_mfma_f32_16x16x32_bf16 v[188:191], v[240:243], a[60:63], v[188:191]
    v_mov_b32 v120, 0
    v_mov_b32 v121, 0
    v_mov_b32 v122, 0
    v_mov_b32 v123, 0
    v_mov_b32 v124, 0
    v_mov_b32 v125, 0
    v_mov_b32 v126, 0
    v_mov_b32 v127, 0
    v_mov_b32 v136, 0
    v_mov_b32 v137, 0
    v_mov_b32 v138, 0
    v_mov_b32 v139, 0
    v_mov_b32 v140, 0
    v_mov_b32 v141, 0
    v_mov_b32 v142, 0
    v_mov_b32 v143, 0
    v_cvt_pk_bf16_f32 v192, v176, v177
    v_cvt_pk_bf16_f32 v193, v178, v179
    v_cvt_pk_bf16_f32 v194, v180, v181
    v_cvt_pk_bf16_f32 v195, v182, v183
    v_cvt_pk_bf16_f32 v196, v184, v185
    v_cvt_pk_bf16_f32 v197, v186, v187
    v_cvt_pk_bf16_f32 v198, v188, v189
    v_cvt_pk_bf16_f32 v199, v190, v191
    s_mov_b32 exec_hi, 0
    ds_write_b64 v234, v[192:193] offset:0
    ds_write_b64 v234, v[194:195] offset:1024
    ds_write_b64 v234, v[196:197] offset:2048
    ds_write_b64 v234, v[198:199] offset:3072
    s_mov_b64 exec, -1
    s_waitcnt lgkmcnt(0)
    s_barrier
    global_load_lds_dwordx4 v2, s[80:81] offset:-3072
    ds_read_b128 v[112:115], v235 offset:0
    ds_read_b128 v[116:119], v236 offset:0
    ds_read_b128 v[128:131], v235 offset:1920
    ds_read_b128 v[132:135], v236 offset:1920
    s_mov_b32 exec_hi, 0
    ds_read_b64 v[120:121], v237 offset:0
    ds_read_b64 v[124:125], v238 offset:0
    ds_read_b64 v[136:137], v237 offset:1920
    ds_read_b64 v[140:141], v238 offset:1920
    s_mov_b64 exec, -1
    s_waitcnt lgkmcnt(7)
    v_mfma_f32_16x16x32_bf16 v[176:179], v[112:115], v[144:147], 0
    s_waitcnt lgkmcnt(6)
    v_mfma_f32_16x16x32_bf16 v[180:183], v[116:119], v[144:147], 0
    s_waitcnt lgkmcnt(5)
    v_mfma_f32_16x16x32_bf16 v[184:187], v[128:131], v[152:155], 0
    s_waitcnt lgkmcnt(4)
    v_mfma_f32_16x16x32_bf16 v[188:191], v[132:135], v[152:155], 0
    v_mfma_f32_16x16x32_bf16 v[192:195], v[112:115], v[160:163], 0
    v_mfma_f32_16x16x32_bf16 v[196:199], v[116:119], v[160:163], 0
    v_mfma_f32_16x16x32_bf16 v[200:203], v[128:131], v[168:171], 0
    v_mfma_f32_16x16x32_bf16 v[204:207], v[132:135], v[168:171], 0
    s_waitcnt lgkmcnt(3)
    v_mfma_f32_16x16x32_bf16 v[176:179], v[120:123], v[148:151], v[176:179]
    s_waitcnt lgkmcnt(2)
    v_mfma_f32_16x16x32_bf16 v[180:183], v[124:127], v[148:151], v[180:183]
    s_waitcnt lgkmcnt(1)
    v_mfma_f32_16x16x32_bf16 v[184:187], v[136:139], v[156:159], v[184:187]
    s_waitcnt lgkmcnt(0)
    v_mfma_f32_16x16x32_bf16 v[188:191], v[140:143], v[156:159], v[188:191]
    v_mfma_f32_16x16x32_bf16 v[192:195], v[120:123], v[164:167], v[192:195]
    v_mfma_f32_16x16x32_bf16 v[196:199], v[124:127], v[164:167], v[196:199]
    v_mfma_f32_16x16x32_bf16 v[200:203], v[136:139], v[172:175], v[200:203]
    v_mfma_f32_16x16x32_bf16 v[204:207], v[140:143], v[172:175], v[204:207]
    v_add_f32 v181, 0x358637bd, v181
    s_nop 2
    v_add_f32 v189, 0x358637bd, v189
    s_nop 0
    v_add_f32 v197, 0x358637bd, v197
    s_nop 0
    v_add_f32 v205, 0x358637bd, v205
    v_rcp_f32 v181, v181
    v_rcp_f32 v189, v189
    v_rcp_f32 v197, v197
    v_rcp_f32 v205, v205
    v_mul_f32 v176, v176, v181
    v_mul_f32 v177, v177, v181
    v_mul_f32 v178, v178, v181
    v_mul_f32 v179, v179, v181
    v_mul_f32 v180, v180, v181
    v_mul_f32 v184, v184, v189
    v_mul_f32 v185, v185, v189
    v_mul_f32 v186, v186, v189
    v_mul_f32 v187, v187, v189
    v_mul_f32 v188, v188, v189
    v_cvt_pk_bf16_f32 v112, v176, v177
    v_cvt_pk_bf16_f32 v113, v178, v179
    v_cvt_pk_bf16_f32 v114, v180, v184
    v_cvt_pk_bf16_f32 v115, v185, v186
    v_cvt_pk_bf16_f32 v116, v187, v188
    global_store_dwordx4 v2, v[112:115], s[50:51] offset:-4096
    global_store_dword v2, v116, s[56:57] offset:-4096
    v_mul_f32 v192, v192, v197
    v_mul_f32 v193, v193, v197
    v_mul_f32 v194, v194, v197
    v_mul_f32 v195, v195, v197
    v_mul_f32 v196, v196, v197
    v_mul_f32 v200, v200, v205
    v_mul_f32 v201, v201, v205
    v_mul_f32 v202, v202, v205
    v_mul_f32 v203, v203, v205
    v_mul_f32 v204, v204, v205
    v_cvt_pk_bf16_f32 v120, v192, v193
    v_cvt_pk_bf16_f32 v121, v194, v195
    v_cvt_pk_bf16_f32 v122, v196, v200
    v_cvt_pk_bf16_f32 v123, v201, v202
    v_cvt_pk_bf16_f32 v124, v203, v204
    global_store_dwordx4 v7, v[120:123], s[50:51] offset:0
    global_store_dword v7, v124, s[56:57] offset:0
    s_add_u32 s29, s29, 1
    v_mov_b32 v254, s29
    s_waitcnt vmcnt(0)
    s_barrier
    s_cmp_lg_u32 s24, 0
    s_nop 1
    s_cbranch_scc1 L_gb1_j_48
    s_mov_b64 exec, 1
    s_cmp_lg_u32 s27, 0
    s_cbranch_scc1 L_gb1_slowst_49
    global_store_dword v247, v254, s[0:1]
    s_branch L_gb1_st_50
L_gb1_slowst_49:
    buffer_wbl2 sc1
    s_waitcnt vmcnt(0)
    global_store_dword v247, v254, s[0:1] sc1
L_gb1_st_50:
    s_mov_b64 exec, 0xffff
    s_mov_b32 s3, 0
L_gb1_poll_46:
    global_load_dword v255, v246, s[0:1] sc1
    s_waitcnt vmcnt(0)
    v_cmp_gt_u32 vcc, s29, v255
    s_add_u32 s3, s3, 1
    s_cmp_gt_u32 s3, 4000000
    s_nop 2
    s_cbranch_scc1 L_gb1_bail_47
    s_cbranch_vccnz L_gb1_poll_46
L_gb1_bail_47:
    s_mov_b64 exec, -1
    s_cmp_eq_u32 s27, 0
    s_cbranch_scc1 L_gb1_j_48
    buffer_inv sc1
    s_waitcnt vmcnt(0)
L_gb1_j_48:
    s_barrier
    global_load_dwordx4 a[0:3], v5, s[10:11] offset:-4096 sc1
    global_load_dwordx4 a[4:7], v5, s[10:11] offset:-3072 sc1
    global_load_dwordx4 a[8:11], v5, s[10:11] offset:-2048 sc1
    global_load_dwordx4 a[12:15], v5, s[10:11] offset:-1024 sc1
    global_load_dwordx4 a[16:19], v5, s[10:11] offset:0 sc1
    global_load_dwordx4 a[20:23], v5, s[10:11] offset:1024 sc1
    s_barrier
    global_load_dwordx4 a[24:27], v5, s[10:11] offset:2048 sc1
    ds_read_b128 a[192:195], v10 offset:0
    ds_read_b128 a[196:199], v10 offset:1024
    ds_read_b128 a[200:203], v10 offset:2048
    ds_read_b128 a[204:207], v10 offset:3072
    ds_read_b128 a[208:211], v10 offset:4096
    ds_read_b128 a[212:215], v10 offset:5120
    ds_read_b128 a[216:219], v10 offset:6144
    ds_read_b128 a[220:223], v10 offset:7168
    ds_read_b128 a[224:227], v10 offset:8192
    ds_read_b128 a[228:231], v10 offset:9216
    s_waitcnt lgkmcnt(5)
    s_waitcnt vmcnt(6)
    v_mfma_f32_16x16x32_bf16 v[32:35], a[192:195], a[0:3], 0
    global_load_dwordx4 a[28:31], v5, s[10:11] offset:3072 sc1
    ds_read_b128 a[232:235], v10 offset:10240
    v_mfma_f32_16x16x32_bf16 v[36:39], a[196:199], a[0:3], 0
    ds_read_b128 a[236:239], v10 offset:11264
    v_mfma_f32_16x16x32_bf16 v[40:43], a[200:203], a[0:3], 0
    global_load_dwordx4 a[32:35], v6, s[10:11] offset:-4096 sc1
    ds_read_b128 a[240:243], v10 offset:12288
    v_mfma_f32_16x16x32_bf16 v[44:47], a[204:207], a[0:3], 0
    ds_read_b128 a[244:247], v10 offset:13312
    v_mfma_f32_16x16x32_bf16 v[48:51], a[208:211], a[0:3], 0
    ds_read_b128 a[248:251], v10 offset:14336
    s_waitcnt lgkmcnt(5)
    s_waitcnt vmcnt(7)
    v_mfma_f32_16x16x32_bf16 v[32:35], a[212:215], a[4:7], v[32:35]
    global_load_dwordx4 a[36:39], v6, s[10:11] offset:-3072 sc1
    ds_read_b128 a[192:195], v10 offset:15360
    v_mfma_f32_16x16x32_bf16 v[36:39], a[216:219], a[4:7], v[36:39]
    ds_read_b128 a[196:199], v10 offset:16384
    v_mfma_f32_16x16x32_bf16 v[40:43], a[220:223], a[4:7], v[40:43]
    global_load_dwordx4 a[40:43], v6, s[10:11] offset:-2048 sc1
    ds_read_b128 a[200:203], v10 offset:17408
    v_mfma_f32_16x16x32_bf16 v[44:47], a[224:227], a[4:7], v[44:47]
    ds_read_b128 a[204:207], v10 offset:18432
    v_mfma_f32_16x16x32_bf16 v[48:51], a[228:231], a[4:7], v[48:51]
    ds_read_b128 a[208:211], v10 offset:19456
    s_barrier
    s_waitcnt lgkmcnt(5)
    global_load_dwordx4 a[44:47], v6, s[10:11] offset:-1024 sc1
    s_waitcnt vmcnt(9)
    v_mfma_f32_16x16x32_bf16 v[32:35], a[232:235], a[8:11], v[32:35]
    ds_read_b128 a[212:215], v10 offset:20480
    v_mfma_f32_16x16x32_bf16 v[36:39], a[236:239], a[8:11], v[36:39]
    ds_read_b128 a[216:219], v10 offset:21504
    v_mfma_f32_16x16x32_bf16 v[40:43], a[240:243], a[8:11], v[40:43]
    global_load_dwordx4 a[48:51], v6, s[10:11] offset:0 sc1
    ds_read_b128 a[220:223], v10 offset:22528
    v_mfma_f32_16x16x32_bf16 v[44:47], a[244:247], a[8:11], v[44:47]
    ds_read_b128 a[224:227], v10 offset:23552
    v_mfma_f32_16x16x32_bf16 v[48:51], a[248:251], a[8:11], v[48:51]
    global_load_dwordx4 a[52:55], v6, s[10:11] offset:1024 sc1
    ds_read_b128 a[228:231], v10 offset:24576
    s_waitcnt lgkmcnt(5)
    s_waitcnt vmcnt(10)
    v_mfma_f32_16x16x32_bf16 v[32:35], a[192:195], a[12:15], v[32:35]
    ds_read_b128 a[232:235], v10 offset:25600
    v_mfma_f32_16x16x32_bf16 v[36:39], a[196:199], a[12:15], v[36:39]
    ds_read_b128 a[236:239], v10 offset:26624
    v_mfma_f32_16x16x32_bf16 v[40:43], a[200:203], a[12:15], v[40:43]
    global_load_dwordx4 a[56:59], v6, s[10:11] offset:2048 sc1
    ds_read_b128 a[240:243], v10 offset:27648
    v_mfma_f32_16x16x32_bf16 v[44:47], a[204:207], a[12:15], v[44:47]
    ds_read_b128 a[244:247], v10 offset:28672
    v_mfma_f32_16x16x32_bf16 v[48:51], a[208:211], a[12:15], v[48:51]
    global_load_dwordx4 a[60:63], v6, s[10:11] offset:3072 sc1
    ds_read_b128 a[248:251], v10 offset:29696
    s_waitcnt lgkmcnt(5)
    s_waitcnt vmcnt(11)
    v_mfma_f32_16x16x32_bf16 v[32:35], a[212:215], a[16:19], v[32:35]
    ds_read_b128 a[192:195], v10 offset:30720
    v_mfma_f32_16x16x32_bf16 v[36:39], a[216:219], a[16:19], v[36:39]
    ds_read_b128 a[196:199], v10 offset:31744
    global_load_dwordx4 a[64:67], v7, s[10:11] offset:-4096 sc1
    v_mfma_f32_16x16x32_bf16 v[40:43], a[220:223], a[16:19], v[40:43]
    ds_read_b128 a[200:203], v10 offset:32768
    v_mfma_f32_16x16x32_bf16 v[44:47], a[224:227], a[16:19], v[44:47]
    ds_read_b128 a[204:207], v10 offset:33792
    v_mfma_f32_16x16x32_bf16 v[48:51], a[228:231], a[16:19], v[48:51]
    global_load_dwordx4 a[68:71], v7, s[10:11] offset:-3072 sc1
    ds_read_b128 a[208:211], v10 offset:34816
    s_waitcnt lgkmcnt(5)
    s_waitcnt vmcnt(12)
    v_mfma_f32_16x16x32_bf16 v[32:35], a[232:235], a[20:23], v[32:35]
    ds_read_b128 a[212:215], v10 offset:35840
    v_mfma_f32_16x16x32_bf16 v[36:39], a[236:239], a[20:23], v[36:39]
    global_load_dwordx4 a[72:75], v7, s[10:11] offset:-2048 sc1
    ds_read_b128 a[216:219], v10 offset:36864
    v_mfma_f32_16x16x32_bf16 v[40:43], a[240:243], a[20:23], v[40:43]
    ds_read_b128 a[220:223], v10 offset:37888
    v_mfma_f32_16x16x32_bf16 v[44:47], a[244:247], a[20:23], v[44:47]
    ds_read_b128 a[224:227], v10 offset:38912
    v_mfma_f32_16x16x32_bf16 v[48:51], a[248:251], a[20:23], v[48:51]
    global_load_dwordx4 a[76:79], v7, s[10:11] offset:-1024 sc1
    ds_read_b128 a[228:231], v10 offset:39936
    s_waitcnt lgkmcnt(5)
    s_waitcnt vmcnt(13)
    v_mfma_f32_16x16x32_bf16 v[32:35], a[192:195], a[24:27], v[32:35]
    ds_read_b128 a[232:235], v10 offset:40960
    v_mfma_f32_16x16x32_bf16 v[36:39], a[196:199], a[24:27], v[36:39]
    s_add_u32 s79, s100, 28672
    s_add_u32 m0, s100, 57344
    s_add_u32 s80, s42, s79
    s_addc_u32 s81, s43, 0
    global_load_lds_dwordx4 v2, s[80:81] offset:-2048
    ds_read_b128 a[236:239], v10 offset:41984
    v_mfma_f32_16x16x32_bf16 v[40:43], a[200:203], a[24:27], v[40:43]
    ds_read_b128 a[240:243], v10 offset:43008
    v_mfma_f32_16x16x32_bf16 v[44:47], a[204:207], a[24:27], v[44:47]
    ds_read_b128 a[244:247], v10 offset:44032
    v_mfma_f32_16x16x32_bf16 v[48:51], a[208:211], a[24:27], v[48:51]
    ds_read_b128 a[248:251], v10 offset:45056
    s_waitcnt lgkmcnt(0)
    s_barrier
    s_waitcnt vmcnt(13)
    v_mfma_f32_16x16x32_bf16 v[32:35], a[212:215], a[28:31], v[32:35]
    ds_read_b128 a[192:195], v10 offset:46080
    v_mfma_f32_16x16x32_bf16 v[36:39], a[216:219], a[28:31], v[36:39]
    ds_read_b128 a[196:199], v10 offset:47104
    v_mfma_f32_16x16x32_bf16 v[40:43], a[220:223], a[28:31], v[40:43]
    ds_read_b128 a[200:203], v10 offset:48128
    v_mfma_f32_16x16x32_bf16 v[44:47], a[224:227], a[28:31], v[44:47]
    s_add_u32 s79, s98, 40960
    s_add_u32 m0, s98, 135168
    s_add_u32 s80, s42, s79
    s_addc_u32 s81, s43, 0
    global_load_lds_dwordx4 v2, s[80:81] offset:-4096
    ds_read_b128 a[204:207], v2 offset:0
    v_mfma_f32_16x16x32_bf16 v[48:51], a[228:231], a[28:31], v[48:51]
    ds_read_b128 a[208:211], v2 offset:1024
    s_waitcnt vmcnt(13)
    v_mfma_f32_16x16x32_bf16 v[32:35], a[232:235], a[32:35], v[32:35]
    ds_read_b128 a[212:215], v2 offset:2048
    ds_read_b128 a[216:219], v2 offset:3072
    v_mfma_f32_16x16x32_bf16 v[36:39], a[236:239], a[32:35], v[36:39]
    ds_read_b128 a[220:223], v2 offset:4096
    global_load_dwordx4 v[56:59], v2, s[16:17] sc1
    v_mfma_f32_16x16x32_bf16 v[40:43], a[240:243], a[32:35], v[40:43]
    ds_read_b128 a[224:227], v2 offset:5120
    global_load_dwordx4 v[60:63], v2, s[16:17] offset:1024 sc1
    global_load_lds_dwordx4 v2, s[80:81] offset:-3072
    v_mfma_f32_16x16x32_bf16 v[44:47], a[244:247], a[32:35], v[44:47]
    ds_read_b128 a[228:231], v2 offset:6144
    global_load_dwordx2 v[64:65], v244, s[20:21] sc1
    v_mfma_f32_16x16x32_bf16 v[48:51], a[248:251], a[32:35], v[48:51]
    s_waitcnt lgkmcnt(5)
    s_waitcnt vmcnt(16)
    v_mfma_f32_16x16x32_bf16 v[32:35], a[192:195], a[36:39], v[32:35]
    ds_read_b128 a[232:235], v2 offset:7168
    v_mfma_f32_16x16x32_bf16 v[36:39], a[196:199], a[36:39], v[36:39]
    ds_read_b128 a[236:239], v2 offset:8192
    v_mfma_f32_16x16x32_bf16 v[40:43], a[200:203], a[36:39], v[40:43]
    ds_read_b128 a[240:243], v2 offset:9216
    v_mfma_f32_16x16x32_bf16 v[44:47], a[204:207], a[36:39], v[44:47]
    global_load_lds_dwordx4 v2, s[80:81] offset:-2048
    ds_read_b128 a[244:247], v2 offset:10240
    v_mfma_f32_16x16x32_bf16 v[48:51], a[208:211], a[36:39], v[48:51]
    ds_read_b128 a[248:251], v2 offset:11264
    s_waitcnt lgkmcnt(5)
    s_waitcnt vmcnt(16)
    v_mfma_f32_16x16x32_bf16 v[32:35], a[212:215], a[40:43], v[32:35]
    ds_read_b128 a[192:195], v2 offset:12288
    v_mfma_f32_16x16x32_bf16 v[36:39], a[216:219], a[40:43], v[36:39]
    ds_read_b128 a[196:199], v2 offset:13312
    v_mfma_f32_16x16x32_bf16 v[40:43], a[220:223], a[40:43], v[40:43]
    ds_read_b128 a[200:203], v2 offset:14336
    v_mfma_f32_16x16x32_bf16 v[44:47], a[224:227], a[40:43], v[44:47]
    ds_read_b128 a[204:207], v2 offset:15360
    global_load_lds_dwordx4 v2, s[80:81] offset:-1024
    v_mfma_f32_16x16x32_bf16 v[48:51], a[228:231], a[40:43], v[48:51]
    ds_read_b128 a[208:211], v2 offset:16384
    s_waitcnt lgkmcnt(5)
    s_waitcnt vmcnt(16)
    v_mfma_f32_16x16x32_bf16 v[32:35], a[232:235], a[44:47], v[32:35]
    ds_read_b128 a[212:215], v2 offset:17408
    v_mfma_f32_16x16x32_bf16 v[36:39], a[236:239], a[44:47], v[36:39]
    ds_read_b128 a[216:219], v2 offset:18432
    v_mfma_f32_16x16x32_bf16 v[40:43], a[240:243], a[44:47], v[40:43]
    ds_read_b128 a[220:223], v2 offset:19456
    v_mfma_f32_16x16x32_bf16 v[44:47], a[244:247], a[44:47], v[44:47]
    ds_read_b128 a[224:227], v2 offset:20480
    v_mfma_f32_16x16x32_bf16 v[48:51], a[248:251], a[44:47], v[48:51]
    global_load_lds_dwordx4 v2, s[80:81] offset:0
    ds_read_b128 a[228:231], v2 offset:21504
    s_waitcnt lgkmcnt(5)
    s_waitcnt vmcnt(16)
    v_mfma_f32_16x16x32_bf16 v[32:35], a[192:195], a[48:51], v[32:35]
    ds_read_b128 a[232:235], v2 offset:22528
    v_mfma_f32_16x16x32_bf16 v[36:39], a[196:199], a[48:51], v[36:39]
    ds_read_b128 a[236:239], v2 offset:23552
    v_mfma_f32_16x16x32_bf16 v[40:43], a[200:203], a[48:51], v[40:43]
    ds_read_b128 a[240:243], v2 offset:24576
    v_mfma_f32_16x16x32_bf16 v[44:47], a[204:207], a[48:51], v[44:47]
    ds_read_b128 a[244:247], v2 offset:25600
    v_mfma_f32_16x16x32_bf16 v[48:51], a[208:211], a[48:51], v[48:51]
    ds_read_b128 a[248:251], v2 offset:26624
    s_waitcnt lgkmcnt(0)
    s_barrier
    global_load_lds_dwordx4 v2, s[80:81] offset:1024
    s_waitcnt vmcnt(16)
    v_mfma_f32_16x16x32_bf16 v[32:35], a[212:215], a[52:55], v[32:35]
    ds_read_b128 a[192:195], v2 offset:27648
    v_mfma_f32_16x16x32_bf16 v[36:39], a[216:219], a[52:55], v[36:39]
    ds_read_b128 a[196:199], v2 offset:28672
    v_mfma_f32_16x16x32_bf16 v[40:43], a[220:223], a[52:55], v[40:43]
    ds_read_b128 a[200:203], v2 offset:29696
    v_mfma_f32_16x16x32_bf16 v[44:47], a[224:227], a[52:55], v[44:47]
    ds_read_b128 a[204:207], v2 offset:30720
    v_mfma_f32_16x16x32_bf16 v[48:51], a[228:231], a[52:55], v[48:51]
    ds_read_b128 a[208:211], v2 offset:31744
    s_waitcnt vmcnt(15)
    v_mfma_f32_16x16x32_bf16 v[32:35], a[232:235], a[56:59], v[32:35]
    s_add_u32 s79, s98, 65536
    s_add_u32 m0, s98, 69632
    s_add_u32 s80, s42, s79
    s_addc_u32 s81, s43, 0
    global_load_lds_dwordx4 v2, s[80:81] offset:-4096
    ds_read_b128 a[212:215], v2 offset:32768
    v_mfma_f32_16x16x32_bf16 v[36:39], a[236:239], a[56:59], v[36:39]
    ds_read_b128 a[216:219], v2 offset:33792
    v_mfma_f32_16x16x32_bf16 v[40:43], a[240:243], a[56:59], v[40:43]
    ds_read_b128 a[220:223], v2 offset:34816
    v_mfma_f32_16x16x32_bf16 v[44:47], a[244:247], a[56:59], v[44:47]
    ds_read_b128 a[224:227], v2 offset:35840
    v_mfma_f32_16x16x32_bf16 v[48:51], a[248:251], a[56:59], v[48:51]
    ds_read_b128 a[228:231], v2 offset:36864
    s_waitcnt lgkmcnt(5)
    s_waitcnt vmcnt(15)
    v_mfma_f32_16x16x32_bf16 v[32:35], a[192:195], a[60:63], v[32:35]
    ds_read_b128 a[232:235], v2 offset:37888
    global_load_lds_dwordx4 v2, s[80:81] offset:-3072
    ds_read_b128 a[236:239], v2 offset:38912
    v_mfma_f32_16x16x32_bf16 v[36:39], a[196:199], a[60:63], v[36:39]
    ds_read_b128 a[240:243], v2 offset:39936
    s_waitcnt vmcnt(9)
    v_lshlrev_b32 v72, 16, v56
    v_mfma_f32_16x16x32_bf16 v[40:43], a[200:203], a[60:63], v[40:43]
    ds_read_b128 a[244:247], v2 offset:40960
    v_and_b32 v73, 0xffff0000, v56
    v_mfma_f32_16x16x32_bf16 v[44:47], a[204:207], a[60:63], v[44:47]
    ds_read_b128 a[248:251], v2 offset:41984
    v_lshlrev_b32 v74, 16, v57
    v_mfma_f32_16x16x32_bf16 v[48:51], a[208:211], a[60:63], v[48:51]
    v_and_b32 v75, 0xffff0000, v57
    s_waitcnt lgkmcnt(5)
    v_mfma_f32_16x16x32_bf16 v[32:35], a[212:215], a[64:67], v[32:35]
    global_load_lds_dwordx4 v2, s[80:81] offset:-2048
    ds_read_b128 a[192:195], v2 offset:43008
    ds_read_b128 a[196:199], v2 offset:44032
    v_mfma_f32_16x16x32_bf16 v[36:39], a[216:219], a[64:67], v[36:39]
    ds_read_b128 a[200:203], v2 offset:45056
    v_lshlrev_b32 v76, 16, v58
    v_mfma_f32_16x16x32_bf16 v[40:43], a[220:223], a[64:67], v[40:43]
    ds_read_b128 a[204:207], v2 offset:46080
    v_and_b32 v77, 0xffff0000, v58
    v_mfma_f32_16x16x32_bf16 v[44:47], a[224:227], a[64:67], v[44:47]
    ds_read_b128 a[208:211], v2 offset:47104
    v_lshlrev_b32 v78, 16, v59
    v_mfma_f32_16x16x32_bf16 v[48:51], a[228:231], a[64:67], v[48:51]
    v_and_b32 v79, 0xffff0000, v59
    s_waitcnt lgkmcnt(5)
    v_mfma_f32_16x16x32_bf16 v[32:35], a[232:235], a[68:71], v[32:35]
    global_load_lds_dwordx4 v2, s[80:81] offset:-1024
    ds_read_b128 a[212:215], v2 offset:48128
    ds_read_b128 a[216:219], v2 offset:49152
    v_mfma_f32_16x16x32_bf16 v[36:39], a[236:239], a[68:71], v[36:39]
    ds_read_b128 a[220:223], v2 offset:50176
    s_waitcnt vmcnt(10)
    v_lshlrev_b32 v80, 16, v60
    v_mfma_f32_16x16x32_bf16 v[40:43], a[240:243], a[68:71], v[40:43]
    ds_read_b128 a[224:227], v2 offset:51200
    v_and_b32 v81, 0xffff0000, v60
    v_mfma_f32_16x16x32_bf16 v[44:47], a[244:247], a[68:71], v[44:47]
    ds_read_b128 a[228:231], v2 offset:52224
    v_lshlrev_b32 v82, 16, v61
    v_mfma_f32_16x16x32_bf16 v[48:51], a[248:251], a[68:71], v[48:51]
    v_and_b32 v83, 0xffff0000, v61
    s_waitcnt lgkmcnt(5)
    v_mfma_f32_16x16x32_bf16 v[32:35], a[192:195], a[72:75], v[32:35]
    global_load_lds_dwordx4 v2, s[80:81] offset:0
    v_lshlrev_b32 v84, 16, v62
    v_mfma_f32_16x16x32_bf16 v[36:39], a[196:199], a[72:75], v[36:39]
    v_and_b32 v85, 0xffff0000, v62
    v_mfma_f32_16x16x32_bf16 v[40:43], a[200:203], a[72:75], v[40:43]
    v_lshlrev_b32 v86, 16, v63
    v_mfma_f32_16x16x32_bf16 v[44:47], a[204:207], a[72:75], v[44:47]
    v_and_b32 v87, 0xffff0000, v63
    v_mfma_f32_16x16x32_bf16 v[48:51], a[208:211], a[72:75], v[48:51]
    s_waitcnt lgkmcnt(0)
    v_mfma_f32_16x16x32_bf16 v[32:35], a[212:215], a[76:79], v[32:35]
    global_load_lds_dwordx4 v2, s[80:81] offset:1024
    s_waitcnt vmcnt(10)
    v_lshlrev_b32 v88, 16, v64
    v_mfma_f32_16x16x32_bf16 v[36:39], a[216:219], a[76:79], v[36:39]
    v_and_b32 v89, 0xffff0000, v64
    v_mfma_f32_16x16x32_bf16 v[40:43], a[220:223], a[76:79], v[40:43]
    v_lshlrev_b32 v90, 16, v65
    v_mfma_f32_16x16x32_bf16 v[44:47], a[224:227], a[76:79], v[44:47]
    v_and_b32 v91, 0xffff0000, v65
    v_mfma_f32_16x16x32_bf16 v[48:51], a[228:231], a[76:79], v[48:51]
    s_barrier
    v_pk_add_f32 v[72:73], v[72:73], v[32:33]
    v_pk_add_f32 v[74:75], v[74:75], v[34:35]
    v_pk_add_f32 v[76:77], v[76:77], v[36:37]
    v_pk_add_f32 v[78:79], v[78:79], v[38:39]
    v_pk_add_f32 v[80:81], v[80:81], v[40:41]
    v_pk_add_f32 v[82:83], v[82:83], v[42:43]
    v_pk_add_f32 v[84:85], v[84:85], v[44:45]
    v_pk_add_f32 v[86:87], v[86:87], v[46:47]
    v_pk_add_f32 v[88:89], v[88:89], v[48:49]
    v_pk_add_f32 v[90:91], v[90:91], v[50:51]
    v_cvt_pk_bf16_f32 v96, v72, v73
    v_cvt_pk_bf16_f32 v97, v74, v75
    v_cvt_pk_bf16_f32 v98, v76, v77
    v_cvt_pk_bf16_f32 v99, v78, v79
    v_cvt_pk_bf16_f32 v100, v80, v81
    v_cvt_pk_bf16_f32 v101, v82, v83
    v_cvt_pk_bf16_f32 v102, v84, v85
    v_cvt_pk_bf16_f32 v103, v86, v87
    v_cvt_pk_bf16_f32 v104, v88, v89
    v_cvt_pk_bf16_f32 v105, v90, v91
    global_store_dwordx4 v2, v[96:99], s[16:17]
    global_store_dwordx4 v2, v[100:103], s[16:17] offset:1024
    global_store_dwordx2 v244, v[104:105], s[20:21]
    v_pk_add_f32 v[144:145], v[72:73], v[74:75]
    v_pk_mul_f32 v[146:147], v[72:73], v[72:73]
    v_pk_fma_f32 v[146:147], v[74:75], v[74:75], v[146:147]
    v_pk_add_f32 v[144:145], v[144:145], v[76:77]
    v_pk_fma_f32 v[146:147], v[76:77], v[76:77], v[146:147]
    v_pk_add_f32 v[144:145], v[144:145], v[78:79]
    v_pk_fma_f32 v[146:147], v[78:79], v[78:79], v[146:147]
    v_pk_add_f32 v[144:145], v[144:145], v[80:81]
    v_pk_fma_f32 v[146:147], v[80:81], v[80:81], v[146:147]
    v_pk_add_f32 v[144:145], v[144:145], v[82:83]
    v_pk_fma_f32 v[146:147], v[82:83], v[82:83], v[146:147]
    v_pk_add_f32 v[144:145], v[144:145], v[84:85]
    v_pk_fma_f32 v[146:147], v[84:85], v[84:85], v[146:147]
    v_pk_add_f32 v[144:145], v[144:145], v[86:87]
    v_pk_fma_f32 v[146:147], v[86:87], v[86:87], v[146:147]
    v_pk_add_f32 v[144:145], v[144:145], v[88:89]
    v_pk_fma_f32 v[146:147], v[88:89], v[88:89], v[146:147]
    v_pk_add_f32 v[144:145], v[144:145], v[90:91]
    v_pk_fma_f32 v[146:147], v[90:91], v[90:91], v[146:147]
    v_add_f32 v144, v144, v145
    v_add_f32 v145, v146, v147
    v_mov_b32 v148, v144
    v_mov_b32 v149, v145
    s_nop 0
    v_permlane16_swap_b32 v144, v148
    v_permlane16_swap_b32 v145, v149
    v_add_f32 v144, v144, v148
    v_add_f32 v145, v145, v149
    v_mov_b32 v148, v144
    v_mov_b32 v149, v145
    s_nop 0
    v_permlane32_swap_b32 v144, v148
    v_permlane32_swap_b32 v145, v149
    v_add_f32 v144, v144, v148
    v_add_f32 v145, v145, v149
    s_mov_b64 exec, 0xffff
    global_store_dwordx2 v2, v[144:145], s[46:47]
    s_mov_b64 exec, -1
    s_add_u32 s29, s29, 1
    v_mov_b32 v254, s29
    s_waitcnt vmcnt(0)
    s_barrier
    s_cmp_lg_u32 s24, 0
    s_nop 1
    s_cbranch_scc1 L_gb2_j_53
    s_mov_b64 exec, 1
    s_cmp_lg_u32 s27, 0
    s_cbranch_scc1 L_gb2_slowst_54
    global_store_dword v247, v254, s[0:1]
    s_branch L_gb2_st_55
L_gb2_slowst_54:
    buffer_wbl2 sc1
    s_waitcnt vmcnt(0)
    global_store_dword v247, v254, s[0:1] sc1
L_gb2_st_55:
    s_mov_b64 exec, 0xffff
    s_mov_b32 s3, 0
L_gb2_poll_51:
    global_load_dword v255, v246, s[0:1] sc1
    s_waitcnt vmcnt(0)
    v_cmp_gt_u32 vcc, s29, v255
    s_add_u32 s3, s3, 1
    s_cmp_gt_u32 s3, 4000000
    s_nop 2
    s_cbranch_scc1 L_gb2_bail_52
    s_cbranch_vccnz L_gb2_poll_51
L_gb2_bail_52:
    s_mov_b64 exec, -1
    s_cmp_eq_u32 s27, 0
    s_cbranch_scc1 L_gb2_j_53
    buffer_inv sc1
    s_waitcnt vmcnt(0)
L_gb2_j_53:
    s_barrier
    global_load_dwordx4 a[0:3], v5, s[4:5] offset:-4096 sc1
    global_load_dwordx4 a[80:83], v7, s[4:5] offset:0 sc1
    global_load_dwordx4 a[4:7], v5, s[4:5] offset:-3072 sc1
    global_load_dwordx4 a[84:87], v7, s[4:5] offset:1024 sc1
    global_load_dwordx4 a[8:11], v5, s[4:5] offset:-2048 sc1
    global_load_dwordx4 a[88:91], v7, s[4:5] offset:2048 sc1
    s_barrier
    global_load_dwordx4 a[12:15], v5, s[4:5] offset:-1024 sc1
    ds_read_b128 a[160:163], v15 offset:24576
    ds_read_b128 a[164:167], v15 offset:25600
    ds_read_b128 a[168:171], v15 offset:26624
    ds_read_b128 a[172:175], v15 offset:27648
    ds_read_b128 a[176:179], v15 offset:28672
    ds_read_b128 a[180:183], v15 offset:29696
    ds_read_b128 a[184:187], v15 offset:30720
    ds_read_b128 a[188:191], v15 offset:31744
    s_waitcnt lgkmcnt(4)
    s_waitcnt vmcnt(6)
    v_mfma_f32_16x16x32_bf16 v[32:35], a[160:163], a[0:3], 0
    ds_read_b128 a[192:195], v10 offset:49152
    global_load_dwordx4 a[92:95], v7, s[4:5] offset:3072 sc1
    s_waitcnt vmcnt(6)
    v_mfma_f32_16x16x32_bf16 v[48:51], a[160:163], a[80:83], 0
    ds_read_b128 a[196:199], v10 offset:50176
    v_mfma_f32_16x16x32_bf16 v[36:39], a[164:167], a[0:3], 0
    ds_read_b128 a[200:203], v10 offset:51200
    v_mfma_f32_16x16x32_bf16 v[52:55], a[164:167], a[80:83], 0
    global_load_dwordx4 a[16:19], v5, s[4:5] offset:0 sc1
    ds_read_b128 a[204:207], v10 offset:52224
    v_mfma_f32_16x16x32_bf16 v[40:43], a[168:171], a[0:3], 0
    v_mfma_f32_16x16x32_bf16 v[56:59], a[168:171], a[80:83], 0
    v_mfma_f32_16x16x32_bf16 v[44:47], a[172:175], a[0:3], 0
    global_load_dwordx4 a[96:99], v8, s[4:5] offset:-4096 sc1
    v_mfma_f32_16x16x32_bf16 v[60:63], a[172:175], a[80:83], 0
    s_waitcnt lgkmcnt(4)
    s_waitcnt vmcnt(7)
    v_mfma_f32_16x16x32_bf16 v[32:35], a[176:179], a[4:7], v[32:35]
    ds_read_b128 a[160:163], v10 offset:53248
    s_waitcnt vmcnt(6)
    v_mfma_f32_16x16x32_bf16 v[48:51], a[176:179], a[84:87], v[48:51]
    global_load_dwordx4 a[20:23], v5, s[4:5] offset:1024 sc1
    ds_read_b128 a[164:167], v10 offset:54272
    v_mfma_f32_16x16x32_bf16 v[36:39], a[180:183], a[4:7], v[36:39]
    ds_read_b128 a[168:171], v10 offset:55296
    v_mfma_f32_16x16x32_bf16 v[52:55], a[180:183], a[84:87], v[52:55]
    ds_read_b128 a[172:175], v10 offset:56320
    v_mfma_f32_16x16x32_bf16 v[40:43], a[184:187], a[4:7], v[40:43]
    global_load_dwordx4 a[100:103], v8, s[4:5] offset:-3072 sc1
    v_mfma_f32_16x16x32_bf16 v[56:59], a[184:187], a[84:87], v[56:59]
    v_mfma_f32_16x16x32_bf16 v[44:47], a[188:191], a[4:7], v[44:47]
    v_mfma_f32_16x16x32_bf16 v[60:63], a[188:191], a[84:87], v[60:63]
    s_waitcnt lgkmcnt(4)
    global_load_dwordx4 a[24:27], v5, s[4:5] offset:2048 sc1
    s_waitcnt vmcnt(8)
    v_mfma_f32_16x16x32_bf16 v[32:35], a[192:195], a[8:11], v[32:35]
    ds_read_b128 a[176:179], v10 offset:57344
    s_waitcnt vmcnt(7)
    v_mfma_f32_16x16x32_bf16 v[48:51], a[192:195], a[88:91], v[48:51]
    ds_read_b128 a[180:183], v10 offset:58368
    v_mfma_f32_16x16x32_bf16 v[36:39], a[196:199], a[8:11], v[36:39]
    global_load_dwordx4 a[104:107], v8, s[4:5] offset:-2048 sc1
    ds_read_b128 a[184:187], v10 offset:59392
    v_mfma_f32_16x16x32_bf16 v[52:55], a[196:199], a[88:91], v[52:55]
    ds_read_b128 a[188:191], v10 offset:60416
    v_mfma_f32_16x16x32_bf16 v[40:43], a[200:203], a[8:11], v[40:43]
    global_load_dwordx4 v[16:19], v5, s[6:7] offset:-4096 sc1
    v_mfma_f32_16x16x32_bf16 v[56:59], a[200:203], a[88:91], v[56:59]
    v_mfma_f32_16x16x32_bf16 v[44:47], a[204:207], a[8:11], v[44:47]
    v_mfma_f32_16x16x32_bf16 v[60:63], a[204:207], a[88:91], v[60:63]
    s_waitcnt lgkmcnt(4)
    s_waitcnt vmcnt(8)
    v_mfma_f32_16x16x32_bf16 v[32:35], a[160:163], a[12:15], v[32:35]
    global_load_dwordx4 v[20:23], v5, s[6:7] offset:-3072 sc1
    ds_read_b128 a[192:195], v10 offset:61440
    s_waitcnt vmcnt(8)
    v_mfma_f32_16x16x32_bf16 v[48:51], a[160:163], a[92:95], v[48:51]
    ds_read_b128 a[196:199], v10 offset:62464
    v_mfma_f32_16x16x32_bf16 v[36:39], a[164:167], a[12:15], v[36:39]
    global_load_dwordx4 a[28:31], v5, s[4:5] offset:3072 sc1
    ds_read_b128 a[200:203], v10 offset:63488
    v_mfma_f32_16x16x32_bf16 v[52:55], a[164:167], a[92:95], v[52:55]
    ds_read_b128 a[204:207], v10 offset:64512
    v_mfma_f32_16x16x32_bf16 v[40:43], a[168:171], a[12:15], v[40:43]
    v_mfma_f32_16x16x32_bf16 v[56:59], a[168:171], a[92:95], v[56:59]
    global_load_dwordx4 a[108:111], v8, s[4:5] offset:-1024 sc1
    v_mfma_f32_16x16x32_bf16 v[44:47], a[172:175], a[12:15], v[44:47]
    v_mfma_f32_16x16x32_bf16 v[60:63], a[172:175], a[92:95], v[60:63]
    s_waitcnt lgkmcnt(0)
    s_barrier
    s_waitcnt vmcnt(9)
    v_mfma_f32_16x16x32_bf16 v[32:35], a[176:179], a[16:19], v[32:35]
    global_load_dwordx4 a[32:35], v6, s[4:5] offset:-4096 sc1
    ds_read_b128 a[160:163], v2 offset:53248
    s_waitcnt vmcnt(9)
    v_mfma_f32_16x16x32_bf16 v[48:51], a[176:179], a[96:99], v[48:51]
    ds_read_b128 a[164:167], v2 offset:54272
    v_mfma_f32_16x16x32_bf16 v[36:39], a[180:183], a[16:19], v[36:39]
    ds_read_b128 a[168:171], v2 offset:55296
    v_mfma_f32_16x16x32_bf16 v[52:55], a[180:183], a[96:99], v[52:55]
    global_load_dwordx4 a[112:115], v8, s[4:5] offset:0 sc1
    ds_read_b128 a[172:175], v2 offset:56320
    v_mfma_f32_16x16x32_bf16 v[40:43], a[184:187], a[16:19], v[40:43]
    v_mfma_f32_16x16x32_bf16 v[56:59], a[184:187], a[96:99], v[56:59]
    v_mfma_f32_16x16x32_bf16 v[44:47], a[188:191], a[16:19], v[44:47]
    global_load_dwordx4 a[36:39], v6, s[4:5] offset:-3072 sc1
    v_mfma_f32_16x16x32_bf16 v[60:63], a[188:191], a[96:99], v[60:63]
    s_waitcnt vmcnt(10)
    v_mfma_f32_16x16x32_bf16 v[32:35], a[192:195], a[20:23], v[32:35]
    ds_read_b128 a[176:179], v2 offset:57344
    s_waitcnt vmcnt(9)
    v_mfma_f32_16x16x32_bf16 v[48:51], a[192:195], a[100:103], v[48:51]
    global_load_dwordx4 a[116:119], v8, s[4:5] offset:1024 sc1
    ds_read_b128 a[180:183], v2 offset:58368
    v_mfma_f32_16x16x32_bf16 v[36:39], a[196:199], a[20:23], v[36:39]
    ds_read_b128 a[184:187], v2 offset:59392
    v_mfma_f32_16x16x32_bf16 v[52:55], a[196:199], a[100:103], v[52:55]
    ds_read_b128 a[188:191], v2 offset:60416
    global_load_dwordx4 a[40:43], v6, s[4:5] offset:-2048 sc1
    v_mfma_f32_16x16x32_bf16 v[40:43], a[200:203], a[20:23], v[40:43]
    v_mfma_f32_16x16x32_bf16 v[56:59], a[200:203], a[100:103], v[56:59]
    v_mfma_f32_16x16x32_bf16 v[44:47], a[204:207], a[20:23], v[44:47]
    v_mfma_f32_16x16x32_bf16 v[60:63], a[204:207], a[100:103], v[60:63]
    s_waitcnt lgkmcnt(4)
    global_load_dwordx4 a[120:123], v8, s[4:5] offset:2048 sc1
    s_waitcnt vmcnt(11)
    v_mfma_f32_16x16x32_bf16 v[32:35], a[160:163], a[24:27], v[32:35]
    ds_read_b128 a[192:195], v2 offset:61440
    s_waitcnt vmcnt(10)
    v_mfma_f32_16x16x32_bf16 v[48:51], a[160:163], a[104:107], v[48:51]
    ds_read_b128 a[196:199], v2 offset:62464
    global_load_dwordx4 a[44:47], v6, s[4:5] offset:-1024 sc1
    v_mfma_f32_16x16x32_bf16 v[36:39], a[164:167], a[24:27], v[36:39]
    ds_read_b128 a[200:203], v2 offset:63488
    v_mfma_f32_16x16x32_bf16 v[52:55], a[164:167], a[104:107], v[52:55]
    ds_read_b128 a[204:207], v2 offset:64512
    v_mfma_f32_16x16x32_bf16 v[40:43], a[168:171], a[24:27], v[40:43]
    global_load_dwordx4 a[124:127], v8, s[4:5] offset:3072 sc1
    v_mfma_f32_16x16x32_bf16 v[56:59], a[168:171], a[104:107], v[56:59]
    v_mfma_f32_16x16x32_bf16 v[44:47], a[172:175], a[24:27], v[44:47]
    v_mfma_f32_16x16x32_bf16 v[60:63], a[172:175], a[104:107], v[60:63]
    s_waitcnt lgkmcnt(0)
    s_barrier
    global_load_dwordx4 a[48:51], v6, s[4:5] offset:0 sc1
    s_waitcnt vmcnt(10)
    v_mfma_f32_16x16x32_bf16 v[32:35], a[176:179], a[28:31], v[32:35]
    ds_read_b128 a[160:163], v15 offset:0
    s_waitcnt vmcnt(9)
    v_mfma_f32_16x16x32_bf16 v[48:51], a[176:179], a[108:111], v[48:51]
    ds_read_b128 a[164:167], v15 offset:1024
    v_mfma_f32_16x16x32_bf16 v[36:39], a[180:183], a[28:31], v[36:39]
    global_load_dwordx4 a[128:131], v9, s[4:5] offset:-4096 sc1
    ds_read_b128 a[168:171], v15 offset:2048
    v_mfma_f32_16x16x32_bf16 v[52:55], a[180:183], a[108:111], v[52:55]
    ds_read_b128 a[172:175], v15 offset:3072
    v_mfma_f32_16x16x32_bf16 v[40:43], a[184:187], a[28:31], v[40:43]
    v_mfma_f32_16x16x32_bf16 v[56:59], a[184:187], a[108:111], v[56:59]
    global_load_dwordx4 a[52:55], v6, s[4:5] offset:1024 sc1
    v_mfma_f32_16x16x32_bf16 v[44:47], a[188:191], a[28:31], v[44:47]
    v_mfma_f32_16x16x32_bf16 v[60:63], a[188:191], a[108:111], v[60:63]
    s_waitcnt vmcnt(10)
    v_mfma_f32_16x16x32_bf16 v[32:35], a[192:195], a[32:35], v[32:35]
    global_load_dwordx4 a[132:135], v9, s[4:5] offset:-3072 sc1
    ds_read_b128 a[176:179], v15 offset:4096
    s_waitcnt vmcnt(10)
    v_mfma_f32_16x16x32_bf16 v[48:51], a[192:195], a[112:115], v[48:51]
    ds_read_b128 a[180:183], v15 offset:5120
    v_mfma_f32_16x16x32_bf16 v[36:39], a[196:199], a[32:35], v[36:39]
    ds_read_b128 a[184:187], v15 offset:6144
    v_mfma_f32_16x16x32_bf16 v[52:55], a[196:199], a[112:115], v[52:55]
    global_load_dwordx4 a[56:59], v6, s[4:5] offset:2048 sc1
    ds_read_b128 a[188:191], v15 offset:7168
    v_mfma_f32_16x16x32_bf16 v[40:43], a[200:203], a[32:35], v[40:43]
    v_mfma_f32_16x16x32_bf16 v[56:59], a[200:203], a[112:115], v[56:59]
    v_mfma_f32_16x16x32_bf16 v[44:47], a[204:207], a[32:35], v[44:47]
    global_load_dwordx4 a[136:139], v9, s[4:5] offset:-2048 sc1
    v_mfma_f32_16x16x32_bf16 v[60:63], a[204:207], a[112:115], v[60:63]
    s_waitcnt lgkmcnt(4)
    s_waitcnt vmcnt(11)
    v_mfma_f32_16x16x32_bf16 v[32:35], a[160:163], a[36:39], v[32:35]
    ds_read_b128 a[192:195], v15 offset:8192
    s_waitcnt vmcnt(10)
    v_mfma_f32_16x16x32_bf16 v[48:51], a[160:163], a[116:119], v[48:51]
    global_load_dwordx4 a[60:63], v6, s[4:5] offset:3072 sc1
    ds_read_b128 a[196:199], v15 offset:9216
    v_mfma_f32_16x16x32_bf16 v[36:39], a[164:167], a[36:39], v[36:39]
    ds_read_b128 a[200:203], v15 offset:10240
    v_mfma_f32_16x16x32_bf16 v[52:55], a[164:167], a[116:119], v[52:55]
    global_load_dwordx4 a[140:143], v9, s[4:5] offset:-1024 sc1
    ds_read_b128 a[204:207], v15 offset:11264
    v_mfma_f32_16x16x32_bf16 v[40:43], a[168:171], a[36:39], v[40:43]
    v_mfma_f32_16x16x32_bf16 v[56:59], a[168:171], a[116:119], v[56:59]
    v_mfma_f32_16x16x32_bf16 v[44:47], a[172:175], a[36:39], v[44:47]
    global_load_dwordx4 a[64:67], v7, s[4:5] offset:-4096 sc1
    v_mfma_f32_16x16x32_bf16 v[60:63], a[172:175], a[116:119], v[60:63]
    s_waitcnt lgkmcnt(4)
    s_waitcnt vmcnt(12)
    v_mfma_f32_16x16x32_bf16 v[32:35], a[176:179], a[40:43], v[32:35]
    ds_read_b128 a[160:163], v15 offset:12288
    s_waitcnt vmcnt(11)
    v_mfma_f32_16x16x32_bf16 v[48:51], a[176:179], a[120:123], v[48:51]
    global_load_dwordx4 a[144:147], v9, s[4:5] offset:0 sc1
    ds_read_b128 a[164:167], v15 offset:13312
    v_mfma_f32_16x16x32_bf16 v[36:39], a[180:183], a[40:43], v[36:39]
    ds_read_b128 a[168:171], v15 offset:14336
    v_mfma_f32_16x16x32_bf16 v[52:55], a[180:183], a[120:123], v[52:55]
    ds_read_b128 a[172:175], v15 offset:15360
    v_mfma_f32_16x16x32_bf16 v[40:43], a[184:187], a[40:43], v[40:43]
    global_load_dwordx4 a[68:71], v7, s[4:5] offset:-3072 sc1
    v_mfma_f32_16x16x32_bf16 v[56:59], a[184:187], a[120:123], v[56:59]
    v_mfma_f32_16x16x32_bf16 v[44:47], a[188:191], a[40:43], v[44:47]
    v_mfma_f32_16x16x32_bf16 v[60:63], a[188:191], a[120:123], v[60:63]
    s_waitcnt lgkmcnt(4)
    global_load_dwordx4 a[148:151], v9, s[4:5] offset:1024 sc1
    s_waitcnt vmcnt(13)
    v_mfma_f32_16x16x32_bf16 v[32:35], a[192:195], a[44:47], v[32:35]
    ds_read_b128 a[176:179], v15 offset:16384
    s_waitcnt vmcnt(12)
    v_mfma_f32_16x16x32_bf16 v[48:51], a[192:195], a[124:127], v[48:51]
    ds_read_b128 a[180:183], v15 offset:17408
    v_mfma_f32_16x16x32_bf16 v[36:39], a[196:199], a[44:47], v[36:39]
    global_load_dwordx4 a[72:75], v7, s[4:5] offset:-2048 sc1
    ds_read_b128 a[184:187], v15 offset:18432
    v_mfma_f32_16x16x32_bf16 v[52:55], a[196:199], a[124:127], v[52:55]
    ds_read_b128 a[188:191], v15 offset:19456
    v_mfma_f32_16x16x32_bf16 v[40:43], a[200:203], a[44:47], v[40:43]
    v_mfma_f32_16x16x32_bf16 v[56:59], a[200:203], a[124:127], v[56:59]
    global_load_dwordx4 a[152:155], v9, s[4:5] offset:2048 sc1
    v_mfma_f32_16x16x32_bf16 v[44:47], a[204:207], a[44:47], v[44:47]
    v_mfma_f32_16x16x32_bf16 v[60:63], a[204:207], a[124:127], v[60:63]
    s_waitcnt lgkmcnt(4)
    s_waitcnt vmcnt(13)
    v_mfma_f32_16x16x32_bf16 v[32:35], a[160:163], a[48:51], v[32:35]
    global_load_dwordx4 a[76:79], v7, s[4:5] offset:-1024 sc1
    ds_read_b128 a[192:195], v15 offset:20480
    v_add_f32 v16, v16, v18
    s_waitcnt vmcnt(13)
    v_mfma_f32_16x16x32_bf16 v[48:51], a[160:163], a[128:131], v[48:51]
    ds_read_b128 a[196:199], v15 offset:21504
    v_add_f32 v20, v20, v22
    v_mfma_f32_16x16x32_bf16 v[36:39], a[164:167], a[48:51], v[36:39]
    global_load_dwordx4 a[156:159], v9, s[4:5] offset:3072 sc1
    ds_read_b128 a[200:203], v15 offset:22528
    v_add_f32 v17, v17, v19
    v_mfma_f32_16x16x32_bf16 v[52:55], a[164:167], a[128:131], v[52:55]
    ds_read_b128 a[204:207], v15 offset:23552
    v_add_f32 v21, v21, v23
    v_mfma_f32_16x16x32_bf16 v[40:43], a[168:171], a[48:51], v[40:43]
    s_add_u32 s79, s98, 90112
    s_add_u32 m0, s98, 94208
    s_add_u32 s80, s42, s79
    s_addc_u32 s81, s43, 0
    global_load_lds_dwordx4 v2, s[80:81] offset:-4096
    v_mov_b32 v28, v16
    v_mov_b32 v30, v20
    v_mfma_f32_16x16x32_bf16 v[56:59], a[168:171], a[128:131], v[56:59]
    v_mov_b32 v29, v17
    v_mov_b32 v31, v21
    v_mfma_f32_16x16x32_bf16 v[44:47], a[172:175], a[48:51], v[44:47]
    v_permlane16_swap_b32 v16, v28
    v_permlane16_swap_b32 v20, v30
    v_mfma_f32_16x16x32_bf16 v[60:63], a[172:175], a[128:131], v[60:63]
    v_permlane16_swap_b32 v17, v29
    s_waitcnt lgkmcnt(0)
    s_barrier
    s_waitcnt vmcnt(14)
    v_mfma_f32_16x16x32_bf16 v[32:35], a[176:179], a[52:55], v[32:35]
    ds_read_b128 a[160:163], v10 offset:0
    v_permlane16_swap_b32 v21, v31
    global_load_lds_dwordx4 v2, s[80:81] offset:-3072
    s_waitcnt vmcnt(14)
    v_mfma_f32_16x16x32_bf16 v[48:51], a[176:179], a[132:135], v[48:51]
    ds_read_b128 a[164:167], v10 offset:1024
    v_add_f32 v16, v16, v28
    v_mfma_f32_16x16x32_bf16 v[36:39], a[180:183], a[52:55], v[36:39]
    ds_read_b128 a[168:171], v10 offset:2048
    v_add_f32 v20, v20, v30
    v_mfma_f32_16x16x32_bf16 v[52:55], a[180:183], a[132:135], v[52:55]
    ds_read_b128 a[172:175], v10 offset:3072
    v_add_f32 v17, v17, v29
    v_mfma_f32_16x16x32_bf16 v[40:43], a[184:187], a[52:55], v[40:43]
    v_add_f32 v21, v21, v31
    v_mov_b32 v28, v16
    v_mfma_f32_16x16x32_bf16 v[56:59], a[184:187], a[132:135], v[56:59]
    global_load_lds_dwordx4 v2, s[80:81] offset:-2048
    v_mov_b32 v30, v20
    v_mov_b32 v29, v17
    v_mfma_f32_16x16x32_bf16 v[44:47], a[188:191], a[52:55], v[44:47]
    v_mov_b32 v31, v21
    v_permlane32_swap_b32 v16, v28
    v_mfma_f32_16x16x32_bf16 v[60:63], a[188:191], a[132:135], v[60:63]
    v_permlane32_swap_b32 v20, v30
    s_waitcnt vmcnt(14)
    v_mfma_f32_16x16x32_bf16 v[32:35], a[192:195], a[56:59], v[32:35]
    ds_read_b128 a[176:179], v10 offset:4096
    v_permlane32_swap_b32 v17, v29
    s_waitcnt vmcnt(13)
    v_mfma_f32_16x16x32_bf16 v[48:51], a[192:195], a[136:139], v[48:51]
    global_load_lds_dwordx4 v2, s[80:81] offset:-1024
    ds_read_b128 a[180:183], v10 offset:5120
    v_permlane32_swap_b32 v21, v31
    v_mfma_f32_16x16x32_bf16 v[36:39], a[196:199], a[56:59], v[36:39]
    ds_read_b128 a[184:187], v10 offset:6144
    v_add_f32 v16, v16, v28
    v_mfma_f32_16x16x32_bf16 v[52:55], a[196:199], a[136:139], v[52:55]
    ds_read_b128 a[188:191], v10 offset:7168
    v_add_f32 v20, v20, v30
    v_mfma_f32_16x16x32_bf16 v[40:43], a[200:203], a[56:59], v[40:43]
    v_add_f32 v17, v17, v29
    v_add_f32 v21, v21, v31
    v_mfma_f32_16x16x32_bf16 v[56:59], a[200:203], a[136:139], v[56:59]
    v_mul_f32 v16, 0xbacccccd, v16
    v_mul_f32 v20, 0xbacccccd, v20
    global_load_lds_dwordx4 v2, s[80:81] offset:0
    v_mfma_f32_16x16x32_bf16 v[44:47], a[204:207], a[56:59], v[44:47]
    v_mul_f32 v17, 0x3acccccd, v17
    v_mfma_f32_16x16x32_bf16 v[60:63], a[204:207], a[136:139], v[60:63]
    v_mul_f32 v21, 0x3acccccd, v21
    s_waitcnt lgkmcnt(4)
    s_waitcnt vmcnt(14)
    v_mfma_f32_16x16x32_bf16 v[32:35], a[160:163], a[60:63], v[32:35]
    ds_read_b128 a[192:195], v10 offset:8192
    v_fma_f32 v17, -v16, v16, v17
    s_waitcnt vmcnt(13)
    v_mfma_f32_16x16x32_bf16 v[48:51], a[160:163], a[140:143], v[48:51]
    ds_read_b128 a[196:199], v10 offset:9216
    v_fma_f32 v21, -v20, v20, v21
    v_mfma_f32_16x16x32_bf16 v[36:39], a[164:167], a[60:63], v[36:39]
    ds_read_b128 a[200:203], v10 offset:10240
    v_max_f32 v17, 0, v17
    global_load_lds_dwordx4 v2, s[80:81] offset:1024
    v_mfma_f32_16x16x32_bf16 v[52:55], a[164:167], a[140:143], v[52:55]
    ds_read_b128 a[204:207], v10 offset:11264
    v_max_f32 v21, 0, v21
    v_mfma_f32_16x16x32_bf16 v[40:43], a[168:171], a[60:63], v[40:43]
    v_add_f32 v17, 0x3727c5ac, v17
    v_add_f32 v21, 0x3727c5ac, v21
    v_mfma_f32_16x16x32_bf16 v[56:59], a[168:171], a[140:143], v[56:59]
    v_rsq_f32 v24, v17
    v_rsq_f32 v26, v21
    v_mfma_f32_16x16x32_bf16 v[44:47], a[172:175], a[60:63], v[44:47]
    v_cvt_pk_bf16_f32 v28, v16, v16
    v_cvt_pk_bf16_f32 v30, v20, v20
    v_mfma_f32_16x16x32_bf16 v[60:63], a[172:175], a[140:143], v[60:63]
    s_add_u32 s79, s99, 114688
    s_add_u32 m0, s99, 4096
    s_add_u32 s80, s42, s79
    s_addc_u32 s81, s43, 0
    global_load_lds_dwordx4 v2, s[80:81] offset:-4096
    v_and_b32 v28, 0xffff0000, v28
    s_waitcnt lgkmcnt(4)
    s_waitcnt vmcnt(14)
    v_mfma_f32_16x16x32_bf16 v[32:35], a[176:179], a[64:67], v[32:35]
    ds_read_b128 a[160:163], v10 offset:12288
    v_and_b32 v30, 0xffff0000, v30
    s_waitcnt vmcnt(13)
    v_mfma_f32_16x16x32_bf16 v[48:51], a[176:179], a[144:147], v[48:51]
    ds_read_b128 a[164:167], v10 offset:13312
    v_sub_f32 v28, v16, v28
    v_mfma_f32_16x16x32_bf16 v[36:39], a[180:183], a[64:67], v[36:39]
    ds_read_b128 a[168:171], v10 offset:14336
    v_sub_f32 v30, v20, v30
    v_mfma_f32_16x16x32_bf16 v[52:55], a[180:183], a[144:147], v[52:55]
    ds_read_b128 a[172:175], v10 offset:15360
    v_cvt_pk_bf16_f32 v104, v16, v28
    global_load_lds_dwordx4 v2, s[80:81] offset:-3072
    v_mfma_f32_16x16x32_bf16 v[40:43], a[184:187], a[64:67], v[40:43]
    v_cvt_pk_bf16_f32 v108, v20, v30
    v_mov_b32 v106, 0
    v_mfma_f32_16x16x32_bf16 v[56:59], a[184:187], a[144:147], v[56:59]
    v_mov_b32 v110, 0
    v_cvt_pk_bf16_f32 v105, v16, v106
    v_mfma_f32_16x16x32_bf16 v[44:47], a[188:191], a[64:67], v[44:47]
    v_cvt_pk_bf16_f32 v109, v20, v110
    v_mov_b32 v107, 0
    v_mfma_f32_16x16x32_bf16 v[60:63], a[188:191], a[144:147], v[60:63]
    v_mov_b32 v111, 0
    s_waitcnt lgkmcnt(4)
    s_waitcnt vmcnt(13)
    v_mfma_f32_16x16x32_bf16 v[32:35], a[192:195], a[68:71], v[32:35]
    global_load_lds_dwordx4 v2, s[80:81] offset:-2048
    ds_read_b128 a[176:179], v10 offset:16384
    v_mul_f32 v164, v24, v24
    s_waitcnt vmcnt(13)
    v_mfma_f32_16x16x32_bf16 v[48:51], a[192:195], a[148:151], v[48:51]
    ds_read_b128 a[180:183], v10 offset:17408
    v_mul_f32 v170, v26, v26
    v_mfma_f32_16x16x32_bf16 v[36:39], a[196:199], a[68:71], v[36:39]
    ds_read_b128 a[184:187], v10 offset:18432
    v_mul_f32 v160, 0xc0135761, v24
    v_mfma_f32_16x16x32_bf16 v[52:55], a[196:199], a[148:151], v[52:55]
    ds_read_b128 a[188:191], v10 offset:19456
    v_mul_f32 v166, 0xc0135761, v26
    v_mfma_f32_16x16x32_bf16 v[40:43], a[200:203], a[68:71], v[40:43]
    v_mul_f32 v162, v164, v24
    v_mul_f32 v168, v170, v26
    v_mfma_f32_16x16x32_bf16 v[56:59], a[200:203], a[148:151], v[56:59]
    global_load_lds_dwordx4 v2, s[80:81] offset:-1024
    v_mul_f32 v162, 0xbdd2d3e8, v162
    v_mul_f32 v168, 0xbdd2d3e8, v168
    v_mfma_f32_16x16x32_bf16 v[44:47], a[204:207], a[68:71], v[44:47]
    v_rcp_f32 v164, v164
    v_mfma_f32_16x16x32_bf16 v[60:63], a[204:207], a[148:151], v[60:63]
    v_rcp_f32 v170, v170
    s_waitcnt lgkmcnt(4)
    s_waitcnt vmcnt(13)
    v_mfma_f32_16x16x32_bf16 v[32:35], a[160:163], a[72:75], v[32:35]
    ds_read_b128 a[192:195], v10 offset:20480
    s_waitcnt vmcnt(12)
    v_mfma_f32_16x16x32_bf16 v[48:51], a[160:163], a[152:155], v[48:51]
    ds_read_b128 a[196:199], v10 offset:21504
    v_mfma_f32_16x16x32_bf16 v[36:39], a[164:167], a[72:75], v[36:39]
    global_load_lds_dwordx4 v2, s[80:81] offset:0
    ds_read_b128 a[200:203], v10 offset:22528
    v_mfma_f32_16x16x32_bf16 v[52:55], a[164:167], a[152:155], v[52:55]
    ds_read_b128 a[204:207], v10 offset:23552
    v_mfma_f32_16x16x32_bf16 v[40:43], a[168:171], a[72:75], v[40:43]
    v_mfma_f32_16x16x32_bf16 v[56:59], a[168:171], a[152:155], v[56:59]
    v_mfma_f32_16x16x32_bf16 v[44:47], a[172:175], a[72:75], v[44:47]
    v_mfma_f32_16x16x32_bf16 v[60:63], a[172:175], a[152:155], v[60:63]
    s_waitcnt vmcnt(5)
    s_barrier
    s_waitcnt lgkmcnt(4)
    v_mfma_f32_16x16x32_bf16 v[32:35], a[176:179], a[76:79], v[32:35]
    global_load_lds_dwordx4 v2, s[80:81] offset:1024
    ds_read_b128 a[160:163], v10 offset:24576
    v_mfma_f32_16x16x32_bf16 v[48:51], a[176:179], a[156:159], v[48:51]
    ds_read_b128 a[164:167], v10 offset:25600
    v_mfma_f32_16x16x32_bf16 v[36:39], a[180:183], a[76:79], v[36:39]
    ds_read_b128 a[168:171], v10 offset:26624
    v_mfma_f32_16x16x32_bf16 v[52:55], a[180:183], a[156:159], v[52:55]
    ds_read_b128 a[172:175], v10 offset:27648
    v_mfma_f32_16x16x32_bf16 v[40:43], a[184:187], a[76:79], v[40:43]
    v_mfma_f32_16x16x32_bf16 v[56:59], a[184:187], a[156:159], v[56:59]
    v_mfma_f32_16x16x32_bf16 v[44:47], a[188:191], a[76:79], v[44:47]
    global_load_lds_dwordx4 v2, s[80:81] offset:2048
    v_mfma_f32_16x16x32_bf16 v[60:63], a[188:191], a[156:159], v[60:63]
    s_waitcnt lgkmcnt(4)
    v_mfma_f32_16x16x32_bf16 v[32:35], a[192:195], v[104:107], v[32:35]
    ds_read_b128 a[176:179], v10 offset:28672
    v_mfma_f32_16x16x32_bf16 v[48:51], a[192:195], v[108:111], v[48:51]
    ds_read_b128 a[180:183], v10 offset:29696
    v_mfma_f32_16x16x32_bf16 v[36:39], a[196:199], v[104:107], v[36:39]
    ds_read_b128 a[184:187], v10 offset:30720
    v_mfma_f32_16x16x32_bf16 v[52:55], a[196:199], v[108:111], v[52:55]
    ds_read_b128 a[188:191], v10 offset:31744
    v_mfma_f32_16x16x32_bf16 v[40:43], a[200:203], v[104:107], v[40:43]
    s_add_u32 s79, s98, 143360
    s_add_u32 m0, s98, 32768
    s_add_u32 s80, s42, s79
    s_addc_u32 s81, s43, 0
    global_load_lds_dwordx4 v2, s[80:81] offset:-4096
    v_mfma_f32_16x16x32_bf16 v[56:59], a[200:203], v[108:111], v[56:59]
    v_mfma_f32_16x16x32_bf16 v[44:47], a[204:207], v[104:107], v[44:47]
    v_mfma_f32_16x16x32_bf16 v[60:63], a[204:207], v[108:111], v[60:63]
    s_waitcnt lgkmcnt(4)
    v_mfma_f32_16x16x32_bf16 v[64:67], a[160:163], a[0:3], 0
    ds_read_b128 a[192:195], v10 offset:32768
    v_mfma_f32_16x16x32_bf16 v[80:83], a[160:163], a[80:83], 0
    ds_read_b128 a[196:199], v10 offset:33792
    v_mfma_f32_16x16x32_bf16 v[68:71], a[164:167], a[0:3], 0
    global_load_lds_dwordx4 v2, s[80:81] offset:-3072
    ds_read_b128 a[200:203], v10 offset:34816
    v_mfma_f32_16x16x32_bf16 v[84:87], a[164:167], a[80:83], 0
    ds_read_b128 a[204:207], v10 offset:35840
    v_mfma_f32_16x16x32_bf16 v[72:75], a[168:171], a[0:3], 0
    v_mfma_f32_16x16x32_bf16 v[88:91], a[168:171], a[80:83], 0
    v_mfma_f32_16x16x32_bf16 v[76:79], a[172:175], a[0:3], 0
    v_mfma_f32_16x16x32_bf16 v[92:95], a[172:175], a[80:83], 0
    s_waitcnt lgkmcnt(4)
    v_mfma_f32_16x16x32_bf16 v[64:67], a[176:179], a[4:7], v[64:67]
    ds_read_b128 a[160:163], v10 offset:36864
    global_load_lds_dwordx4 v2, s[80:81] offset:-2048
    v_mul_f32 v112, v32, v32
    v_mfma_f32_16x16x32_bf16 v[80:83], a[176:179], a[84:87], v[80:83]
    ds_read_b128 a[164:167], v10 offset:37888
    v_mul_f32 v136, v48, v48
    v_mfma_f32_16x16x32_bf16 v[68:71], a[180:183], a[4:7], v[68:71]
    ds_read_b128 a[168:171], v10 offset:38912
    v_fma_f32 v112, v112, v162, v160
    v_mfma_f32_16x16x32_bf16 v[84:87], a[180:183], a[84:87], v[84:87]
    ds_read_b128 a[172:175], v10 offset:39936
    v_fma_f32 v136, v136, v168, v166
    v_mfma_f32_16x16x32_bf16 v[72:75], a[184:187], a[4:7], v[72:75]
    v_mul_f32 v112, v32, v112
    v_mfma_f32_16x16x32_bf16 v[88:91], a[184:187], a[84:87], v[88:91]
    global_load_lds_dwordx4 v2, s[80:81] offset:-1024
    v_mul_f32 v136, v48, v136
    v_mfma_f32_16x16x32_bf16 v[76:79], a[188:191], a[4:7], v[76:79]
    v_exp_f32 v112, v112
    v_mfma_f32_16x16x32_bf16 v[92:95], a[188:191], a[84:87], v[92:95]
    v_exp_f32 v136, v136
    s_waitcnt lgkmcnt(4)
    v_mfma_f32_16x16x32_bf16 v[64:67], a[192:195], a[8:11], v[64:67]
    ds_read_b128 a[176:179], v10 offset:40960
    v_mul_f32 v36, v36, v32
    v_mfma_f32_16x16x32_bf16 v[80:83], a[192:195], a[88:91], v[80:83]
    ds_read_b128 a[180:183], v10 offset:41984
    v_mul_f32 v52, v52, v48
    v_mfma_f32_16x16x32_bf16 v[68:71], a[196:199], a[8:11], v[68:71]
    global_load_lds_dwordx4 v2, s[80:81] offset:0
    ds_read_b128 a[184:187], v10 offset:43008
    v_fma_f32 v112, v112, v164, v164
    v_mfma_f32_16x16x32_bf16 v[84:87], a[196:199], a[88:91], v[84:87]
    ds_read_b128 a[188:191], v10 offset:44032
    v_mfma_f32_16x16x32_bf16 v[72:75], a[200:203], a[8:11], v[72:75]
    v_fma_f32 v136, v136, v170, v170
    v_mfma_f32_16x16x32_bf16 v[88:91], a[200:203], a[88:91], v[88:91]
    v_rcp_f32 v112, v112
    v_mfma_f32_16x16x32_bf16 v[76:79], a[204:207], a[8:11], v[76:79]
    v_rcp_f32 v136, v136
    v_mfma_f32_16x16x32_bf16 v[92:95], a[204:207], a[88:91], v[92:95]
    global_load_lds_dwordx4 v2, s[80:81] offset:1024
    v_mul_f32 v113, v33, v33
    s_waitcnt lgkmcnt(4)
    v_mfma_f32_16x16x32_bf16 v[64:67], a[160:163], a[12:15], v[64:67]
    ds_read_b128 a[192:195], v10 offset:45056
    v_mul_f32 v137, v49, v49
    v_mfma_f32_16x16x32_bf16 v[80:83], a[160:163], a[92:95], v[80:83]
    ds_read_b128 a[196:199], v10 offset:46080
    v_fma_f32 v113, v113, v162, v160
    v_mfma_f32_16x16x32_bf16 v[68:71], a[164:167], a[12:15], v[68:71]
    ds_read_b128 a[200:203], v10 offset:47104
    v_fma_f32 v137, v137, v168, v166
    v_mfma_f32_16x16x32_bf16 v[84:87], a[164:167], a[92:95], v[84:87]
    ds_read_b128 a[204:207], v10 offset:48128
    v_mfma_f32_16x16x32_bf16 v[72:75], a[168:171], a[12:15], v[72:75]
    s_add_u32 s79, s101, 167936
    s_add_u32 m0, s101, 159744
    s_add_u32 s80, s42, s79
    s_addc_u32 s81, s43, 0
    global_load_lds_dwordx4 v2, s[80:81] offset:-4096
    v_mul_f32 v113, v33, v113
    v_mfma_f32_16x16x32_bf16 v[88:91], a[168:171], a[92:95], v[88:91]
    v_mul_f32 v137, v49, v137
    v_mfma_f32_16x16x32_bf16 v[76:79], a[172:175], a[12:15], v[76:79]
    v_exp_f32 v113, v113
    v_mfma_f32_16x16x32_bf16 v[92:95], a[172:175], a[92:95], v[92:95]
    v_exp_f32 v137, v137
    s_waitcnt vmcnt(7)
    s_waitcnt lgkmcnt(0)
    s_barrier
    v_mfma_f32_16x16x32_bf16 v[64:67], a[176:179], a[16:19], v[64:67]
    ds_read_b128 a[160:163], v2 offset:0
    v_mul_f32 v37, v37, v33
    v_mfma_f32_16x16x32_bf16 v[80:83], a[176:179], a[96:99], v[80:83]
    ds_read_b128 a[164:167], v2 offset:1024
    global_load_lds_dwordx4 v2, s[80:81] offset:-3072
    v_mul_f32 v53, v53, v49
    v_mfma_f32_16x16x32_bf16 v[68:71], a[180:183], a[16:19], v[68:71]
    ds_read_b128 a[168:171], v2 offset:2048
    v_fma_f32 v113, v113, v164, v164
    v_mfma_f32_16x16x32_bf16 v[84:87], a[180:183], a[96:99], v[84:87]
    ds_read_b128 a[172:175], v2 offset:3072
    v_fma_f32 v137, v137, v170, v170
    v_mfma_f32_16x16x32_bf16 v[72:75], a[184:187], a[16:19], v[72:75]
    v_rcp_f32 v113, v113
    v_mfma_f32_16x16x32_bf16 v[88:91], a[184:187], a[96:99], v[88:91]
    v_rcp_f32 v137, v137
    v_mfma_f32_16x16x32_bf16 v[76:79], a[188:191], a[16:19], v[76:79]
    v_mul_f32 v36, v36, v112
    v_mfma_f32_16x16x32_bf16 v[92:95], a[188:191], a[96:99], v[92:95]
    s_add_u32 s79, s83, 176128
    s_add_u32 m0, s83, 118784
    s_add_u32 s80, s42, s79
    s_addc_u32 s81, s43, 0
    global_load_lds_dwordx4 v2, s[80:81] offset:-4096
    v_mul_f32 v52, v52, v136
    v_mfma_f32_16x16x32_bf16 v[64:67], a[192:195], a[20:23], v[64:67]
    ds_read_b128 a[176:179], v2 offset:4096
    v_mul_f32 v37, v37, v113
    v_mfma_f32_16x16x32_bf16 v[80:83], a[192:195], a[100:103], v[80:83]
    ds_read_b128 a[180:183], v2 offset:5120
    v_mul_f32 v53, v53, v137
    v_mfma_f32_16x16x32_bf16 v[68:71], a[196:199], a[20:23], v[68:71]
    ds_read_b128 a[184:187], v2 offset:6144
    v_mul_f32 v114, v34, v34
    v_mfma_f32_16x16x32_bf16 v[84:87], a[196:199], a[100:103], v[84:87]
    ds_read_b128 a[188:191], v2 offset:7168
    v_mfma_f32_16x16x32_bf16 v[72:75], a[200:203], a[20:23], v[72:75]
    v_mul_f32 v138, v50, v50
    v_mfma_f32_16x16x32_bf16 v[88:91], a[200:203], a[100:103], v[88:91]
    global_load_lds_dwordx4 v2, s[80:81] offset:-3072
    v_fma_f32 v114, v114, v162, v160
    v_mfma_f32_16x16x32_bf16 v[76:79], a[204:207], a[20:23], v[76:79]
    v_fma_f32 v138, v138, v168, v166
    v_mfma_f32_16x16x32_bf16 v[92:95], a[204:207], a[100:103], v[92:95]
    v_mul_f32 v114, v34, v114
    s_waitcnt lgkmcnt(4)
    v_mfma_f32_16x16x32_bf16 v[64:67], a[160:163], a[24:27], v[64:67]
    ds_read_b128 a[192:195], v2 offset:8192
    v_mul_f32 v138, v50, v138
    v_mfma_f32_16x16x32_bf16 v[80:83], a[160:163], a[104:107], v[80:83]
    ds_read_b128 a[196:199], v2 offset:9216
    v_exp_f32 v114, v114
    v_mfma_f32_16x16x32_bf16 v[68:71], a[164:167], a[24:27], v[68:71]
    ds_read_b128 a[200:203], v2 offset:10240
    v_exp_f32 v138, v138
    global_load_lds_dwordx4 v2, s[80:81] offset:-2048
    v_mfma_f32_16x16x32_bf16 v[84:87], a[164:167], a[104:107], v[84:87]
    ds_read_b128 a[204:207], v2 offset:11264
    v_mfma_f32_16x16x32_bf16 v[72:75], a[168:171], a[24:27], v[72:75]
    v_mul_f32 v38, v38, v34
    v_mfma_f32_16x16x32_bf16 v[88:91], a[168:171], a[104:107], v[88:91]
    v_mul_f32 v54, v54, v50
    v_mfma_f32_16x16x32_bf16 v[76:79], a[172:175], a[24:27], v[76:79]
    v_fma_f32 v114, v114, v164, v164
    v_mfma_f32_16x16x32_bf16 v[92:95], a[172:175], a[104:107], v[92:95]
    v_fma_f32 v138, v138, v170, v170
    s_waitcnt lgkmcnt(4)
    v_mfma_f32_16x16x32_bf16 v[64:67], a[176:179], a[28:31], v[64:67]
    ds_read_b128 a[160:163], v2 offset:12288
    v_rcp_f32 v114, v114
    global_load_lds_dwordx4 v2, s[80:81] offset:-1024
    v_mfma_f32_16x16x32_bf16 v[80:83], a[176:179], a[108:111], v[80:83]
    ds_read_b128 a[164:167], v2 offset:13312
    v_rcp_f32 v138, v138
    v_mfma_f32_16x16x32_bf16 v[68:71], a[180:183], a[28:31], v[68:71]
    ds_read_b128 a[168:171], v2 offset:14336
    v_mul_f32 v115, v35, v35
    v_mfma_f32_16x16x32_bf16 v[84:87], a[180:183], a[108:111], v[84:87]
    ds_read_b128 a[172:175], v2 offset:15360
    v_mfma_f32_16x16x32_bf16 v[72:75], a[184:187], a[28:31], v[72:75]
    v_mul_f32 v139, v51, v51
    v_mfma_f32_16x16x32_bf16 v[88:91], a[184:187], a[108:111], v[88:91]
    v_fma_f32 v115, v115, v162, v160
    v_mfma_f32_16x16x32_bf16 v[76:79], a[188:191], a[28:31], v[76:79]
    v_fma_f32 v139, v139, v168, v166
    s_add_u32 s79, s100, 192512
    s_add_u32 m0, s100, 57344
    s_add_u32 s80, s42, s79
    s_addc_u32 s81, s43, 0
    global_load_lds_dwordx4 v2, s[80:81] offset:-4096
    v_mfma_f32_16x16x32_bf16 v[92:95], a[188:191], a[108:111], v[92:95]
    v_mul_f32 v115, v35, v115
    s_waitcnt lgkmcnt(4)
    v_mfma_f32_16x16x32_bf16 v[64:67], a[192:195], a[32:35], v[64:67]
    ds_read_b128 a[176:179], v2 offset:16384
    v_mul_f32 v139, v51, v139
    v_mfma_f32_16x16x32_bf16 v[80:83], a[192:195], a[112:115], v[80:83]
    ds_read_b128 a[180:183], v2 offset:17408
    v_exp_f32 v115, v115
    v_mfma_f32_16x16x32_bf16 v[68:71], a[196:199], a[32:35], v[68:71]
    ds_read_b128 a[184:187], v2 offset:18432
    v_exp_f32 v139, v139
    v_mfma_f32_16x16x32_bf16 v[84:87], a[196:199], a[112:115], v[84:87]
    ds_read_b128 a[188:191], v2 offset:19456
    v_mul_f32 v39, v39, v35
    v_mfma_f32_16x16x32_bf16 v[72:75], a[200:203], a[32:35], v[72:75]
    global_load_lds_dwordx4 v2, s[80:81] offset:-3072
    v_mul_f32 v55, v55, v51
    v_mfma_f32_16x16x32_bf16 v[88:91], a[200:203], a[112:115], v[88:91]
    v_fma_f32 v115, v115, v164, v164
    v_mfma_f32_16x16x32_bf16 v[76:79], a[204:207], a[32:35], v[76:79]
    v_fma_f32 v139, v139, v170, v170
    v_mfma_f32_16x16x32_bf16 v[92:95], a[204:207], a[112:115], v[92:95]
    v_rcp_f32 v115, v115
    s_waitcnt lgkmcnt(4)
    v_mfma_f32_16x16x32_bf16 v[64:67], a[160:163], a[36:39], v[64:67]
    ds_read_b128 a[192:195], v2 offset:20480
    v_rcp_f32 v139, v139
    v_mfma_f32_16x16x32_bf16 v[80:83], a[160:163], a[116:119], v[80:83]
    ds_read_b128 a[196:199], v2 offset:21504
    v_mul_f32 v38, v38, v114
    global_load_lds_dwordx4 v2, s[80:81] offset:-2048
    v_mfma_f32_16x16x32_bf16 v[68:71], a[164:167], a[36:39], v[68:71]
    ds_read_b128 a[200:203], v2 offset:22528
    v_mul_f32 v54, v54, v138
    v_mfma_f32_16x16x32_bf16 v[84:87], a[164:167], a[116:119], v[84:87]
    ds_read_b128 a[204:207], v2 offset:23552
    v_mfma_f32_16x16x32_bf16 v[72:75], a[168:171], a[36:39], v[72:75]
    v_mul_f32 v39, v39, v115
    v_mfma_f32_16x16x32_bf16 v[88:91], a[168:171], a[116:119], v[88:91]
    v_mul_f32 v55, v55, v139
    v_mfma_f32_16x16x32_bf16 v[76:79], a[172:175], a[36:39], v[76:79]
    v_mul_f32 v116, v40, v40
    v_mfma_f32_16x16x32_bf16 v[92:95], a[172:175], a[116:119], v[92:95]
    v_mul_f32 v140, v56, v56
    s_waitcnt lgkmcnt(4)
    v_mfma_f32_16x16x32_bf16 v[64:67], a[176:179], a[40:43], v[64:67]
    s_add_u32 s79, s98, 204800
    s_add_u32 m0, s98, 135168
    s_add_u32 s80, s42, s79
    s_addc_u32 s81, s43, 0
    global_load_lds_dwordx4 v2, s[80:81] offset:-4096
    ds_read_b128 a[160:163], v2 offset:24576
    v_fma_f32 v116, v116, v162, v160
    v_mfma_f32_16x16x32_bf16 v[80:83], a[176:179], a[120:123], v[80:83]
    ds_read_b128 a[164:167], v2 offset:25600
    v_fma_f32 v140, v140, v168, v166
    v_mfma_f32_16x16x32_bf16 v[68:71], a[180:183], a[40:43], v[68:71]
    ds_read_b128 a[168:171], v2 offset:26624
    v_mul_f32 v116, v40, v116
    v_mfma_f32_16x16x32_bf16 v[84:87], a[180:183], a[120:123], v[84:87]
    ds_read_b128 a[172:175], v2 offset:27648
    v_mfma_f32_16x16x32_bf16 v[72:75], a[184:187], a[40:43], v[72:75]
    v_mul_f32 v140, v56, v140
    v_mfma_f32_16x16x32_bf16 v[88:91], a[184:187], a[120:123], v[88:91]
    v_exp_f32 v116, v116
    global_load_lds_dwordx4 v2, s[80:81] offset:-3072
    v_mfma_f32_16x16x32_bf16 v[76:79], a[188:191], a[40:43], v[76:79]
    v_exp_f32 v140, v140
    v_mfma_f32_16x16x32_bf16 v[92:95], a[188:191], a[120:123], v[92:95]
    v_mul_f32 v44, v44, v40
    s_waitcnt vmcnt(11)
    s_waitcnt lgkmcnt(0)
    s_barrier
    v_mfma_f32_16x16x32_bf16 v[64:67], a[192:195], a[44:47], v[64:67]
    ds_read_b128 a[176:179], v2 offset:28672
    v_mul_f32 v60, v60, v56
    v_mfma_f32_16x16x32_bf16 v[80:83], a[192:195], a[124:127], v[80:83]
    ds_read_b128 a[180:183], v2 offset:29696
    v_fma_f32 v116, v116, v164, v164
    v_mfma_f32_16x16x32_bf16 v[68:71], a[196:199], a[44:47], v[68:71]
    ds_read_b128 a[184:187], v2 offset:30720
    v_fma_f32 v140, v140, v170, v170
    v_mfma_f32_16x16x32_bf16 v[84:87], a[196:199], a[124:127], v[84:87]
    global_load_lds_dwordx4 v2, s[80:81] offset:-2048
    ds_read_b128 a[188:191], v2 offset:31744
    v_mfma_f32_16x16x32_bf16 v[72:75], a[200:203], a[44:47], v[72:75]
    v_rcp_f32 v116, v116
    v_mfma_f32_16x16x32_bf16 v[88:91], a[200:203], a[124:127], v[88:91]
    v_rcp_f32 v140, v140
    v_mfma_f32_16x16x32_bf16 v[76:79], a[204:207], a[44:47], v[76:79]
    v_mul_f32 v117, v41, v41
    v_mfma_f32_16x16x32_bf16 v[92:95], a[204:207], a[124:127], v[92:95]
    v_mul_f32 v141, v57, v57
    v_mfma_f32_16x16x32_bf16 v[64:67], a[160:163], a[48:51], v[64:67]
    ds_read_b128 a[192:195], v2 offset:32768
    v_fma_f32 v117, v117, v162, v160
    v_mfma_f32_16x16x32_bf16 v[80:83], a[160:163], a[128:131], v[80:83]
    global_load_lds_dwordx4 v2, s[80:81] offset:-1024
    ds_read_b128 a[196:199], v2 offset:33792
    v_fma_f32 v141, v141, v168, v166
    v_mfma_f32_16x16x32_bf16 v[68:71], a[164:167], a[48:51], v[68:71]
    ds_read_b128 a[200:203], v2 offset:34816
    v_mul_f32 v117, v41, v117
    v_mfma_f32_16x16x32_bf16 v[84:87], a[164:167], a[128:131], v[84:87]
    ds_read_b128 a[204:207], v2 offset:35840
    v_mul_f32 v141, v57, v141
    v_mfma_f32_16x16x32_bf16 v[72:75], a[168:171], a[48:51], v[72:75]
    v_exp_f32 v117, v117
    v_mfma_f32_16x16x32_bf16 v[88:91], a[168:171], a[128:131], v[88:91]
    v_exp_f32 v141, v141
    v_mfma_f32_16x16x32_bf16 v[76:79], a[172:175], a[48:51], v[76:79]
    v_mul_f32 v45, v45, v41
    global_load_lds_dwordx4 v2, s[80:81] offset:0
    v_mfma_f32_16x16x32_bf16 v[92:95], a[172:175], a[128:131], v[92:95]
    v_mul_f32 v61, v61, v57
    s_waitcnt lgkmcnt(4)
    v_mfma_f32_16x16x32_bf16 v[64:67], a[176:179], a[52:55], v[64:67]
    ds_read_b128 a[160:163], v2 offset:36864
    v_fma_f32 v117, v117, v164, v164
    v_mfma_f32_16x16x32_bf16 v[80:83], a[176:179], a[132:135], v[80:83]
    ds_read_b128 a[164:167], v2 offset:37888
    v_fma_f32 v141, v141, v170, v170
    v_mfma_f32_16x16x32_bf16 v[68:71], a[180:183], a[52:55], v[68:71]
    ds_read_b128 a[168:171], v2 offset:38912
    v_rcp_f32 v117, v117
    v_mfma_f32_16x16x32_bf16 v[84:87], a[180:183], a[132:135], v[84:87]
    ds_read_b128 a[172:175], v2 offset:39936
    v_mfma_f32_16x16x32_bf16 v[72:75], a[184:187], a[52:55], v[72:75]
    global_load_lds_dwordx4 v2, s[80:81] offset:1024
    v_rcp_f32 v141, v141
    v_mfma_f32_16x16x32_bf16 v[88:91], a[184:187], a[132:135], v[88:91]
    v_mul_f32 v44, v44, v116
    v_mfma_f32_16x16x32_bf16 v[76:79], a[188:191], a[52:55], v[76:79]
    v_mul_f32 v60, v60, v140
    v_mfma_f32_16x16x32_bf16 v[92:95], a[188:191], a[132:135], v[92:95]
    v_mul_f32 v45, v45, v117
    s_waitcnt lgkmcnt(4)
    v_mfma_f32_16x16x32_bf16 v[64:67], a[192:195], a[56:59], v[64:67]
    ds_read_b128 a[176:179], v2 offset:40960
    v_mul_f32 v61, v61, v141
    v_mfma_f32_16x16x32_bf16 v[80:83], a[192:195], a[136:139], v[80:83]
    ds_read_b128 a[180:183], v2 offset:41984
    v_mul_f32 v118, v42, v42
    v_mfma_f32_16x16x32_bf16 v[68:71], a[196:199], a[56:59], v[68:71]
    s_mul_i32 s78, s24, 8192
    s_add_u32 s79, s78, 229376
    s_add_u32 m0, s78, 69632
    s_add_u32 s80, s42, s79
    s_addc_u32 s81, s43, 0
    global_load_lds_dwordx4 v2, s[80:81] offset:-4096
    ds_read_b128 a[184:187], v2 offset:43008
    v_mul_f32 v142, v58, v58
    v_mfma_f32_16x16x32_bf16 v[84:87], a[196:199], a[136:139], v[84:87]
    ds_read_b128 a[188:191], v2 offset:44032
    v_mfma_f32_16x16x32_bf16 v[72:75], a[200:203], a[56:59], v[72:75]
    v_fma_f32 v118, v118, v162, v160
    v_mfma_f32_16x16x32_bf16 v[88:91], a[200:203], a[136:139], v[88:91]
    v_fma_f32 v142, v142, v168, v166
    v_mfma_f32_16x16x32_bf16 v[76:79], a[204:207], a[56:59], v[76:79]
    v_mul_f32 v118, v42, v118
    v_mfma_f32_16x16x32_bf16 v[92:95], a[204:207], a[136:139], v[92:95]
    v_mul_f32 v142, v58, v142
    s_waitcnt lgkmcnt(4)
    v_mfma_f32_16x16x32_bf16 v[64:67], a[160:163], a[60:63], v[64:67]
    ds_read_b128 a[192:195], v2 offset:45056
    global_load_lds_dwordx4 v2, s[80:81] offset:-3072
    v_exp_f32 v118, v118
    v_mfma_f32_16x16x32_bf16 v[80:83], a[160:163], a[140:143], v[80:83]
    ds_read_b128 a[196:199], v2 offset:46080
    v_exp_f32 v142, v142
    v_mfma_f32_16x16x32_bf16 v[68:71], a[164:167], a[60:63], v[68:71]
    ds_read_b128 a[200:203], v2 offset:47104
    v_mul_f32 v46, v46, v42
    v_mfma_f32_16x16x32_bf16 v[84:87], a[164:167], a[140:143], v[84:87]
    ds_read_b128 a[204:207], v2 offset:48128
    v_mfma_f32_16x16x32_bf16 v[72:75], a[168:171], a[60:63], v[72:75]
    v_mul_f32 v62, v62, v58
    v_mfma_f32_16x16x32_bf16 v[88:91], a[168:171], a[140:143], v[88:91]
    v_fma_f32 v118, v118, v164, v164
    v_mfma_f32_16x16x32_bf16 v[76:79], a[172:175], a[60:63], v[76:79]
    global_load_lds_dwordx4 v2, s[80:81] offset:-2048
    v_fma_f32 v142, v142, v170, v170
    v_mfma_f32_16x16x32_bf16 v[92:95], a[172:175], a[140:143], v[92:95]
    v_rcp_f32 v118, v118
    s_waitcnt lgkmcnt(4)
    v_mfma_f32_16x16x32_bf16 v[64:67], a[176:179], a[64:67], v[64:67]
    ds_read_b128 a[160:163], v2 offset:49152
    v_rcp_f32 v142, v142
    v_mfma_f32_16x16x32_bf16 v[80:83], a[176:179], a[144:147], v[80:83]
    ds_read_b128 a[164:167], v2 offset:50176
    v_mul_f32 v119, v43, v43
    v_mfma_f32_16x16x32_bf16 v[68:71], a[180:183], a[64:67], v[68:71]
    ds_read_b128 a[168:171], v2 offset:51200
    v_mul_f32 v143, v59, v59
    v_mfma_f32_16x16x32_bf16 v[84:87], a[180:183], a[144:147], v[84:87]
    ds_read_b128 a[172:175], v2 offset:52224
    global_load_lds_dwordx4 v2, s[80:81] offset:-1024
    v_fma_f32 v119, v119, v162, v160
    v_mfma_f32_16x16x32_bf16 v[72:75], a[184:187], a[64:67], v[72:75]
    v_fma_f32 v143, v143, v168, v166
    v_mfma_f32_16x16x32_bf16 v[88:91], a[184:187], a[144:147], v[88:91]
    v_mul_f32 v119, v43, v119
    v_mfma_f32_16x16x32_bf16 v[76:79], a[188:191], a[64:67], v[76:79]
    v_mul_f32 v143, v59, v143
    v_mfma_f32_16x16x32_bf16 v[92:95], a[188:191], a[144:147], v[92:95]
    v_exp_f32 v119, v119
    s_waitcnt vmcnt(17)
    s_waitcnt vmcnt(13)
    s_waitcnt lgkmcnt(0)
    s_barrier
    v_mfma_f32_16x16x32_bf16 v[64:67], a[192:195], a[68:71], v[64:67]
    ds_read_b128 a[176:179], v15 offset:24576
    v_exp_f32 v143, v143
    v_mfma_f32_16x16x32_bf16 v[80:83], a[192:195], a[148:151], v[80:83]
    global_load_lds_dwordx4 v2, s[80:81] offset:0
    ds_read_b128 a[180:183], v15 offset:25600
    v_mul_f32 v47, v47, v43
    v_mfma_f32_16x16x32_bf16 v[68:71], a[196:199], a[68:71], v[68:71]
    ds_read_b128 a[184:187], v15 offset:26624
    v_mul_f32 v63, v63, v59
    v_mfma_f32_16x16x32_bf16 v[84:87], a[196:199], a[148:151], v[84:87]
    ds_read_b128 a[188:191], v15 offset:27648
    v_mfma_f32_16x16x32_bf16 v[72:75], a[200:203], a[68:71], v[72:75]
    v_fma_f32 v119, v119, v164, v164
    v_mfma_f32_16x16x32_bf16 v[88:91], a[200:203], a[148:151], v[88:91]
    v_fma_f32 v143, v143, v170, v170
    v_mfma_f32_16x16x32_bf16 v[76:79], a[204:207], a[68:71], v[76:79]
    v_rcp_f32 v119, v119
    v_mfma_f32_16x16x32_bf16 v[92:95], a[204:207], a[148:151], v[92:95]
    global_load_lds_dwordx4 v2, s[80:81] offset:1024
    v_rcp_f32 v143, v143
    v_mfma_f32_16x16x32_bf16 v[64:67], a[160:163], a[72:75], v[64:67]
    ds_read_b128 a[192:195], v15 offset:28672
    v_mul_f32 v46, v46, v118
    v_mfma_f32_16x16x32_bf16 v[80:83], a[160:163], a[152:155], v[80:83]
    ds_read_b128 a[196:199], v15 offset:29696
    v_mul_f32 v62, v62, v142
    v_mfma_f32_16x16x32_bf16 v[68:71], a[164:167], a[72:75], v[68:71]
    ds_read_b128 a[200:203], v15 offset:30720
    v_mul_f32 v47, v47, v119
    v_mfma_f32_16x16x32_bf16 v[84:87], a[164:167], a[152:155], v[84:87]
    ds_read_b128 a[204:207], v15 offset:31744
    v_mfma_f32_16x16x32_bf16 v[72:75], a[168:171], a[72:75], v[72:75]
    v_mul_f32 v63, v63, v143
    v_mfma_f32_16x16x32_bf16 v[88:91], a[168:171], a[152:155], v[88:91]
    global_load_lds_dwordx4 v2, s[80:81] offset:2048
    v_cvt_pk_bf16_f32 v120, v36, v37
    v_mfma_f32_16x16x32_bf16 v[76:79], a[172:175], a[72:75], v[76:79]
    v_cvt_pk_bf16_f32 v144, v52, v53
    v_mfma_f32_16x16x32_bf16 v[92:95], a[172:175], a[152:155], v[92:95]
    v_cvt_pk_bf16_f32 v121, v38, v39
    s_waitcnt lgkmcnt(4)
    v_mfma_f32_16x16x32_bf16 v[64:67], a[176:179], a[76:79], v[64:67]
    ds_read_b128 a[160:163], v10 offset:49152
    v_cvt_pk_bf16_f32 v145, v54, v55
    v_mfma_f32_16x16x32_bf16 v[80:83], a[176:179], a[156:159], v[80:83]
    ds_read_b128 a[164:167], v10 offset:50176
    v_cvt_pk_bf16_f32 v122, v44, v45
    v_mfma_f32_16x16x32_bf16 v[68:71], a[180:183], a[76:79], v[68:71]
    ds_read_b128 a[168:171], v10 offset:51200
    v_cvt_pk_bf16_f32 v146, v60, v61
    v_mfma_f32_16x16x32_bf16 v[84:87], a[180:183], a[156:159], v[84:87]
    global_load_lds_dwordx4 v2, s[80:81] offset:3072
    ds_read_b128 a[172:175], v10 offset:52224
    v_mfma_f32_16x16x32_bf16 v[72:75], a[184:187], a[76:79], v[72:75]
    v_cvt_pk_bf16_f32 v123, v46, v47
    v_mfma_f32_16x16x32_bf16 v[88:91], a[184:187], a[156:159], v[88:91]
    v_cvt_pk_bf16_f32 v147, v62, v63
    v_mfma_f32_16x16x32_bf16 v[76:79], a[188:191], a[76:79], v[76:79]
    global_store_dwordx4 v2, v[120:123], s[58:59] offset:0
    v_mfma_f32_16x16x32_bf16 v[92:95], a[188:191], a[156:159], v[92:95]
    global_store_dwordx4 v245, v[144:147], s[58:59] offset:0
    s_waitcnt lgkmcnt(4)
    v_mfma_f32_16x16x32_bf16 v[64:67], a[192:195], v[104:107], v[64:67]
    ds_read_b128 a[176:179], v10 offset:53248
    v_mfma_f32_16x16x32_bf16 v[80:83], a[192:195], v[108:111], v[80:83]
    s_add_u32 s79, s83, 4096
    s_add_u32 m0, s83, 102400
    s_add_u32 s80, s44, s79
    s_addc_u32 s81, s45, 0
    global_load_lds_dwordx4 v2, s[80:81] offset:-4096
    ds_read_b128 a[180:183], v10 offset:54272
    v_mfma_f32_16x16x32_bf16 v[68:71], a[196:199], v[104:107], v[68:71]
    ds_read_b128 a[184:187], v10 offset:55296
    v_mfma_f32_16x16x32_bf16 v[84:87], a[196:199], v[108:111], v[84:87]
    ds_read_b128 a[188:191], v10 offset:56320
    v_mfma_f32_16x16x32_bf16 v[72:75], a[200:203], v[104:107], v[72:75]
    v_mfma_f32_16x16x32_bf16 v[88:91], a[200:203], v[108:111], v[88:91]
    global_load_lds_dwordx4 v2, s[80:81] offset:-3072
    v_mfma_f32_16x16x32_bf16 v[76:79], a[204:207], v[104:107], v[76:79]
    v_mfma_f32_16x16x32_bf16 v[92:95], a[204:207], v[108:111], v[92:95]
    s_waitcnt lgkmcnt(4)
    v_mfma_f32_16x16x32_bf16 v[32:35], a[160:163], a[0:3], 0
    ds_read_b128 a[192:195], v10 offset:57344
    v_mfma_f32_16x16x32_bf16 v[48:51], a[160:163], a[80:83], 0
    global_load_lds_dwordx4 v2, s[80:81] offset:-2048
    ds_read_b128 a[196:199], v10 offset:58368
    v_mfma_f32_16x16x32_bf16 v[36:39], a[164:167], a[0:3], 0
    ds_read_b128 a[200:203], v10 offset:59392
    v_mfma_f32_16x16x32_bf16 v[52:55], a[164:167], a[80:83], 0
    ds_read_b128 a[204:207], v10 offset:60416
    v_mfma_f32_16x16x32_bf16 v[40:43], a[168:171], a[0:3], 0
    v_mfma_f32_16x16x32_bf16 v[56:59], a[168:171], a[80:83], 0
    global_load_lds_dwordx4 v2, s[80:81] offset:-1024
    v_mfma_f32_16x16x32_bf16 v[44:47], a[172:175], a[0:3], 0
    v_mfma_f32_16x16x32_bf16 v[60:63], a[172:175], a[80:83], 0
    s_waitcnt lgkmcnt(4)
    v_mfma_f32_16x16x32_bf16 v[32:35], a[176:179], a[4:7], v[32:35]
    ds_read_b128 a[160:163], v10 offset:61440
    v_mul_f32 v112, v64, v64
    s_add_u32 s79, s99, 20480
    s_add_u32 m0, s99, 4096
    s_add_u32 s80, s44, s79
    s_addc_u32 s81, s45, 0
    global_load_lds_dwordx4 v2, s[80:81] offset:-4096
    v_mfma_f32_16x16x32_bf16 v[48:51], a[176:179], a[84:87], v[48:51]
    ds_read_b128 a[164:167], v10 offset:62464
    v_mul_f32 v136, v80, v80
    v_mfma_f32_16x16x32_bf16 v[36:39], a[180:183], a[4:7], v[36:39]
    ds_read_b128 a[168:171], v10 offset:63488
    v_fma_f32 v112, v112, v162, v160
    v_mfma_f32_16x16x32_bf16 v[52:55], a[180:183], a[84:87], v[52:55]
    ds_read_b128 a[172:175], v10 offset:64512
    v_fma_f32 v136, v136, v168, v166
    global_load_lds_dwordx4 v2, s[80:81] offset:-3072
    v_mfma_f32_16x16x32_bf16 v[40:43], a[184:187], a[4:7], v[40:43]
    v_mul_f32 v112, v64, v112
    v_mfma_f32_16x16x32_bf16 v[56:59], a[184:187], a[84:87], v[56:59]
    v_mul_f32 v136, v80, v136
    v_mfma_f32_16x16x32_bf16 v[44:47], a[188:191], a[4:7], v[44:47]
    v_exp_f32 v112, v112
    v_mfma_f32_16x16x32_bf16 v[60:63], a[188:191], a[84:87], v[60:63]
    global_load_lds_dwordx4 v2, s[80:81] offset:-2048
    v_exp_f32 v136, v136
    s_waitcnt vmcnt(23)
    s_waitcnt lgkmcnt(0)
    s_barrier
    v_mfma_f32_16x16x32_bf16 v[32:35], a[192:195], a[8:11], v[32:35]
    ds_read_b128 a[176:179], v2 offset:53248
    v_mul_f32 v68, v68, v64
    v_mfma_f32_16x16x32_bf16 v[48:51], a[192:195], a[88:91], v[48:51]
    ds_read_b128 a[180:183], v2 offset:54272
    v_mul_f32 v84, v84, v80
    v_mfma_f32_16x16x32_bf16 v[36:39], a[196:199], a[8:11], v[36:39]
    global_load_lds_dwordx4 v2, s[80:81] offset:-1024
    ds_read_b128 a[184:187], v2 offset:55296
    v_fma_f32 v112, v112, v164, v164
    v_mfma_f32_16x16x32_bf16 v[52:55], a[196:199], a[88:91], v[52:55]
    ds_read_b128 a[188:191], v2 offset:56320
    v_mfma_f32_16x16x32_bf16 v[40:43], a[200:203], a[8:11], v[40:43]
    v_fma_f32 v136, v136, v170, v170
    v_mfma_f32_16x16x32_bf16 v[56:59], a[200:203], a[88:91], v[56:59]
    global_load_lds_dwordx4 v2, s[80:81] offset:0
    v_rcp_f32 v112, v112
    v_mfma_f32_16x16x32_bf16 v[44:47], a[204:207], a[8:11], v[44:47]
    v_rcp_f32 v136, v136
    v_mfma_f32_16x16x32_bf16 v[60:63], a[204:207], a[88:91], v[60:63]
    v_mul_f32 v113, v65, v65
    v_mfma_f32_16x16x32_bf16 v[32:35], a[160:163], a[12:15], v[32:35]
    global_load_lds_dwordx4 v2, s[80:81] offset:1024
    ds_read_b128 a[192:195], v2 offset:57344
    v_mul_f32 v137, v81, v81
    v_mfma_f32_16x16x32_bf16 v[48:51], a[160:163], a[92:95], v[48:51]
    ds_read_b128 a[196:199], v2 offset:58368
    v_fma_f32 v113, v113, v162, v160
    v_mfma_f32_16x16x32_bf16 v[36:39], a[164:167], a[12:15], v[36:39]
    ds_read_b128 a[200:203], v2 offset:59392
    v_fma_f32 v137, v137, v168, v166
    v_mfma_f32_16x16x32_bf16 v[52:55], a[164:167], a[92:95], v[52:55]
    global_load_lds_dwordx4 v2, s[80:81] offset:2048
    ds_read_b128 a[204:207], v2 offset:60416
    v_mfma_f32_16x16x32_bf16 v[40:43], a[168:171], a[12:15], v[40:43]
    v_mul_f32 v113, v65, v113
    v_mfma_f32_16x16x32_bf16 v[56:59], a[168:171], a[92:95], v[56:59]
    v_mul_f32 v137, v81, v137
    v_mfma_f32_16x16x32_bf16 v[44:47], a[172:175], a[12:15], v[44:47]
    v_exp_f32 v113, v113
    s_add_u32 s79, s98, 49152
    s_add_u32 m0, s98, 32768
    s_add_u32 s80, s44, s79
    s_addc_u32 s81, s45, 0
    global_load_lds_dwordx4 v2, s[80:81] offset:-4096
    v_mfma_f32_16x16x32_bf16 v[60:63], a[172:175], a[92:95], v[60:63]
    v_exp_f32 v137, v137
    s_waitcnt lgkmcnt(4)
    v_mfma_f32_16x16x32_bf16 v[32:35], a[176:179], a[16:19], v[32:35]
    ds_read_b128 a[160:163], v2 offset:61440
    v_mul_f32 v69, v69, v65
    v_mfma_f32_16x16x32_bf16 v[48:51], a[176:179], a[96:99], v[48:51]
    global_load_lds_dwordx4 v2, s[80:81] offset:-3072
    ds_read_b128 a[164:167], v2 offset:62464
    v_mul_f32 v85, v85, v81
    v_mfma_f32_16x16x32_bf16 v[36:39], a[180:183], a[16:19], v[36:39]
    ds_read_b128 a[168:171], v2 offset:63488
    v_fma_f32 v113, v113, v164, v164
    v_mfma_f32_16x16x32_bf16 v[52:55], a[180:183], a[96:99], v[52:55]
    ds_read_b128 a[172:175], v2 offset:64512
    v_fma_f32 v137, v137, v170, v170
    v_mfma_f32_16x16x32_bf16 v[40:43], a[184:187], a[16:19], v[40:43]
    global_load_lds_dwordx4 v2, s[80:81] offset:-2048
    v_rcp_f32 v113, v113
    v_mfma_f32_16x16x32_bf16 v[56:59], a[184:187], a[96:99], v[56:59]
    v_rcp_f32 v137, v137
    v_mfma_f32_16x16x32_bf16 v[44:47], a[188:191], a[16:19], v[44:47]
    v_mul_f32 v68, v68, v112
    v_mfma_f32_16x16x32_bf16 v[60:63], a[188:191], a[96:99], v[60:63]
    global_load_lds_dwordx4 v2, s[80:81] offset:-1024
    v_mul_f32 v84, v84, v136
    s_waitcnt vmcnt(25)
    s_waitcnt lgkmcnt(0)
    s_barrier
    v_mfma_f32_16x16x32_bf16 v[32:35], a[192:195], a[20:23], v[32:35]
    ds_read_b128 a[176:179], v15 offset:0
    v_mul_f32 v69, v69, v113
    v_mfma_f32_16x16x32_bf16 v[48:51], a[192:195], a[100:103], v[48:51]
    ds_read_b128 a[180:183], v15 offset:1024
    v_mul_f32 v85, v85, v137
    v_mfma_f32_16x16x32_bf16 v[36:39], a[196:199], a[20:23], v[36:39]
    ds_read_b128 a[184:187], v15 offset:2048
    global_load_lds_dwordx4 v2, s[80:81] offset:0
    v_mul_f32 v114, v66, v66
    v_mfma_f32_16x16x32_bf16 v[52:55], a[196:199], a[100:103], v[52:55]
    ds_read_b128 a[188:191], v15 offset:3072
    v_mfma_f32_16x16x32_bf16 v[40:43], a[200:203], a[20:23], v[40:43]
    v_mul_f32 v138, v82, v82
    v_mfma_f32_16x16x32_bf16 v[56:59], a[200:203], a[100:103], v[56:59]
    v_fma_f32 v114, v114, v162, v160
    v_mfma_f32_16x16x32_bf16 v[44:47], a[204:207], a[20:23], v[44:47]
    global_load_lds_dwordx4 v2, s[80:81] offset:1024
    v_fma_f32 v138, v138, v168, v166
    v_mfma_f32_16x16x32_bf16 v[60:63], a[204:207], a[100:103], v[60:63]
    v_mul_f32 v114, v66, v114
    v_mfma_f32_16x16x32_bf16 v[32:35], a[160:163], a[24:27], v[32:35]
    ds_read_b128 a[192:195], v15 offset:4096
    v_mul_f32 v138, v82, v138
    v_mfma_f32_16x16x32_bf16 v[48:51], a[160:163], a[104:107], v[48:51]
    s_add_u32 s79, s101, 73728
    s_add_u32 m0, s101, 159744
    s_add_u32 s80, s44, s79
    s_addc_u32 s81, s45, 0
    global_load_lds_dwordx4 v2, s[80:81] offset:-4096
    ds_read_b128 a[196:199], v15 offset:5120
    v_exp_f32 v114, v114
    v_mfma_f32_16x16x32_bf16 v[36:39], a[164:167], a[24:27], v[36:39]
    ds_read_b128 a[200:203], v15 offset:6144
    v_exp_f32 v138, v138
    v_mfma_f32_16x16x32_bf16 v[52:55], a[164:167], a[104:107], v[52:55]
    ds_read_b128 a[204:207], v15 offset:7168
    v_mfma_f32_16x16x32_bf16 v[40:43], a[168:171], a[24:27], v[40:43]
    global_load_lds_dwordx4 v2, s[80:81] offset:-3072
    v_mul_f32 v70, v70, v66
    v_mfma_f32_16x16x32_bf16 v[56:59], a[168:171], a[104:107], v[56:59]
    v_mul_f32 v86, v86, v82
    v_mfma_f32_16x16x32_bf16 v[44:47], a[172:175], a[24:27], v[44:47]
    v_fma_f32 v114, v114, v164, v164
    v_mfma_f32_16x16x32_bf16 v[60:63], a[172:175], a[104:107], v[60:63]
    s_add_u32 s79, s83, 81920
    s_add_u32 m0, s83, 118784
    s_add_u32 s80, s44, s79
    s_addc_u32 s81, s45, 0
    global_load_lds_dwordx4 v2, s[80:81] offset:-4096
    v_fma_f32 v138, v138, v170, v170
    s_waitcnt lgkmcnt(4)
    v_mfma_f32_16x16x32_bf16 v[32:35], a[176:179], a[28:31], v[32:35]
    ds_read_b128 a[160:163], v15 offset:8192
    v_rcp_f32 v114, v114
    v_mfma_f32_16x16x32_bf16 v[48:51], a[176:179], a[108:111], v[48:51]
    ds_read_b128 a[164:167], v15 offset:9216
    v_rcp_f32 v138, v138
    v_mfma_f32_16x16x32_bf16 v[36:39], a[180:183], a[28:31], v[36:39]
    global_load_lds_dwordx4 v2, s[80:81] offset:-3072
    ds_read_b128 a[168:171], v15 offset:10240
    v_mul_f32 v115, v67, v67
    v_mfma_f32_16x16x32_bf16 v[52:55], a[180:183], a[108:111], v[52:55]
    ds_read_b128 a[172:175], v15 offset:11264
    v_mfma_f32_16x16x32_bf16 v[40:43], a[184:187], a[28:31], v[40:43]
    v_mul_f32 v139, v83, v83
    v_mfma_f32_16x16x32_bf16 v[56:59], a[184:187], a[108:111], v[56:59]
    global_load_lds_dwordx4 v2, s[80:81] offset:-2048
    v_fma_f32 v115, v115, v162, v160
    v_mfma_f32_16x16x32_bf16 v[44:47], a[188:191], a[28:31], v[44:47]
    v_fma_f32 v139, v139, v168, v166
    v_mfma_f32_16x16x32_bf16 v[60:63], a[188:191], a[108:111], v[60:63]
    v_mul_f32 v115, v67, v115
    s_waitcnt lgkmcnt(4)
    v_mfma_f32_16x16x32_bf16 v[32:35], a[192:195], a[32:35], v[32:35]
    ds_read_b128 a[176:179], v15 offset:12288
    v_mul_f32 v139, v83, v139
    global_load_lds_dwordx4 v2, s[80:81] offset:-1024
    v_mfma_f32_16x16x32_bf16 v[48:51], a[192:195], a[112:115], v[48:51]
    ds_read_b128 a[180:183], v15 offset:13312
    v_exp_f32 v115, v115
    v_mfma_f32_16x16x32_bf16 v[36:39], a[196:199], a[32:35], v[36:39]
    ds_read_b128 a[184:187], v15 offset:14336
    v_exp_f32 v139, v139
    v_mfma_f32_16x16x32_bf16 v[52:55], a[196:199], a[112:115], v[52:55]
    s_add_u32 s79, s100, 98304
    s_add_u32 m0, s100, 57344
    s_add_u32 s80, s44, s79
    s_addc_u32 s81, s45, 0
    global_load_lds_dwordx4 v2, s[80:81] offset:-4096
    ds_read_b128 a[188:191], v15 offset:15360
    v_mul_f32 v71, v71, v67
    v_mfma_f32_16x16x32_bf16 v[40:43], a[200:203], a[32:35], v[40:43]
    v_mul_f32 v87, v87, v83
    v_mfma_f32_16x16x32_bf16 v[56:59], a[200:203], a[112:115], v[56:59]
    v_fma_f32 v115, v115, v164, v164
    v_mfma_f32_16x16x32_bf16 v[44:47], a[204:207], a[32:35], v[44:47]
    v_fma_f32 v139, v139, v170, v170
    global_load_lds_dwordx4 v2, s[80:81] offset:-3072
    v_mfma_f32_16x16x32_bf16 v[60:63], a[204:207], a[112:115], v[60:63]
    v_rcp_f32 v115, v115
    s_waitcnt lgkmcnt(4)
    v_mfma_f32_16x16x32_bf16 v[32:35], a[160:163], a[36:39], v[32:35]
    ds_read_b128 a[192:195], v15 offset:16384
    v_rcp_f32 v139, v139
    v_mfma_f32_16x16x32_bf16 v[48:51], a[160:163], a[116:119], v[48:51]
    ds_read_b128 a[196:199], v15 offset:17408
    global_load_lds_dwordx4 v2, s[80:81] offset:-2048
    v_mul_f32 v70, v70, v114
    v_mfma_f32_16x16x32_bf16 v[36:39], a[164:167], a[36:39], v[36:39]
    ds_read_b128 a[200:203], v15 offset:18432
    v_mul_f32 v86, v86, v138
    v_mfma_f32_16x16x32_bf16 v[52:55], a[164:167], a[116:119], v[52:55]
    ds_read_b128 a[204:207], v15 offset:19456
    v_mfma_f32_16x16x32_bf16 v[40:43], a[168:171], a[36:39], v[40:43]
    v_mul_f32 v71, v71, v115
    v_mfma_f32_16x16x32_bf16 v[56:59], a[168:171], a[116:119], v[56:59]
    v_mul_f32 v87, v87, v139
    v_mfma_f32_16x16x32_bf16 v[44:47], a[172:175], a[36:39], v[44:47]
    v_mul_f32 v116, v72, v72
    v_mfma_f32_16x16x32_bf16 v[60:63], a[172:175], a[116:119], v[60:63]
    v_mul_f32 v140, v88, v88
    s_waitcnt lgkmcnt(4)
    v_mfma_f32_16x16x32_bf16 v[32:35], a[176:179], a[40:43], v[32:35]
    ds_read_b128 a[160:163], v15 offset:20480
    v_fma_f32 v116, v116, v162, v160
    v_mfma_f32_16x16x32_bf16 v[48:51], a[176:179], a[120:123], v[48:51]
    ds_read_b128 a[164:167], v15 offset:21504
    v_fma_f32 v140, v140, v168, v166
    v_mfma_f32_16x16x32_bf16 v[36:39], a[180:183], a[40:43], v[36:39]
    ds_read_b128 a[168:171], v15 offset:22528
    v_mul_f32 v116, v72, v116
    v_mfma_f32_16x16x32_bf16 v[52:55], a[180:183], a[120:123], v[52:55]
    ds_read_b128 a[172:175], v15 offset:23552
    v_mfma_f32_16x16x32_bf16 v[40:43], a[184:187], a[40:43], v[40:43]
    v_mul_f32 v140, v88, v140
    v_mfma_f32_16x16x32_bf16 v[56:59], a[184:187], a[120:123], v[56:59]
    v_exp_f32 v116, v116
    v_mfma_f32_16x16x32_bf16 v[44:47], a[188:191], a[40:43], v[44:47]
    v_exp_f32 v140, v140
    v_mfma_f32_16x16x32_bf16 v[60:63], a[188:191], a[120:123], v[60:63]
    v_mul_f32 v76, v76, v72
    s_waitcnt vmcnt(28)
    s_waitcnt lgkmcnt(0)
    s_barrier
    s_add_u32 s79, s98, 110592
    s_add_u32 m0, s98, 135168
    s_add_u32 s80, s44, s79
    s_addc_u32 s81, s45, 0
    global_load_lds_dwordx4 v2, s[80:81] offset:-4096
    global_load_lds_dwordx4 v2, s[80:81] offset:-3072
    v_mfma_f32_16x16x32_bf16 v[32:35], a[192:195], a[44:47], v[32:35]
    ds_read_b128 a[176:179], v10 offset:0
    v_mul_f32 v92, v92, v88
    v_mfma_f32_16x16x32_bf16 v[48:51], a[192:195], a[124:127], v[48:51]
    global_load_lds_dwordx4 v2, s[80:81] offset:-2048
    ds_read_b128 a[180:183], v10 offset:1024
    v_fma_f32 v116, v116, v164, v164
    v_mfma_f32_16x16x32_bf16 v[36:39], a[196:199], a[44:47], v[36:39]
    ds_read_b128 a[184:187], v10 offset:2048
    v_fma_f32 v140, v140, v170, v170
    v_mfma_f32_16x16x32_bf16 v[52:55], a[196:199], a[124:127], v[52:55]
    ds_read_b128 a[188:191], v10 offset:3072
    v_mfma_f32_16x16x32_bf16 v[40:43], a[200:203], a[44:47], v[40:43]
    global_load_lds_dwordx4 v2, s[80:81] offset:-1024
    v_rcp_f32 v116, v116
    v_mfma_f32_16x16x32_bf16 v[56:59], a[200:203], a[124:127], v[56:59]
    v_rcp_f32 v140, v140
    v_mfma_f32_16x16x32_bf16 v[44:47], a[204:207], a[44:47], v[44:47]
    v_mul_f32 v117, v73, v73
    v_mfma_f32_16x16x32_bf16 v[60:63], a[204:207], a[124:127], v[60:63]
    global_load_lds_dwordx4 v2, s[80:81] offset:0
    v_mul_f32 v141, v89, v89
    v_mfma_f32_16x16x32_bf16 v[32:35], a[160:163], a[48:51], v[32:35]
    ds_read_b128 a[192:195], v10 offset:4096
    v_fma_f32 v117, v117, v162, v160
    v_mfma_f32_16x16x32_bf16 v[48:51], a[160:163], a[128:131], v[48:51]
    ds_read_b128 a[196:199], v10 offset:5120
    v_fma_f32 v141, v141, v168, v166
    v_mfma_f32_16x16x32_bf16 v[36:39], a[164:167], a[48:51], v[36:39]
    ds_read_b128 a[200:203], v10 offset:6144
    global_load_lds_dwordx4 v2, s[80:81] offset:1024
    v_mul_f32 v117, v73, v117
    v_mfma_f32_16x16x32_bf16 v[52:55], a[164:167], a[128:131], v[52:55]
    ds_read_b128 a[204:207], v10 offset:7168
    v_mul_f32 v141, v89, v141
    v_mfma_f32_16x16x32_bf16 v[40:43], a[168:171], a[48:51], v[40:43]
    v_exp_f32 v117, v117
    v_mfma_f32_16x16x32_bf16 v[56:59], a[168:171], a[128:131], v[56:59]
    v_exp_f32 v141, v141
    v_mfma_f32_16x16x32_bf16 v[44:47], a[172:175], a[48:51], v[44:47]
    v_mul_f32 v77, v77, v73
    v_mfma_f32_16x16x32_bf16 v[60:63], a[172:175], a[128:131], v[60:63]
    v_mul_f32 v93, v93, v89
    s_waitcnt lgkmcnt(4)
    v_mfma_f32_16x16x32_bf16 v[32:35], a[176:179], a[52:55], v[32:35]
    ds_read_b128 a[160:163], v10 offset:8192
    v_fma_f32 v117, v117, v164, v164
    v_mfma_f32_16x16x32_bf16 v[48:51], a[176:179], a[132:135], v[48:51]
    ds_read_b128 a[164:167], v10 offset:9216
    v_fma_f32 v141, v141, v170, v170
    v_mfma_f32_16x16x32_bf16 v[36:39], a[180:183], a[52:55], v[36:39]
    ds_read_b128 a[168:171], v10 offset:10240
    v_rcp_f32 v117, v117
    v_mfma_f32_16x16x32_bf16 v[52:55], a[180:183], a[132:135], v[52:55]
    ds_read_b128 a[172:175], v10 offset:11264
    v_mfma_f32_16x16x32_bf16 v[40:43], a[184:187], a[52:55], v[40:43]
    v_rcp_f32 v141, v141
    v_mfma_f32_16x16x32_bf16 v[56:59], a[184:187], a[132:135], v[56:59]
    v_mul_f32 v76, v76, v116
    v_mfma_f32_16x16x32_bf16 v[44:47], a[188:191], a[52:55], v[44:47]
    v_mul_f32 v92, v92, v140
    v_mfma_f32_16x16x32_bf16 v[60:63], a[188:191], a[132:135], v[60:63]
    v_mul_f32 v77, v77, v117
    s_waitcnt lgkmcnt(4)
    v_mfma_f32_16x16x32_bf16 v[32:35], a[192:195], a[56:59], v[32:35]
    ds_read_b128 a[176:179], v10 offset:12288
    v_mul_f32 v93, v93, v141
    v_mfma_f32_16x16x32_bf16 v[48:51], a[192:195], a[136:139], v[48:51]
    ds_read_b128 a[180:183], v10 offset:13312
    v_mul_f32 v118, v74, v74
    v_mfma_f32_16x16x32_bf16 v[36:39], a[196:199], a[56:59], v[36:39]
    ds_read_b128 a[184:187], v10 offset:14336
    v_mul_f32 v142, v90, v90
    v_mfma_f32_16x16x32_bf16 v[52:55], a[196:199], a[136:139], v[52:55]
    ds_read_b128 a[188:191], v10 offset:15360
    v_mfma_f32_16x16x32_bf16 v[40:43], a[200:203], a[56:59], v[40:43]
    v_fma_f32 v118, v118, v162, v160
    v_mfma_f32_16x16x32_bf16 v[56:59], a[200:203], a[136:139], v[56:59]
    v_fma_f32 v142, v142, v168, v166
    v_mfma_f32_16x16x32_bf16 v[44:47], a[204:207], a[56:59], v[44:47]
    v_mul_f32 v118, v74, v118
    v_mfma_f32_16x16x32_bf16 v[60:63], a[204:207], a[136:139], v[60:63]
    v_mul_f32 v142, v90, v142
    s_waitcnt lgkmcnt(4)
    v_mfma_f32_16x16x32_bf16 v[32:35], a[160:163], a[60:63], v[32:35]
    ds_read_b128 a[192:195], v10 offset:16384
    v_exp_f32 v118, v118
    v_mfma_f32_16x16x32_bf16 v[48:51], a[160:163], a[140:143], v[48:51]
    ds_read_b128 a[196:199], v10 offset:17408
    v_exp_f32 v142, v142
    v_mfma_f32_16x16x32_bf16 v[36:39], a[164:167], a[60:63], v[36:39]
    ds_read_b128 a[200:203], v10 offset:18432
    v_mul_f32 v78, v78, v74
    v_mfma_f32_16x16x32_bf16 v[52:55], a[164:167], a[140:143], v[52:55]
    ds_read_b128 a[204:207], v10 offset:19456
    v_mfma_f32_16x16x32_bf16 v[40:43], a[168:171], a[60:63], v[40:43]
    v_mul_f32 v94, v94, v90
    v_mfma_f32_16x16x32_bf16 v[56:59], a[168:171], a[140:143], v[56:59]
    v_fma_f32 v118, v118, v164, v164
    v_mfma_f32_16x16x32_bf16 v[44:47], a[172:175], a[60:63], v[44:47]
    v_fma_f32 v142, v142, v170, v170
    v_mfma_f32_16x16x32_bf16 v[60:63], a[172:175], a[140:143], v[60:63]
    v_rcp_f32 v118, v118
    s_waitcnt lgkmcnt(4)
    v_mfma_f32_16x16x32_bf16 v[32:35], a[176:179], a[64:67], v[32:35]
    ds_read_b128 a[160:163], v10 offset:20480
    v_rcp_f32 v142, v142
    v_mfma_f32_16x16x32_bf16 v[48:51], a[176:179], a[144:147], v[48:51]
    ds_read_b128 a[164:167], v10 offset:21504
    v_mul_f32 v119, v75, v75
    v_mfma_f32_16x16x32_bf16 v[36:39], a[180:183], a[64:67], v[36:39]
    ds_read_b128 a[168:171], v10 offset:22528
    v_mul_f32 v143, v91, v91
    v_mfma_f32_16x16x32_bf16 v[52:55], a[180:183], a[144:147], v[52:55]
    ds_read_b128 a[172:175], v10 offset:23552
    v_fma_f32 v119, v119, v162, v160
    v_mfma_f32_16x16x32_bf16 v[40:43], a[184:187], a[64:67], v[40:43]
    v_fma_f32 v143, v143, v168, v166
    v_mfma_f32_16x16x32_bf16 v[56:59], a[184:187], a[144:147], v[56:59]
    v_mul_f32 v119, v75, v119
    v_mfma_f32_16x16x32_bf16 v[44:47], a[188:191], a[64:67], v[44:47]
    v_mul_f32 v143, v91, v143
    v_mfma_f32_16x16x32_bf16 v[60:63], a[188:191], a[144:147], v[60:63]
    v_exp_f32 v119, v119
    s_waitcnt lgkmcnt(4)
    v_mfma_f32_16x16x32_bf16 v[32:35], a[192:195], a[68:71], v[32:35]
    ds_read_b128 a[176:179], v10 offset:24576
    v_exp_f32 v143, v143
    v_mfma_f32_16x16x32_bf16 v[48:51], a[192:195], a[148:151], v[48:51]
    ds_read_b128 a[180:183], v10 offset:25600
    v_mul_f32 v79, v79, v75
    v_mfma_f32_16x16x32_bf16 v[36:39], a[196:199], a[68:71], v[36:39]
    ds_read_b128 a[184:187], v10 offset:26624
    v_mul_f32 v95, v95, v91
    v_mfma_f32_16x16x32_bf16 v[52:55], a[196:199], a[148:151], v[52:55]
    ds_read_b128 a[188:191], v10 offset:27648
    v_mfma_f32_16x16x32_bf16 v[40:43], a[200:203], a[68:71], v[40:43]
    v_fma_f32 v119, v119, v164, v164
    v_mfma_f32_16x16x32_bf16 v[56:59], a[200:203], a[148:151], v[56:59]
    v_fma_f32 v143, v143, v170, v170
    v_mfma_f32_16x16x32_bf16 v[44:47], a[204:207], a[68:71], v[44:47]
    v_rcp_f32 v119, v119
    v_mfma_f32_16x16x32_bf16 v[60:63], a[204:207], a[148:151], v[60:63]
    v_rcp_f32 v143, v143
    s_waitcnt lgkmcnt(4)
    v_mfma_f32_16x16x32_bf16 v[32:35], a[160:163], a[72:75], v[32:35]
    ds_read_b128 a[192:195], v10 offset:28672
    v_mul_f32 v78, v78, v118
    v_mfma_f32_16x16x32_bf16 v[48:51], a[160:163], a[152:155], v[48:51]
    ds_read_b128 a[196:199], v10 offset:29696
    v_mul_f32 v94, v94, v142
    v_mfma_f32_16x16x32_bf16 v[36:39], a[164:167], a[72:75], v[36:39]
    ds_read_b128 a[200:203], v10 offset:30720
    v_mul_f32 v79, v79, v119
    v_mfma_f32_16x16x32_bf16 v[52:55], a[164:167], a[152:155], v[52:55]
    ds_read_b128 a[204:207], v10 offset:31744
    v_mfma_f32_16x16x32_bf16 v[40:43], a[168:171], a[72:75], v[40:43]
    v_mul_f32 v95, v95, v143
    v_mfma_f32_16x16x32_bf16 v[56:59], a[168:171], a[152:155], v[56:59]
    v_cvt_pk_bf16_f32 v120, v68, v69
    v_mfma_f32_16x16x32_bf16 v[44:47], a[172:175], a[72:75], v[44:47]
    v_cvt_pk_bf16_f32 v144, v84, v85
    v_mfma_f32_16x16x32_bf16 v[60:63], a[172:175], a[152:155], v[60:63]
    v_cvt_pk_bf16_f32 v121, v70, v71
    s_waitcnt lgkmcnt(4)
    v_mfma_f32_16x16x32_bf16 v[32:35], a[176:179], a[76:79], v[32:35]
    v_cvt_pk_bf16_f32 v145, v86, v87
    v_mfma_f32_16x16x32_bf16 v[48:51], a[176:179], a[156:159], v[48:51]
    v_cvt_pk_bf16_f32 v122, v76, v77
    v_mfma_f32_16x16x32_bf16 v[36:39], a[180:183], a[76:79], v[36:39]
    v_cvt_pk_bf16_f32 v146, v92, v93
    v_mfma_f32_16x16x32_bf16 v[52:55], a[180:183], a[156:159], v[52:55]
    v_cvt_pk_bf16_f32 v123, v78, v79
    v_mfma_f32_16x16x32_bf16 v[40:43], a[184:187], a[76:79], v[40:43]
    v_cvt_pk_bf16_f32 v147, v94, v95
    v_mfma_f32_16x16x32_bf16 v[56:59], a[184:187], a[156:159], v[56:59]
    global_store_dwordx4 v2, v[120:123], s[58:59] offset:1024
    v_mfma_f32_16x16x32_bf16 v[44:47], a[188:191], a[76:79], v[44:47]
    global_store_dwordx4 v245, v[144:147], s[58:59] offset:1024
    v_mfma_f32_16x16x32_bf16 v[60:63], a[188:191], a[156:159], v[60:63]
    s_waitcnt lgkmcnt(0)
    v_mfma_f32_16x16x32_bf16 v[32:35], a[192:195], v[104:107], v[32:35]
    v_mfma_f32_16x16x32_bf16 v[48:51], a[192:195], v[108:111], v[48:51]
    v_mfma_f32_16x16x32_bf16 v[36:39], a[196:199], v[104:107], v[36:39]
    v_mfma_f32_16x16x32_bf16 v[52:55], a[196:199], v[108:111], v[52:55]
    v_mfma_f32_16x16x32_bf16 v[40:43], a[200:203], v[104:107], v[40:43]
    v_mfma_f32_16x16x32_bf16 v[56:59], a[200:203], v[108:111], v[56:59]
    v_mfma_f32_16x16x32_bf16 v[44:47], a[204:207], v[104:107], v[44:47]
    v_mfma_f32_16x16x32_bf16 v[60:63], a[204:207], v[108:111], v[60:63]
    s_barrier
    v_pk_mul_f32 v[112:113], v[32:33], v[32:33]
    v_pk_mul_f32 v[136:137], v[48:49], v[48:49]
    v_pk_fma_f32 v[112:113], v[112:113], v[162:163], v[160:161] op_sel_hi:[1,0,0]
    v_pk_fma_f32 v[136:137], v[136:137], v[168:169], v[166:167] op_sel_hi:[1,0,0]
    v_pk_mul_f32 v[112:113], v[32:33], v[112:113]
    v_pk_mul_f32 v[136:137], v[48:49], v[136:137]
    v_exp_f32 v112, v112
    v_exp_f32 v136, v136
    v_exp_f32 v113, v113
    v_exp_f32 v137, v137
    v_pk_mul_f32 v[36:37], v[36:37], v[32:33]
    v_pk_mul_f32 v[52:53], v[52:53], v[48:49]
    v_pk_fma_f32 v[112:113], v[112:113], v[164:165], v[164:165] op_sel_hi:[1,0,0]
    v_pk_fma_f32 v[136:137], v[136:137], v[170:171], v[170:171] op_sel_hi:[1,0,0]
    v_rcp_f32 v112, v112
    v_rcp_f32 v136, v136
    v_rcp_f32 v113, v113
    v_rcp_f32 v137, v137
    v_pk_mul_f32 v[36:37], v[36:37], v[112:113]
    v_pk_mul_f32 v[52:53], v[52:53], v[136:137]
    v_pk_mul_f32 v[114:115], v[34:35], v[34:35]
    v_pk_mul_f32 v[138:139], v[50:51], v[50:51]
    v_pk_fma_f32 v[114:115], v[114:115], v[162:163], v[160:161] op_sel_hi:[1,0,0]
    v_pk_fma_f32 v[138:139], v[138:139], v[168:169], v[166:167] op_sel_hi:[1,0,0]
    v_pk_mul_f32 v[114:115], v[34:35], v[114:115]
    v_pk_mul_f32 v[138:139], v[50:51], v[138:139]
    v_exp_f32 v114, v114
    v_exp_f32 v138, v138
    v_exp_f32 v115, v115
    v_exp_f32 v139, v139
    v_pk_mul_f32 v[38:39], v[38:39], v[34:35]
    v_pk_mul_f32 v[54:55], v[54:55], v[50:51]
    v_pk_fma_f32 v[114:115], v[114:115], v[164:165], v[164:165] op_sel_hi:[1,0,0]
    v_pk_fma_f32 v[138:139], v[138:139], v[170:171], v[170:171] op_sel_hi:[1,0,0]
    v_rcp_f32 v114, v114
    v_rcp_f32 v138, v138
    v_rcp_f32 v115, v115
    v_rcp_f32 v139, v139
    v_pk_mul_f32 v[38:39], v[38:39], v[114:115]
    v_pk_mul_f32 v[54:55], v[54:55], v[138:139]
    v_pk_mul_f32 v[116:117], v[40:41], v[40:41]
    v_pk_mul_f32 v[140:141], v[56:57], v[56:57]
    v_pk_fma_f32 v[116:117], v[116:117], v[162:163], v[160:161] op_sel_hi:[1,0,0]
    v_pk_fma_f32 v[140:141], v[140:141], v[168:169], v[166:167] op_sel_hi:[1,0,0]
    v_pk_mul_f32 v[116:117], v[40:41], v[116:117]
    v_pk_mul_f32 v[140:141], v[56:57], v[140:141]
    v_exp_f32 v116, v116
    v_exp_f32 v140, v140
    v_exp_f32 v117, v117
    v_exp_f32 v141, v141
    v_pk_mul_f32 v[44:45], v[44:45], v[40:41]
    v_pk_mul_f32 v[60:61], v[60:61], v[56:57]
    v_pk_fma_f32 v[116:117], v[116:117], v[164:165], v[164:165] op_sel_hi:[1,0,0]
    v_pk_fma_f32 v[140:141], v[140:141], v[170:171], v[170:171] op_sel_hi:[1,0,0]
    v_rcp_f32 v116, v116
    v_rcp_f32 v140, v140
    v_rcp_f32 v117, v117
    v_rcp_f32 v141, v141
    v_pk_mul_f32 v[44:45], v[44:45], v[116:117]
    v_pk_mul_f32 v[60:61], v[60:61], v[140:141]
    v_pk_mul_f32 v[118:119], v[42:43], v[42:43]
    v_pk_mul_f32 v[142:143], v[58:59], v[58:59]
    v_pk_fma_f32 v[118:119], v[118:119], v[162:163], v[160:161] op_sel_hi:[1,0,0]
    v_pk_fma_f32 v[142:143], v[142:143], v[168:169], v[166:167] op_sel_hi:[1,0,0]
    v_pk_mul_f32 v[118:119], v[42:43], v[118:119]
    v_pk_mul_f32 v[142:143], v[58:59], v[142:143]
    v_exp_f32 v118, v118
    v_exp_f32 v142, v142
    v_exp_f32 v119, v119
    v_exp_f32 v143, v143
    v_pk_mul_f32 v[46:47], v[46:47], v[42:43]
    v_pk_mul_f32 v[62:63], v[62:63], v[58:59]
    v_pk_fma_f32 v[118:119], v[118:119], v[164:165], v[164:165] op_sel_hi:[1,0,0]
    v_pk_fma_f32 v[142:143], v[142:143], v[170:171], v[170:171] op_sel_hi:[1,0,0]
    v_rcp_f32 v118, v118
    v_rcp_f32 v142, v142
    v_rcp_f32 v119, v119
    v_rcp_f32 v143, v143
    v_pk_mul_f32 v[46:47], v[46:47], v[118:119]
    v_pk_mul_f32 v[62:63], v[62:63], v[142:143]
    v_cvt_pk_bf16_f32 v120, v36, v37
    v_cvt_pk_bf16_f32 v144, v52, v53
    v_cvt_pk_bf16_f32 v121, v38, v39
    v_cvt_pk_bf16_f32 v145, v54, v55
    v_cvt_pk_bf16_f32 v122, v44, v45
    v_cvt_pk_bf16_f32 v146, v60, v61
    v_cvt_pk_bf16_f32 v123, v46, v47
    v_cvt_pk_bf16_f32 v147, v62, v63
    global_store_dwordx4 v2, v[120:123], s[58:59] offset:2048
    global_store_dwordx4 v245, v[144:147], s[58:59] offset:2048
    s_add_u32 s29, s29, 1
    v_mov_b32 v254, s29
    s_waitcnt vmcnt(0)
    s_barrier
    s_cmp_lg_u32 s24, 0
    s_nop 1
    s_cbranch_scc1 L_gb3_j_58
    s_mov_b64 exec, 1
    s_cmp_lg_u32 s27, 0
    s_cbranch_scc1 L_gb3_slowst_59
    global_store_dword v247, v254, s[0:1]
    s_branch L_gb3_st_60
L_gb3_slowst_59:
    buffer_wbl2 sc1
    s_waitcnt vmcnt(0)
    global_store_dword v247, v254, s[0:1] sc1
L_gb3_st_60:
    s_mov_b64 exec, 0xffff
    s_mov_b32 s3, 0
L_gb3_poll_56:
    global_load_dword v255, v246, s[0:1] sc1
    s_waitcnt vmcnt(0)
    v_cmp_gt_u32 vcc, s29, v255
    s_add_u32 s3, s3, 1
    s_cmp_gt_u32 s3, 4000000
    s_nop 2
    s_cbranch_scc1 L_gb3_bail_57
    s_cbranch_vccnz L_gb3_poll_56
L_gb3_bail_57:
    s_mov_b64 exec, -1
    s_cmp_eq_u32 s27, 0
    s_cbranch_scc1 L_gb3_j_58
    buffer_inv sc1
    s_waitcnt vmcnt(0)
L_gb3_j_58:
    s_barrier
    s_cmp_eq_u32 s28, 1
    s_cbranch_scc1 L_last_61
    global_load_dwordx4 a[0:3], v5, s[12:13] offset:-4096 sc1
    global_load_dwordx4 a[4:7], v5, s[12:13] offset:-3072 sc1
    global_load_dwordx4 a[8:11], v5, s[12:13] offset:-2048 sc1
    global_load_dwordx4 a[12:15], v5, s[12:13] offset:-1024 sc1
    global_load_dwordx4 a[16:19], v5, s[12:13] offset:0 sc1
    global_load_dwordx4 a[20:23], v5, s[12:13] offset:1024 sc1
    s_barrier
    global_load_dwordx4 a[24:27], v5, s[12:13] offset:2048 sc1
    ds_read_b128 a[192:195], v10 offset:32768
    ds_read_b128 a[196:199], v10 offset:33792
    ds_read_b128 a[200:203], v10 offset:34816
    ds_read_b128 a[204:207], v10 offset:35840
    ds_read_b128 a[208:211], v10 offset:36864
    ds_read_b128 a[212:215], v10 offset:37888
    ds_read_b128 a[216:219], v10 offset:38912
    ds_read_b128 a[220:223], v10 offset:39936
    ds_read_b128 a[224:227], v10 offset:40960
    global_load_dwordx4 a[28:31], v5, s[12:13] offset:3072 sc1
    ds_read_b128 a[228:231], v10 offset:41984
    s_waitcnt lgkmcnt(5)
    s_waitcnt vmcnt(7)
    v_mfma_f32_16x16x32_bf16 v[32:35], a[192:195], a[0:3], 0
    ds_read_b128 a[232:235], v10 offset:43008
    v_mfma_f32_16x16x32_bf16 v[36:39], a[196:199], a[0:3], 0
    global_load_dwordx4 a[32:35], v6, s[12:13] offset:-4096 sc1
    ds_read_b128 a[236:239], v10 offset:44032
    v_mfma_f32_16x16x32_bf16 v[40:43], a[200:203], a[0:3], 0
    ds_read_b128 a[240:243], v10 offset:45056
    v_mfma_f32_16x16x32_bf16 v[44:47], a[204:207], a[0:3], 0
    global_load_dwordx4 a[36:39], v6, s[12:13] offset:-3072 sc1
    ds_read_b128 a[244:247], v10 offset:46080
    v_mfma_f32_16x16x32_bf16 v[48:51], a[208:211], a[0:3], 0
    ds_read_b128 a[248:251], v10 offset:47104
    s_barrier
    s_waitcnt lgkmcnt(5)
    s_waitcnt vmcnt(8)
    v_mfma_f32_16x16x32_bf16 v[32:35], a[212:215], a[4:7], v[32:35]
    global_load_dwordx4 a[40:43], v6, s[12:13] offset:-2048 sc1
    ds_read_b128 a[192:195], v10 offset:48128
    v_mfma_f32_16x16x32_bf16 v[36:39], a[216:219], a[4:7], v[36:39]
    ds_read_b128 a[196:199], v2 offset:0
    global_load_dwordx4 a[44:47], v6, s[12:13] offset:-1024 sc1
    v_mfma_f32_16x16x32_bf16 v[40:43], a[220:223], a[4:7], v[40:43]
    ds_read_b128 a[200:203], v2 offset:1024
    v_mfma_f32_16x16x32_bf16 v[44:47], a[224:227], a[4:7], v[44:47]
    global_load_dwordx4 a[48:51], v6, s[12:13] offset:0 sc1
    ds_read_b128 a[204:207], v2 offset:2048
    v_mfma_f32_16x16x32_bf16 v[48:51], a[228:231], a[4:7], v[48:51]
    ds_read_b128 a[208:211], v2 offset:3072
    s_waitcnt lgkmcnt(5)
    s_waitcnt vmcnt(10)
    v_mfma_f32_16x16x32_bf16 v[32:35], a[232:235], a[8:11], v[32:35]
    global_load_dwordx4 a[52:55], v6, s[12:13] offset:1024 sc1
    ds_read_b128 a[212:215], v2 offset:4096
    v_mfma_f32_16x16x32_bf16 v[36:39], a[236:239], a[8:11], v[36:39]
    ds_read_b128 a[216:219], v2 offset:5120
    v_mfma_f32_16x16x32_bf16 v[40:43], a[240:243], a[8:11], v[40:43]
    global_load_dwordx4 a[56:59], v6, s[12:13] offset:2048 sc1
    ds_read_b128 a[220:223], v2 offset:6144
    v_mfma_f32_16x16x32_bf16 v[44:47], a[244:247], a[8:11], v[44:47]
    ds_read_b128 a[224:227], v2 offset:7168
    v_mfma_f32_16x16x32_bf16 v[48:51], a[248:251], a[8:11], v[48:51]
    global_load_dwordx4 a[60:63], v6, s[12:13] offset:3072 sc1
    ds_read_b128 a[228:231], v2 offset:8192
    s_waitcnt lgkmcnt(5)
    s_waitcnt vmcnt(12)
    v_mfma_f32_16x16x32_bf16 v[32:35], a[192:195], a[12:15], v[32:35]
    ds_read_b128 a[232:235], v2 offset:9216
    global_load_dwordx4 a[64:67], v7, s[12:13] offset:-4096 sc1
    v_mfma_f32_16x16x32_bf16 v[36:39], a[196:199], a[12:15], v[36:39]
    ds_read_b128 a[236:239], v2 offset:10240
    v_mfma_f32_16x16x32_bf16 v[40:43], a[200:203], a[12:15], v[40:43]
    global_load_dwordx4 a[68:71], v7, s[12:13] offset:-3072 sc1
    ds_read_b128 a[240:243], v2 offset:11264
    v_mfma_f32_16x16x32_bf16 v[44:47], a[204:207], a[12:15], v[44:47]
    ds_read_b128 a[244:247], v2 offset:12288
    v_mfma_f32_16x16x32_bf16 v[48:51], a[208:211], a[12:15], v[48:51]
    global_load_dwordx4 a[72:75], v7, s[12:13] offset:-2048 sc1
    ds_read_b128 a[248:251], v2 offset:13312
    s_waitcnt lgkmcnt(5)
    s_waitcnt vmcnt(14)
    v_mfma_f32_16x16x32_bf16 v[32:35], a[212:215], a[16:19], v[32:35]
    ds_read_b128 a[192:195], v2 offset:14336
    v_mfma_f32_16x16x32_bf16 v[36:39], a[216:219], a[16:19], v[36:39]
    global_load_dwordx4 a[76:79], v7, s[12:13] offset:-1024 sc1
    ds_read_b128 a[196:199], v2 offset:15360
    v_mfma_f32_16x16x32_bf16 v[40:43], a[220:223], a[16:19], v[40:43]
    ds_read_b128 a[200:203], v2 offset:16384
    v_mfma_f32_16x16x32_bf16 v[44:47], a[224:227], a[16:19], v[44:47]
    global_load_dwordx4 a[80:83], v7, s[12:13] offset:0 sc1
    ds_read_b128 a[204:207], v2 offset:17408
    v_mfma_f32_16x16x32_bf16 v[48:51], a[228:231], a[16:19], v[48:51]
    ds_read_b128 a[208:211], v2 offset:18432
    s_waitcnt lgkmcnt(5)
    global_load_dwordx4 a[84:87], v7, s[12:13] offset:1024 sc1
    s_waitcnt vmcnt(16)
    v_mfma_f32_16x16x32_bf16 v[32:35], a[232:235], a[20:23], v[32:35]
    ds_read_b128 a[212:215], v2 offset:19456
    v_mfma_f32_16x16x32_bf16 v[36:39], a[236:239], a[20:23], v[36:39]
    s_add_u32 s79, s98, 135168
    s_add_u32 m0, s98, 69632
    s_add_u32 s80, s44, s79
    s_addc_u32 s81, s45, 0
    global_load_lds_dwordx4 v2, s[80:81] offset:-4096
    ds_read_b128 a[216:219], v2 offset:20480
    v_mfma_f32_16x16x32_bf16 v[40:43], a[240:243], a[20:23], v[40:43]
    ds_read_b128 a[220:223], v2 offset:21504
    v_mfma_f32_16x16x32_bf16 v[44:47], a[244:247], a[20:23], v[44:47]
    ds_read_b128 a[224:227], v2 offset:22528
    v_mfma_f32_16x16x32_bf16 v[48:51], a[248:251], a[20:23], v[48:51]
    ds_read_b128 a[228:231], v2 offset:23552
    s_waitcnt lgkmcnt(0)
    s_barrier
    s_waitcnt vmcnt(16)
    v_mfma_f32_16x16x32_bf16 v[32:35], a[192:195], a[24:27], v[32:35]
    global_load_dwordx4 a[88:91], v7, s[12:13] offset:2048 sc1
    ds_read_b128 a[232:235], v2 offset:24576
    v_mfma_f32_16x16x32_bf16 v[36:39], a[196:199], a[24:27], v[36:39]
    ds_read_b128 a[236:239], v2 offset:25600
    v_mfma_f32_16x16x32_bf16 v[40:43], a[200:203], a[24:27], v[40:43]
    global_load_lds_dwordx4 v2, s[80:81] offset:-3072
    ds_read_b128 a[240:243], v2 offset:26624
    v_mfma_f32_16x16x32_bf16 v[44:47], a[204:207], a[24:27], v[44:47]
    ds_read_b128 a[244:247], v2 offset:27648
    v_mfma_f32_16x16x32_bf16 v[48:51], a[208:211], a[24:27], v[48:51]
    ds_read_b128 a[248:251], v2 offset:28672
    s_waitcnt vmcnt(17)
    v_mfma_f32_16x16x32_bf16 v[32:35], a[212:215], a[28:31], v[32:35]
    global_load_dwordx4 a[92:95], v7, s[12:13] offset:3072 sc1
    ds_read_b128 a[192:195], v2 offset:29696
    v_mfma_f32_16x16x32_bf16 v[36:39], a[216:219], a[28:31], v[36:39]
    ds_read_b128 a[196:199], v2 offset:30720
    v_mfma_f32_16x16x32_bf16 v[40:43], a[220:223], a[28:31], v[40:43]
    global_load_lds_dwordx4 v2, s[80:81] offset:-2048
    ds_read_b128 a[200:203], v2 offset:31744
    v_mfma_f32_16x16x32_bf16 v[44:47], a[224:227], a[28:31], v[44:47]
    ds_read_b128 a[204:207], v2 offset:32768
    v_mfma_f32_16x16x32_bf16 v[48:51], a[228:231], a[28:31], v[48:51]
    ds_read_b128 a[208:211], v2 offset:33792
    s_waitcnt lgkmcnt(5)
    s_waitcnt vmcnt(18)
    v_mfma_f32_16x16x32_bf16 v[32:35], a[232:235], a[32:35], v[32:35]
    ds_read_b128 a[212:215], v2 offset:34816
    global_load_dwordx4 a[96:99], v8, s[12:13] offset:-4096 sc1
    v_mfma_f32_16x16x32_bf16 v[36:39], a[236:239], a[32:35], v[36:39]
    ds_read_b128 a[216:219], v2 offset:35840
    v_mfma_f32_16x16x32_bf16 v[40:43], a[240:243], a[32:35], v[40:43]
    global_load_lds_dwordx4 v2, s[80:81] offset:-1024
    ds_read_b128 a[220:223], v2 offset:36864
    v_mfma_f32_16x16x32_bf16 v[44:47], a[244:247], a[32:35], v[44:47]
    ds_read_b128 a[224:227], v2 offset:37888
    v_mfma_f32_16x16x32_bf16 v[48:51], a[248:251], a[32:35], v[48:51]
    ds_read_b128 a[228:231], v2 offset:38912
    s_waitcnt lgkmcnt(5)
    s_waitcnt vmcnt(19)
    v_mfma_f32_16x16x32_bf16 v[32:35], a[192:195], a[36:39], v[32:35]
    ds_read_b128 a[232:235], v2 offset:39936
    v_mfma_f32_16x16x32_bf16 v[36:39], a[196:199], a[36:39], v[36:39]
    global_load_dwordx4 a[100:103], v8, s[12:13] offset:-3072 sc1
    ds_read_b128 a[236:239], v2 offset:40960
    v_mfma_f32_16x16x32_bf16 v[40:43], a[200:203], a[36:39], v[40:43]
    ds_read_b128 a[240:243], v2 offset:41984
    global_load_lds_dwordx4 v2, s[80:81] offset:0
    v_mfma_f32_16x16x32_bf16 v[44:47], a[204:207], a[36:39], v[44:47]
    ds_read_b128 a[244:247], v2 offset:43008
    v_mfma_f32_16x16x32_bf16 v[48:51], a[208:211], a[36:39], v[48:51]
    ds_read_b128 a[248:251], v2 offset:44032
    s_waitcnt lgkmcnt(5)
    s_waitcnt vmcnt(20)
    v_mfma_f32_16x16x32_bf16 v[32:35], a[212:215], a[40:43], v[32:35]
    ds_read_b128 a[192:195], v2 offset:45056
    v_mfma_f32_16x16x32_bf16 v[36:39], a[216:219], a[40:43], v[36:39]
    global_load_dwordx4 a[104:107], v8, s[12:13] offset:-2048 sc1
    ds_read_b128 a[196:199], v2 offset:46080
    v_mfma_f32_16x16x32_bf16 v[40:43], a[220:223], a[40:43], v[40:43]
    ds_read_b128 a[200:203], v2 offset:47104
    v_mfma_f32_16x16x32_bf16 v[44:47], a[224:227], a[40:43], v[44:47]
    global_load_lds_dwordx4 v2, s[80:81] offset:1024
    ds_read_b128 a[204:207], v2 offset:48128
    v_mfma_f32_16x16x32_bf16 v[48:51], a[228:231], a[40:43], v[48:51]
    ds_read_b128 a[208:211], v2 offset:49152
    s_waitcnt lgkmcnt(0)
    s_barrier
    s_waitcnt vmcnt(21)
    v_mfma_f32_16x16x32_bf16 v[32:35], a[232:235], a[44:47], v[32:35]
    ds_read_b128 a[212:215], v2 offset:50176
    v_mfma_f32_16x16x32_bf16 v[36:39], a[236:239], a[44:47], v[36:39]
    global_load_dwordx4 a[108:111], v8, s[12:13] offset:-1024 sc1
    ds_read_b128 a[216:219], v2 offset:51200
    v_mfma_f32_16x16x32_bf16 v[40:43], a[240:243], a[44:47], v[40:43]
    ds_read_b128 a[220:223], v2 offset:52224
    v_mfma_f32_16x16x32_bf16 v[44:47], a[244:247], a[44:47], v[44:47]
    s_add_u32 s79, s98, 159744
    s_add_u32 m0, s98, 94208
    s_add_u32 s80, s44, s79
    s_addc_u32 s81, s45, 0
    global_load_lds_dwordx4 v2, s[80:81] offset:-4096
    ds_read_b128 a[224:227], v15 offset:24576
    v_mfma_f32_16x16x32_bf16 v[48:51], a[248:251], a[44:47], v[48:51]
    ds_read_b128 a[228:231], v15 offset:25600
    s_waitcnt vmcnt(22)
    v_mfma_f32_16x16x32_bf16 v[32:35], a[192:195], a[48:51], v[32:35]
    ds_read_b128 a[232:235], v15 offset:26624
    v_mfma_f32_16x16x32_bf16 v[36:39], a[196:199], a[48:51], v[36:39]
    global_load_dwordx4 a[112:115], v8, s[12:13] offset:0 sc1
    ds_read_b128 a[236:239], v15 offset:27648
    v_mfma_f32_16x16x32_bf16 v[40:43], a[200:203], a[48:51], v[40:43]
    ds_read_b128 a[240:243], v15 offset:28672
    v_mfma_f32_16x16x32_bf16 v[44:47], a[204:207], a[48:51], v[44:47]
    global_load_lds_dwordx4 v2, s[80:81] offset:-3072
    ds_read_b128 a[244:247], v15 offset:29696
    v_mfma_f32_16x16x32_bf16 v[48:51], a[208:211], a[48:51], v[48:51]
    ds_read_b128 a[248:251], v15 offset:30720
    s_waitcnt lgkmcnt(5)
    s_waitcnt vmcnt(23)
    v_mfma_f32_16x16x32_bf16 v[32:35], a[212:215], a[52:55], v[32:35]
    ds_read_b128 a[192:195], v15 offset:31744
    global_load_dwordx4 a[116:119], v8, s[12:13] offset:1024 sc1
    v_mfma_f32_16x16x32_bf16 v[36:39], a[216:219], a[52:55], v[36:39]
    ds_read_b128 a[196:199], v10 offset:49152
    v_mfma_f32_16x16x32_bf16 v[40:43], a[220:223], a[52:55], v[40:43]
    global_load_lds_dwordx4 v2, s[80:81] offset:-2048
    ds_read_b128 a[200:203], v10 offset:50176
    v_mfma_f32_16x16x32_bf16 v[44:47], a[224:227], a[52:55], v[44:47]
    ds_read_b128 a[204:207], v10 offset:51200
    v_mfma_f32_16x16x32_bf16 v[48:51], a[228:231], a[52:55], v[48:51]
    ds_read_b128 a[208:211], v10 offset:52224
    s_waitcnt lgkmcnt(5)
    s_waitcnt vmcnt(24)
    v_mfma_f32_16x16x32_bf16 v[32:35], a[232:235], a[56:59], v[32:35]
    global_load_dwordx4 a[120:123], v8, s[12:13] offset:2048 sc1
    ds_read_b128 a[212:215], v10 offset:53248
    v_mfma_f32_16x16x32_bf16 v[36:39], a[236:239], a[56:59], v[36:39]
    ds_read_b128 a[216:219], v10 offset:54272
    v_mfma_f32_16x16x32_bf16 v[40:43], a[240:243], a[56:59], v[40:43]
    global_load_lds_dwordx4 v2, s[80:81] offset:-1024
    ds_read_b128 a[220:223], v10 offset:55296
    v_mfma_f32_16x16x32_bf16 v[44:47], a[244:247], a[56:59], v[44:47]
    ds_read_b128 a[224:227], v10 offset:56320
    v_mfma_f32_16x16x32_bf16 v[48:51], a[248:251], a[56:59], v[48:51]
    ds_read_b128 a[228:231], v10 offset:57344
    s_waitcnt lgkmcnt(5)
    global_load_dwordx4 a[124:127], v8, s[12:13] offset:3072 sc1
    s_waitcnt vmcnt(26)
    v_mfma_f32_16x16x32_bf16 v[32:35], a[192:195], a[60:63], v[32:35]
    ds_read_b128 a[232:235], v10 offset:58368
    v_mfma_f32_16x16x32_bf16 v[36:39], a[196:199], a[60:63], v[36:39]
    global_load_lds_dwordx4 v2, s[80:81] offset:0
    ds_read_b128 a[236:239], v10 offset:59392
    v_mfma_f32_16x16x32_bf16 v[40:43], a[200:203], a[60:63], v[40:43]
    ds_read_b128 a[240:243], v10 offset:60416
    v_mfma_f32_16x16x32_bf16 v[44:47], a[204:207], a[60:63], v[44:47]
    ds_read_b128 a[244:247], v10 offset:61440
    v_mfma_f32_16x16x32_bf16 v[48:51], a[208:211], a[60:63], v[48:51]
    global_load_lds_dwordx4 v2, s[80:81] offset:1024
    ds_read_b128 a[248:251], v10 offset:62464
    s_waitcnt lgkmcnt(0)
    s_barrier
    s_waitcnt vmcnt(27)
    v_mfma_f32_16x16x32_bf16 v[32:35], a[212:215], a[64:67], v[32:35]
    ds_read_b128 a[192:195], v10 offset:63488
    v_mfma_f32_16x16x32_bf16 v[36:39], a[216:219], a[64:67], v[36:39]
    ds_read_b128 a[196:199], v10 offset:64512
    v_mfma_f32_16x16x32_bf16 v[40:43], a[220:223], a[64:67], v[40:43]
    global_load_dwordx4 a[128:131], v9, s[12:13] offset:-4096 sc1
    ds_read_b128 a[200:203], v2 offset:53248
    v_mfma_f32_16x16x32_bf16 v[44:47], a[224:227], a[64:67], v[44:47]
    ds_read_b128 a[204:207], v2 offset:54272
    v_mfma_f32_16x16x32_bf16 v[48:51], a[228:231], a[64:67], v[48:51]
    s_add_u32 s79, s99, 184320
    s_add_u32 m0, s99, 4096
    s_add_u32 s80, s44, s79
    s_addc_u32 s81, s45, 0
    global_load_lds_dwordx4 v2, s[80:81] offset:-4096
    ds_read_b128 a[208:211], v2 offset:55296
    s_waitcnt vmcnt(28)
    v_mfma_f32_16x16x32_bf16 v[32:35], a[232:235], a[68:71], v[32:35]
    ds_read_b128 a[212:215], v2 offset:56320
    v_mfma_f32_16x16x32_bf16 v[36:39], a[236:239], a[68:71], v[36:39]
    ds_read_b128 a[216:219], v2 offset:57344
    global_load_dwordx4 a[132:135], v9, s[12:13] offset:-3072 sc1
    v_mfma_f32_16x16x32_bf16 v[40:43], a[240:243], a[68:71], v[40:43]
    ds_read_b128 a[220:223], v2 offset:58368
    v_mfma_f32_16x16x32_bf16 v[44:47], a[244:247], a[68:71], v[44:47]
    global_load_lds_dwordx4 v2, s[80:81] offset:-3072
    ds_read_b128 a[224:227], v2 offset:59392
    v_mfma_f32_16x16x32_bf16 v[48:51], a[248:251], a[68:71], v[48:51]
    ds_read_b128 a[228:231], v2 offset:60416
    s_waitcnt lgkmcnt(5)
    s_waitcnt vmcnt(29)
    v_mfma_f32_16x16x32_bf16 v[32:35], a[192:195], a[72:75], v[32:35]
    ds_read_b128 a[232:235], v2 offset:61440
    v_mfma_f32_16x16x32_bf16 v[36:39], a[196:199], a[72:75], v[36:39]
    global_load_dwordx4 a[136:139], v9, s[12:13] offset:-2048 sc1
    ds_read_b128 a[236:239], v2 offset:62464
    v_mfma_f32_16x16x32_bf16 v[40:43], a[200:203], a[72:75], v[40:43]
    ds_read_b128 a[240:243], v2 offset:63488
    v_mfma_f32_16x16x32_bf16 v[44:47], a[204:207], a[72:75], v[44:47]
    global_load_lds_dwordx4 v2, s[80:81] offset:-2048
    ds_read_b128 a[244:247], v2 offset:64512
    v_mfma_f32_16x16x32_bf16 v[48:51], a[208:211], a[72:75], v[48:51]
    ds_read_b128 a[248:251], v15 offset:0
    s_waitcnt lgkmcnt(5)
    s_waitcnt vmcnt(30)
    v_mfma_f32_16x16x32_bf16 v[32:35], a[212:215], a[76:79], v[32:35]
    ds_read_b128 a[192:195], v15 offset:1024
    global_load_dwordx4 a[140:143], v9, s[12:13] offset:-1024 sc1
    v_mfma_f32_16x16x32_bf16 v[36:39], a[216:219], a[76:79], v[36:39]
    ds_read_b128 a[196:199], v15 offset:2048
    v_mfma_f32_16x16x32_bf16 v[40:43], a[220:223], a[76:79], v[40:43]
    global_load_lds_dwordx4 v2, s[80:81] offset:-1024
    ds_read_b128 a[200:203], v15 offset:3072
    v_mfma_f32_16x16x32_bf16 v[44:47], a[224:227], a[76:79], v[44:47]
    ds_read_b128 a[204:207], v15 offset:4096
    v_mfma_f32_16x16x32_bf16 v[48:51], a[228:231], a[76:79], v[48:51]
    ds_read_b128 a[208:211], v15 offset:5120
    s_waitcnt lgkmcnt(5)
    s_waitcnt vmcnt(31)
    v_mfma_f32_16x16x32_bf16 v[32:35], a[232:235], a[80:83], v[32:35]
    global_load_dwordx4 a[144:147], v9, s[12:13] offset:0 sc1
    ds_read_b128 a[212:215], v15 offset:6144
    ds_read_b128 a[216:219], v15 offset:7168
    v_mfma_f32_16x16x32_bf16 v[36:39], a[236:239], a[80:83], v[36:39]
    ds_read_b128 a[220:223], v15 offset:8192
    global_load_dwordx4 v[56:59], v2, s[16:17] sc1
    global_load_lds_dwordx4 v2, s[80:81] offset:0
    v_mfma_f32_16x16x32_bf16 v[40:43], a[240:243], a[80:83], v[40:43]
    ds_read_b128 a[224:227], v15 offset:9216
    global_load_dwordx4 v[60:63], v2, s[16:17] offset:1024 sc1
    v_mfma_f32_16x16x32_bf16 v[44:47], a[244:247], a[80:83], v[44:47]
    ds_read_b128 a[228:231], v15 offset:10240
    global_load_dwordx2 v[64:65], v244, s[20:21] sc1
    v_mfma_f32_16x16x32_bf16 v[48:51], a[248:251], a[80:83], v[48:51]
    s_waitcnt lgkmcnt(5)
    global_load_dwordx4 a[148:151], v9, s[12:13] offset:1024 sc1
    s_waitcnt vmcnt(36)
    v_mfma_f32_16x16x32_bf16 v[32:35], a[192:195], a[84:87], v[32:35]
    ds_read_b128 a[232:235], v15 offset:11264
    v_mfma_f32_16x16x32_bf16 v[36:39], a[196:199], a[84:87], v[36:39]
    global_load_lds_dwordx4 v2, s[80:81] offset:1024
    ds_read_b128 a[236:239], v15 offset:12288
    v_mfma_f32_16x16x32_bf16 v[40:43], a[200:203], a[84:87], v[40:43]
    ds_read_b128 a[240:243], v15 offset:13312
    v_mfma_f32_16x16x32_bf16 v[44:47], a[204:207], a[84:87], v[44:47]
    ds_read_b128 a[244:247], v15 offset:14336
    global_load_lds_dwordx4 v2, s[80:81] offset:2048
    v_mfma_f32_16x16x32_bf16 v[48:51], a[208:211], a[84:87], v[48:51]
    ds_read_b128 a[248:251], v15 offset:15360
    s_waitcnt lgkmcnt(5)
    s_waitcnt vmcnt(36)
    v_mfma_f32_16x16x32_bf16 v[32:35], a[212:215], a[88:91], v[32:35]
    ds_read_b128 a[192:195], v15 offset:16384
    v_mfma_f32_16x16x32_bf16 v[36:39], a[216:219], a[88:91], v[36:39]
    global_load_dwordx4 a[152:155], v9, s[12:13] offset:2048 sc1
    ds_read_b128 a[196:199], v15 offset:17408
    v_mfma_f32_16x16x32_bf16 v[40:43], a[220:223], a[88:91], v[40:43]
    ds_read_b128 a[200:203], v15 offset:18432
    v_mfma_f32_16x16x32_bf16 v[44:47], a[224:227], a[88:91], v[44:47]
    s_add_u32 s79, s98, 212992
    s_add_u32 m0, s98, 32768
    s_add_u32 s80, s44, s79
    s_addc_u32 s81, s45, 0
    global_load_lds_dwordx4 v2, s[80:81] offset:-4096
    ds_read_b128 a[204:207], v15 offset:19456
    v_mfma_f32_16x16x32_bf16 v[48:51], a[228:231], a[88:91], v[48:51]
    ds_read_b128 a[208:211], v15 offset:20480
    s_waitcnt vmcnt(29)
    s_waitcnt lgkmcnt(0)
    s_barrier
    v_mfma_f32_16x16x32_bf16 v[32:35], a[232:235], a[92:95], v[32:35]
    ds_read_b128 a[212:215], v15 offset:21504
    v_mfma_f32_16x16x32_bf16 v[36:39], a[236:239], a[92:95], v[36:39]
    global_load_dwordx4 a[156:159], v9, s[12:13] offset:3072 sc1
    ds_read_b128 a[216:219], v15 offset:22528
    v_mfma_f32_16x16x32_bf16 v[40:43], a[240:243], a[92:95], v[40:43]
    ds_read_b128 a[220:223], v15 offset:23552
    v_mfma_f32_16x16x32_bf16 v[44:47], a[244:247], a[92:95], v[44:47]
    global_load_lds_dwordx4 v2, s[80:81] offset:-3072
    ds_read_b128 a[224:227], v10 offset:0
    v_mfma_f32_16x16x32_bf16 v[48:51], a[248:251], a[92:95], v[48:51]
    ds_read_b128 a[228:231], v10 offset:1024
    v_mfma_f32_16x16x32_bf16 v[32:35], a[192:195], a[96:99], v[32:35]
    ds_read_b128 a[232:235], v10 offset:2048
    global_load_dwordx4 a[160:163], v5, s[14:15] offset:-4096 sc1
    v_mfma_f32_16x16x32_bf16 v[36:39], a[196:199], a[96:99], v[36:39]
    ds_read_b128 a[236:239], v10 offset:3072
    v_mfma_f32_16x16x32_bf16 v[40:43], a[200:203], a[96:99], v[40:43]
    global_load_lds_dwordx4 v2, s[80:81] offset:-2048
    ds_read_b128 a[240:243], v10 offset:4096
    v_mfma_f32_16x16x32_bf16 v[44:47], a[204:207], a[96:99], v[44:47]
    ds_read_b128 a[244:247], v10 offset:5120
    v_mfma_f32_16x16x32_bf16 v[48:51], a[208:211], a[96:99], v[48:51]
    ds_read_b128 a[248:251], v10 offset:6144
    s_waitcnt lgkmcnt(5)
    v_mfma_f32_16x16x32_bf16 v[32:35], a[212:215], a[100:103], v[32:35]
    global_load_dwordx4 a[164:167], v5, s[14:15] offset:-3072 sc1
    ds_read_b128 a[192:195], v10 offset:7168
    v_mfma_f32_16x16x32_bf16 v[36:39], a[216:219], a[100:103], v[36:39]
    ds_read_b128 a[196:199], v10 offset:8192
    v_mfma_f32_16x16x32_bf16 v[40:43], a[220:223], a[100:103], v[40:43]
    global_load_lds_dwordx4 v2, s[80:81] offset:-1024
    ds_read_b128 a[200:203], v10 offset:9216
    v_mfma_f32_16x16x32_bf16 v[44:47], a[224:227], a[100:103], v[44:47]
    ds_read_b128 a[204:207], v10 offset:10240
    v_mfma_f32_16x16x32_bf16 v[48:51], a[228:231], a[100:103], v[48:51]
    ds_read_b128 a[208:211], v10 offset:11264
    s_waitcnt lgkmcnt(5)
    global_load_dwordx4 a[168:171], v5, s[14:15] offset:-2048 sc1
    v_mfma_f32_16x16x32_bf16 v[32:35], a[232:235], a[104:107], v[32:35]
    ds_read_b128 a[212:215], v10 offset:12288
    v_mfma_f32_16x16x32_bf16 v[36:39], a[236:239], a[104:107], v[36:39]
    global_load_lds_dwordx4 v2, s[80:81] offset:0
    ds_read_b128 a[216:219], v10 offset:13312
    v_mfma_f32_16x16x32_bf16 v[40:43], a[240:243], a[104:107], v[40:43]
    ds_read_b128 a[220:223], v10 offset:14336
    v_mfma_f32_16x16x32_bf16 v[44:47], a[244:247], a[104:107], v[44:47]
    ds_read_b128 a[224:227], v10 offset:15360
    v_mfma_f32_16x16x32_bf16 v[48:51], a[248:251], a[104:107], v[48:51]
    global_load_lds_dwordx4 v2, s[80:81] offset:1024
    ds_read_b128 a[228:231], v10 offset:16384
    s_waitcnt lgkmcnt(5)
    s_waitcnt vmcnt(37)
    v_mfma_f32_16x16x32_bf16 v[32:35], a[192:195], a[108:111], v[32:35]
    ds_read_b128 a[232:235], v10 offset:17408
    v_mfma_f32_16x16x32_bf16 v[36:39], a[196:199], a[108:111], v[36:39]
    ds_read_b128 a[236:239], v10 offset:18432
    v_mfma_f32_16x16x32_bf16 v[40:43], a[200:203], a[108:111], v[40:43]
    global_load_dwordx4 a[172:175], v5, s[14:15] offset:-1024 sc1
    ds_read_b128 a[240:243], v10 offset:19456
    v_mfma_f32_16x16x32_bf16 v[44:47], a[204:207], a[108:111], v[44:47]
    ds_read_b128 a[244:247], v10 offset:20480
    v_mfma_f32_16x16x32_bf16 v[48:51], a[208:211], a[108:111], v[48:51]
    s_add_u32 s79, s101, 45056
    s_add_u32 m0, s101, 159744
    s_add_u32 s80, s36, s79
    s_addc_u32 s81, s37, 0
    global_load_lds_dwordx4 v2, s[80:81] offset:-4096
    ds_read_b128 a[248:251], v10 offset:21504
    s_waitcnt vmcnt(29)
    s_waitcnt lgkmcnt(0)
    s_barrier
    v_mfma_f32_16x16x32_bf16 v[32:35], a[212:215], a[112:115], v[32:35]
    ds_read_b128 a[192:195], v10 offset:22528
    v_mfma_f32_16x16x32_bf16 v[36:39], a[216:219], a[112:115], v[36:39]
    ds_read_b128 a[196:199], v10 offset:23552
    v_mfma_f32_16x16x32_bf16 v[40:43], a[220:223], a[112:115], v[40:43]
    global_load_dwordx4 a[176:179], v5, s[14:15] offset:0 sc1
    ds_read_b128 a[200:203], v10 offset:24576
    v_mfma_f32_16x16x32_bf16 v[44:47], a[224:227], a[112:115], v[44:47]
    ds_read_b128 a[204:207], v10 offset:25600
    v_mfma_f32_16x16x32_bf16 v[48:51], a[228:231], a[112:115], v[48:51]
    global_load_lds_dwordx4 v2, s[80:81] offset:-3072
    ds_read_b128 a[208:211], v10 offset:26624
    v_mfma_f32_16x16x32_bf16 v[32:35], a[232:235], a[116:119], v[32:35]
    ds_read_b128 a[212:215], v10 offset:27648
    v_mfma_f32_16x16x32_bf16 v[36:39], a[236:239], a[116:119], v[36:39]
    ds_read_b128 a[216:219], v10 offset:28672
    v_mfma_f32_16x16x32_bf16 v[40:43], a[240:243], a[116:119], v[40:43]
    ds_read_b128 a[220:223], v10 offset:29696
    v_mfma_f32_16x16x32_bf16 v[44:47], a[244:247], a[116:119], v[44:47]
    global_load_dwordx4 a[180:183], v5, s[14:15] offset:1024 sc1
    ds_read_b128 a[224:227], v10 offset:30720
    v_mfma_f32_16x16x32_bf16 v[48:51], a[248:251], a[116:119], v[48:51]
    ds_read_b128 a[228:231], v10 offset:31744
    s_waitcnt lgkmcnt(5)
    v_mfma_f32_16x16x32_bf16 v[32:35], a[192:195], a[120:123], v[32:35]
    global_load_dwordx4 a[184:187], v5, s[14:15] offset:2048 sc1
    ds_read_b128 a[232:235], v10 offset:32768
    v_mfma_f32_16x16x32_bf16 v[36:39], a[196:199], a[120:123], v[36:39]
    ds_read_b128 a[236:239], v10 offset:33792
    s_add_u32 s79, s100, 237568
    s_add_u32 m0, s100, 57344
    s_add_u32 s80, s44, s79
    s_addc_u32 s81, s45, 0
    global_load_lds_dwordx4 v2, s[80:81] offset:-4096
    v_mfma_f32_16x16x32_bf16 v[40:43], a[200:203], a[120:123], v[40:43]
    ds_read_b128 a[240:243], v10 offset:34816
    v_mfma_f32_16x16x32_bf16 v[44:47], a[204:207], a[120:123], v[44:47]
    ds_read_b128 a[244:247], v10 offset:35840
    v_mfma_f32_16x16x32_bf16 v[48:51], a[208:211], a[120:123], v[48:51]
    global_load_lds_dwordx4 v2, s[80:81] offset:-3072
    ds_read_b128 a[248:251], v10 offset:36864
    s_waitcnt lgkmcnt(5)
    v_mfma_f32_16x16x32_bf16 v[32:35], a[212:215], a[124:127], v[32:35]
    ds_read_b128 a[192:195], v10 offset:37888
    v_mfma_f32_16x16x32_bf16 v[36:39], a[216:219], a[124:127], v[36:39]
    ds_read_b128 a[196:199], v10 offset:38912
    v_mfma_f32_16x16x32_bf16 v[40:43], a[220:223], a[124:127], v[40:43]
    global_load_dwordx4 a[188:191], v5, s[14:15] offset:3072 sc1
    ds_read_b128 a[200:203], v10 offset:39936
    v_mfma_f32_16x16x32_bf16 v[44:47], a[224:227], a[124:127], v[44:47]
    ds_read_b128 a[204:207], v10 offset:40960
    v_mfma_f32_16x16x32_bf16 v[48:51], a[228:231], a[124:127], v[48:51]
    global_load_lds_dwordx4 v2, s[80:81] offset:-2048
    ds_read_b128 a[208:211], v10 offset:41984
    s_waitcnt lgkmcnt(5)
    s_waitcnt vmcnt(36)
    v_mfma_f32_16x16x32_bf16 v[32:35], a[232:235], a[128:131], v[32:35]
    ds_read_b128 a[212:215], v10 offset:43008
    v_mfma_f32_16x16x32_bf16 v[36:39], a[236:239], a[128:131], v[36:39]
    ds_read_b128 a[216:219], v10 offset:44032
    s_add_u32 s79, s83, 28672
    s_add_u32 m0, s83, 118784
    s_add_u32 s80, s36, s79
    s_addc_u32 s81, s37, 0
    global_load_lds_dwordx4 v2, s[80:81] offset:-4096
    v_mfma_f32_16x16x32_bf16 v[40:43], a[240:243], a[128:131], v[40:43]
    ds_read_b128 a[220:223], v10 offset:45056
    v_mfma_f32_16x16x32_bf16 v[44:47], a[244:247], a[128:131], v[44:47]
    ds_read_b128 a[224:227], v10 offset:46080
    v_mfma_f32_16x16x32_bf16 v[48:51], a[248:251], a[128:131], v[48:51]
    ds_read_b128 a[228:231], v10 offset:47104
    s_waitcnt vmcnt(22)
    s_waitcnt lgkmcnt(0)
    s_barrier
    v_mfma_f32_16x16x32_bf16 v[32:35], a[192:195], a[132:135], v[32:35]
    global_load_lds_dwordx4 v2, s[80:81] offset:-3072
    ds_read_b128 a[232:235], v10 offset:48128
    v_mfma_f32_16x16x32_bf16 v[36:39], a[196:199], a[132:135], v[36:39]
    ds_read_b128 a[236:239], v2 offset:0
    v_mfma_f32_16x16x32_bf16 v[40:43], a[200:203], a[132:135], v[40:43]
    ds_read_b128 a[240:243], v2 offset:1024
    v_mfma_f32_16x16x32_bf16 v[44:47], a[204:207], a[132:135], v[44:47]
    ds_read_b128 a[244:247], v2 offset:2048
    v_mfma_f32_16x16x32_bf16 v[48:51], a[208:211], a[132:135], v[48:51]
    global_load_lds_dwordx4 v2, s[80:81] offset:-2048
    ds_read_b128 a[248:251], v2 offset:3072
    v_mfma_f32_16x16x32_bf16 v[32:35], a[212:215], a[136:139], v[32:35]
    ds_read_b128 a[192:195], v2 offset:4096
    v_mfma_f32_16x16x32_bf16 v[36:39], a[216:219], a[136:139], v[36:39]
    ds_read_b128 a[196:199], v2 offset:5120
    v_mfma_f32_16x16x32_bf16 v[40:43], a[220:223], a[136:139], v[40:43]
    ds_read_b128 a[200:203], v2 offset:6144
    v_mfma_f32_16x16x32_bf16 v[44:47], a[224:227], a[136:139], v[44:47]
    global_load_lds_dwordx4 v2, s[80:81] offset:-1024
    ds_read_b128 a[204:207], v2 offset:7168
    v_mfma_f32_16x16x32_bf16 v[48:51], a[228:231], a[136:139], v[48:51]
    ds_read_b128 a[208:211], v2 offset:8192
    s_waitcnt lgkmcnt(5)
    v_mfma_f32_16x16x32_bf16 v[32:35], a[232:235], a[140:143], v[32:35]
    ds_read_b128 a[212:215], v2 offset:9216
    v_mfma_f32_16x16x32_bf16 v[36:39], a[236:239], a[140:143], v[36:39]
    ds_read_b128 a[216:219], v2 offset:10240
    s_add_u32 s79, s98, 4096
    s_add_u32 m0, s98, 135168
    s_add_u32 s80, s36, s79
    s_addc_u32 s81, s37, 0
    global_load_lds_dwordx4 v2, s[80:81] offset:-4096
    v_mfma_f32_16x16x32_bf16 v[40:43], a[240:243], a[140:143], v[40:43]
    ds_read_b128 a[220:223], v2 offset:11264
    v_mfma_f32_16x16x32_bf16 v[44:47], a[244:247], a[140:143], v[44:47]
    ds_read_b128 a[224:227], v2 offset:12288
    v_mfma_f32_16x16x32_bf16 v[48:51], a[248:251], a[140:143], v[48:51]
    ds_read_b128 a[228:231], v2 offset:13312
    s_waitcnt lgkmcnt(5)
    v_mfma_f32_16x16x32_bf16 v[32:35], a[192:195], a[144:147], v[32:35]
    global_load_lds_dwordx4 v2, s[80:81] offset:-3072
    ds_read_b128 a[232:235], v2 offset:14336
    v_mfma_f32_16x16x32_bf16 v[36:39], a[196:199], a[144:147], v[36:39]
    ds_read_b128 a[236:239], v2 offset:15360
    v_mfma_f32_16x16x32_bf16 v[40:43], a[200:203], a[144:147], v[40:43]
    ds_read_b128 a[240:243], v2 offset:16384
    v_mfma_f32_16x16x32_bf16 v[44:47], a[204:207], a[144:147], v[44:47]
    ds_read_b128 a[244:247], v2 offset:17408
    v_mfma_f32_16x16x32_bf16 v[48:51], a[208:211], a[144:147], v[48:51]
    global_load_lds_dwordx4 v2, s[80:81] offset:-2048
    ds_read_b128 a[248:251], v2 offset:18432
    s_waitcnt lgkmcnt(5)
    v_mfma_f32_16x16x32_bf16 v[32:35], a[212:215], a[148:151], v[32:35]
    ds_read_b128 a[192:195], v2 offset:19456
    v_mfma_f32_16x16x32_bf16 v[36:39], a[216:219], a[148:151], v[36:39]
    ds_read_b128 a[196:199], v2 offset:20480
    v_mfma_f32_16x16x32_bf16 v[40:43], a[220:223], a[148:151], v[40:43]
    ds_read_b128 a[200:203], v2 offset:21504
    v_mfma_f32_16x16x32_bf16 v[44:47], a[224:227], a[148:151], v[44:47]
    global_load_lds_dwordx4 v2, s[80:81] offset:-1024
    ds_read_b128 a[204:207], v2 offset:22528
    v_mfma_f32_16x16x32_bf16 v[48:51], a[228:231], a[148:151], v[48:51]
    ds_read_b128 a[208:211], v2 offset:23552
    s_waitcnt vmcnt(18)
    s_waitcnt lgkmcnt(0)
    s_barrier
    v_mfma_f32_16x16x32_bf16 v[32:35], a[232:235], a[152:155], v[32:35]
    ds_read_b128 a[212:215], v2 offset:24576
    v_mfma_f32_16x16x32_bf16 v[36:39], a[236:239], a[152:155], v[36:39]
    ds_read_b128 a[216:219], v2 offset:25600
    global_load_lds_dwordx4 v2, s[80:81] offset:0
    v_mfma_f32_16x16x32_bf16 v[40:43], a[240:243], a[152:155], v[40:43]
    ds_read_b128 a[220:223], v2 offset:26624
    v_mfma_f32_16x16x32_bf16 v[44:47], a[244:247], a[152:155], v[44:47]
    ds_read_b128 a[224:227], v2 offset:27648
    v_mfma_f32_16x16x32_bf16 v[48:51], a[248:251], a[152:155], v[48:51]
    ds_read_b128 a[228:231], v2 offset:28672
    v_mfma_f32_16x16x32_bf16 v[32:35], a[192:195], a[156:159], v[32:35]
    global_load_lds_dwordx4 v2, s[80:81] offset:1024
    ds_read_b128 a[232:235], v2 offset:29696
    v_mfma_f32_16x16x32_bf16 v[36:39], a[196:199], a[156:159], v[36:39]
    ds_read_b128 a[236:239], v2 offset:30720
    v_mfma_f32_16x16x32_bf16 v[40:43], a[200:203], a[156:159], v[40:43]
    ds_read_b128 a[240:243], v2 offset:31744
    v_mfma_f32_16x16x32_bf16 v[44:47], a[204:207], a[156:159], v[44:47]
    ds_read_b128 a[244:247], v2 offset:32768
    v_mfma_f32_16x16x32_bf16 v[48:51], a[208:211], a[156:159], v[48:51]
    s_add_u32 s79, s98, 53248
    s_add_u32 m0, s98, 69632
    s_add_u32 s80, s36, s79
    s_addc_u32 s81, s37, 0
    global_load_lds_dwordx4 v2, s[80:81] offset:-4096
    ds_read_b128 a[248:251], v2 offset:33792
    s_waitcnt lgkmcnt(5)
    v_mfma_f32_16x16x32_bf16 v[32:35], a[212:215], a[160:163], v[32:35]
    ds_read_b128 a[192:195], v2 offset:34816
    v_mfma_f32_16x16x32_bf16 v[36:39], a[216:219], a[160:163], v[36:39]
    ds_read_b128 a[196:199], v2 offset:35840
    v_mfma_f32_16x16x32_bf16 v[40:43], a[220:223], a[160:163], v[40:43]
    ds_read_b128 a[200:203], v2 offset:36864
    v_mfma_f32_16x16x32_bf16 v[44:47], a[224:227], a[160:163], v[44:47]
    global_load_lds_dwordx4 v2, s[80:81] offset:-3072
    ds_read_b128 a[204:207], v2 offset:37888
    v_mfma_f32_16x16x32_bf16 v[48:51], a[228:231], a[160:163], v[48:51]
    ds_read_b128 a[208:211], v2 offset:38912
    s_waitcnt lgkmcnt(5)
    v_mfma_f32_16x16x32_bf16 v[32:35], a[232:235], a[164:167], v[32:35]
    ds_read_b128 a[212:215], v2 offset:39936
    v_mfma_f32_16x16x32_bf16 v[36:39], a[236:239], a[164:167], v[36:39]
    ds_read_b128 a[216:219], v2 offset:40960
    global_load_lds_dwordx4 v2, s[80:81] offset:-2048
    v_mfma_f32_16x16x32_bf16 v[40:43], a[240:243], a[164:167], v[40:43]
    ds_read_b128 a[220:223], v2 offset:41984
    v_mfma_f32_16x16x32_bf16 v[44:47], a[244:247], a[164:167], v[44:47]
    ds_read_b128 a[224:227], v2 offset:43008
    v_mfma_f32_16x16x32_bf16 v[48:51], a[248:251], a[164:167], v[48:51]
    ds_read_b128 a[228:231], v2 offset:44032
    s_waitcnt lgkmcnt(5)
    v_mfma_f32_16x16x32_bf16 v[32:35], a[192:195], a[168:171], v[32:35]
    global_load_lds_dwordx4 v2, s[80:81] offset:-1024
    ds_read_b128 a[232:235], v2 offset:45056
    v_mfma_f32_16x16x32_bf16 v[36:39], a[196:199], a[168:171], v[36:39]
    ds_read_b128 a[236:239], v2 offset:46080
    v_mfma_f32_16x16x32_bf16 v[40:43], a[200:203], a[168:171], v[40:43]
    ds_read_b128 a[240:243], v2 offset:47104
    v_mfma_f32_16x16x32_bf16 v[44:47], a[204:207], a[168:171], v[44:47]
    ds_read_b128 a[244:247], v2 offset:48128
    v_mfma_f32_16x16x32_bf16 v[48:51], a[208:211], a[168:171], v[48:51]
    global_load_lds_dwordx4 v2, s[80:81] offset:0
    ds_read_b128 a[248:251], v2 offset:49152
    s_waitcnt vmcnt(15)
    s_barrier
    s_waitcnt lgkmcnt(5)
    v_mfma_f32_16x16x32_bf16 v[32:35], a[212:215], a[172:175], v[32:35]
    ds_read_b128 a[192:195], v2 offset:50176
    ds_read_b128 a[196:199], v2 offset:51200
    v_mfma_f32_16x16x32_bf16 v[36:39], a[216:219], a[172:175], v[36:39]
    ds_read_b128 a[200:203], v2 offset:52224
    v_lshlrev_b32 v72, 16, v56
    v_mfma_f32_16x16x32_bf16 v[40:43], a[220:223], a[172:175], v[40:43]
    ds_read_b128 a[204:207], v2 offset:53248
    global_load_lds_dwordx4 v2, s[80:81] offset:1024
    v_and_b32 v73, 0xffff0000, v56
    v_mfma_f32_16x16x32_bf16 v[44:47], a[224:227], a[172:175], v[44:47]
    ds_read_b128 a[208:211], v2 offset:54272
    v_lshlrev_b32 v74, 16, v57
    v_mfma_f32_16x16x32_bf16 v[48:51], a[228:231], a[172:175], v[48:51]
    v_and_b32 v75, 0xffff0000, v57
    s_waitcnt lgkmcnt(5)
    v_mfma_f32_16x16x32_bf16 v[32:35], a[232:235], a[176:179], v[32:35]
    ds_read_b128 a[212:215], v2 offset:55296
    ds_read_b128 a[216:219], v2 offset:56320
    s_add_u32 s79, s98, 77824
    s_add_u32 m0, s98, 94208
    s_add_u32 s80, s36, s79
    s_addc_u32 s81, s37, 0
    global_load_lds_dwordx4 v2, s[80:81] offset:-4096
    v_mfma_f32_16x16x32_bf16 v[36:39], a[236:239], a[176:179], v[36:39]
    ds_read_b128 a[220:223], v2 offset:57344
    v_lshlrev_b32 v76, 16, v58
    v_mfma_f32_16x16x32_bf16 v[40:43], a[240:243], a[176:179], v[40:43]
    ds_read_b128 a[224:227], v2 offset:58368
    v_and_b32 v77, 0xffff0000, v58
    v_mfma_f32_16x16x32_bf16 v[44:47], a[244:247], a[176:179], v[44:47]
    ds_read_b128 a[228:231], v2 offset:59392
    v_lshlrev_b32 v78, 16, v59
    v_mfma_f32_16x16x32_bf16 v[48:51], a[248:251], a[176:179], v[48:51]
    global_load_lds_dwordx4 v2, s[80:81] offset:-3072
    v_and_b32 v79, 0xffff0000, v59
    s_waitcnt lgkmcnt(5)
    v_mfma_f32_16x16x32_bf16 v[32:35], a[192:195], a[180:183], v[32:35]
    ds_read_b128 a[232:235], v2 offset:60416
    ds_read_b128 a[236:239], v2 offset:61440
    v_mfma_f32_16x16x32_bf16 v[36:39], a[196:199], a[180:183], v[36:39]
    ds_read_b128 a[240:243], v2 offset:62464
    v_lshlrev_b32 v80, 16, v60
    v_mfma_f32_16x16x32_bf16 v[40:43], a[200:203], a[180:183], v[40:43]
    global_load_lds_dwordx4 v2, s[80:81] offset:-2048
    ds_read_b128 a[244:247], v2 offset:63488
    v_and_b32 v81, 0xffff0000, v60
    v_mfma_f32_16x16x32_bf16 v[44:47], a[204:207], a[180:183], v[44:47]
    ds_read_b128 a[248:251], v2 offset:64512
    v_lshlrev_b32 v82, 16, v61
    v_mfma_f32_16x16x32_bf16 v[48:51], a[208:211], a[180:183], v[48:51]
    v_and_b32 v83, 0xffff0000, v61
    s_waitcnt lgkmcnt(5)
    v_mfma_f32_16x16x32_bf16 v[32:35], a[212:215], a[184:187], v[32:35]
    v_lshlrev_b32 v84, 16, v62
    global_load_lds_dwordx4 v2, s[80:81] offset:-1024
    v_mfma_f32_16x16x32_bf16 v[36:39], a[216:219], a[184:187], v[36:39]
    v_and_b32 v85, 0xffff0000, v62
    v_mfma_f32_16x16x32_bf16 v[40:43], a[220:223], a[184:187], v[40:43]
    v_lshlrev_b32 v86, 16, v63
    v_mfma_f32_16x16x32_bf16 v[44:47], a[224:227], a[184:187], v[44:47]
    v_and_b32 v87, 0xffff0000, v63
    v_mfma_f32_16x16x32_bf16 v[48:51], a[228:231], a[184:187], v[48:51]
    s_waitcnt lgkmcnt(0)
    global_load_lds_dwordx4 v2, s[80:81] offset:0
    v_mfma_f32_16x16x32_bf16 v[32:35], a[232:235], a[188:191], v[32:35]
    v_lshlrev_b32 v88, 16, v64
    v_mfma_f32_16x16x32_bf16 v[36:39], a[236:239], a[188:191], v[36:39]
    v_and_b32 v89, 0xffff0000, v64
    v_mfma_f32_16x16x32_bf16 v[40:43], a[240:243], a[188:191], v[40:43]
    v_lshlrev_b32 v90, 16, v65
    v_mfma_f32_16x16x32_bf16 v[44:47], a[244:247], a[188:191], v[44:47]
    global_load_lds_dwordx4 v2, s[80:81] offset:1024
    v_and_b32 v91, 0xffff0000, v65
    v_mfma_f32_16x16x32_bf16 v[48:51], a[248:251], a[188:191], v[48:51]
    s_barrier
    v_pk_add_f32 v[72:73], v[72:73], v[32:33]
    v_pk_add_f32 v[74:75], v[74:75], v[34:35]
    v_pk_add_f32 v[76:77], v[76:77], v[36:37]
    v_pk_add_f32 v[78:79], v[78:79], v[38:39]
    v_pk_add_f32 v[80:81], v[80:81], v[40:41]
    v_pk_add_f32 v[82:83], v[82:83], v[42:43]
    v_pk_add_f32 v[84:85], v[84:85], v[44:45]
    v_pk_add_f32 v[86:87], v[86:87], v[46:47]
    v_pk_add_f32 v[88:89], v[88:89], v[48:49]
    v_pk_add_f32 v[90:91], v[90:91], v[50:51]
    v_cvt_pk_bf16_f32 v96, v72, v73
    v_cvt_pk_bf16_f32 v97, v74, v75
    v_cvt_pk_bf16_f32 v98, v76, v77
    v_cvt_pk_bf16_f32 v99, v78, v79
    v_cvt_pk_bf16_f32 v100, v80, v81
    v_cvt_pk_bf16_f32 v101, v82, v83
    v_cvt_pk_bf16_f32 v102, v84, v85
    v_cvt_pk_bf16_f32 v103, v86, v87
    v_cvt_pk_bf16_f32 v104, v88, v89
    v_cvt_pk_bf16_f32 v105, v90, v91
    global_store_dwordx4 v2, v[96:99], s[16:17]
    global_store_dwordx4 v2, v[100:103], s[16:17] offset:1024
    global_store_dwordx2 v244, v[104:105], s[20:21]
    v_pk_add_f32 v[144:145], v[72:73], v[74:75]
    v_pk_mul_f32 v[146:147], v[72:73], v[72:73]
    v_pk_fma_f32 v[146:147], v[74:75], v[74:75], v[146:147]
    v_pk_add_f32 v[144:145], v[144:145], v[76:77]
    v_pk_fma_f32 v[146:147], v[76:77], v[76:77], v[146:147]
    v_pk_add_f32 v[144:145], v[144:145], v[78:79]
    v_pk_fma_f32 v[146:147], v[78:79], v[78:79], v[146:147]
    v_pk_add_f32 v[144:145], v[144:145], v[80:81]
    v_pk_fma_f32 v[146:147], v[80:81], v[80:81], v[146:147]
    v_pk_add_f32 v[144:145], v[144:145], v[82:83]
    v_pk_fma_f32 v[146:147], v[82:83], v[82:83], v[146:147]
    v_pk_add_f32 v[144:145], v[144:145], v[84:85]
    v_pk_fma_f32 v[146:147], v[84:85], v[84:85], v[146:147]
    v_pk_add_f32 v[144:145], v[144:145], v[86:87]
    v_pk_fma_f32 v[146:147], v[86:87], v[86:87], v[146:147]
    v_pk_add_f32 v[144:145], v[144:145], v[88:89]
    v_pk_fma_f32 v[146:147], v[88:89], v[88:89], v[146:147]
    v_pk_add_f32 v[144:145], v[144:145], v[90:91]
    v_pk_fma_f32 v[146:147], v[90:91], v[90:91], v[146:147]
    v_add_f32 v144, v144, v145
    v_add_f32 v145, v146, v147
    v_mov_b32 v148, v144
    v_mov_b32 v149, v145
    s_nop 0
    v_permlane16_swap_b32 v144, v148
    v_permlane16_swap_b32 v145, v149
    v_add_f32 v144, v144, v148
    v_add_f32 v145, v145, v149
    v_mov_b32 v148, v144
    v_mov_b32 v149, v145
    s_nop 0
    v_permlane32_swap_b32 v144, v148
    v_permlane32_swap_b32 v145, v149
    v_add_f32 v144, v144, v148
    v_add_f32 v145, v145, v149
    s_mov_b64 exec, 0xffff
    global_store_dwordx2 v2, v[144:145], s[46:47]
    s_mov_b64 exec, -1
    s_add_u32 s29, s29, 1
    v_mov_b32 v254, s29
    s_waitcnt vmcnt(0)
    s_barrier
    s_cmp_lg_u32 s24, 0
    s_nop 1
    s_cbranch_scc1 L_gb4_j_64
    s_mov_b64 exec, 1
    s_cmp_lg_u32 s27, 0
    s_cbranch_scc1 L_gb4_slowst_65
    global_store_dword v247, v254, s[0:1]
    s_branch L_gb4_st_66
L_gb4_slowst_65:
    buffer_wbl2 sc1
    s_waitcnt vmcnt(0)
    global_store_dword v247, v254, s[0:1] sc1
L_gb4_st_66:
    s_mov_b64 exec, 0xffff
    s_mov_b32 s3, 0
L_gb4_poll_62:
    global_load_dword v255, v246, s[0:1] sc1
    s_waitcnt vmcnt(0)
    v_cmp_gt_u32 vcc, s29, v255
    s_add_u32 s3, s3, 1
    s_cmp_gt_u32 s3, 4000000
    s_nop 2
    s_cbranch_scc1 L_gb4_bail_63
    s_cbranch_vccnz L_gb4_poll_62
L_gb4_bail_63:
    s_mov_b64 exec, -1
    s_cmp_eq_u32 s27, 0
    s_cbranch_scc1 L_gb4_j_64
    buffer_inv sc1
    s_waitcnt vmcnt(0)
L_gb4_j_64:
    s_barrier
    s_mov_b32 s28, 1
    global_load_dwordx4 a[0:3], v5, s[4:5] offset:-4096 sc1
    global_load_dwordx4 a[80:83], v7, s[4:5] offset:0 sc1
    global_load_dwordx4 a[4:7], v5, s[4:5] offset:-3072 sc1
    global_load_dwordx4 a[84:87], v7, s[4:5] offset:1024 sc1
    global_load_dwordx4 a[8:11], v5, s[4:5] offset:-2048 sc1
    global_load_dwordx4 a[88:91], v7, s[4:5] offset:2048 sc1
    s_lshl_b32 s30, s28, 20
    s_add_u32 s60, s86, s30
    s_addc_u32 s61, s87, 0
    s_add_u32 s62, s88, s30
    s_addc_u32 s63, s89, 0
    s_lshl_b32 s30, s28, 4
    s_add_u32 s30, s30, s26
    s_lshl_b32 s30, s30, 8
    s_add_u32 s67, s30, 8192
    s_lshl_b32 s30, s25, 2
    s_add_u32 s66, s67, s30
    s_barrier
    global_load_dwordx4 a[12:15], v5, s[4:5] offset:-1024 sc1
    ds_read_b128 a[160:163], v15 offset:0
    ds_read_b128 a[164:167], v15 offset:1024
    ds_read_b128 a[168:171], v15 offset:2048
    global_load_dwordx4 a[92:95], v7, s[4:5] offset:3072 sc1
    ds_read_b128 a[172:175], v15 offset:3072
    ds_read_b128 a[176:179], v15 offset:4096
    ds_read_b128 a[180:183], v15 offset:5120
    ds_read_b128 a[184:187], v15 offset:6144
    ds_read_b128 a[188:191], v15 offset:7168
    ds_read_b128 a[192:195], v15 offset:8192
    ds_read_b128 a[196:199], v15 offset:9216
    s_waitcnt lgkmcnt(5)
    s_waitcnt vmcnt(7)
    v_mfma_f32_16x16x32_bf16 v[32:35], a[160:163], a[0:3], 0
    ds_read_b128 a[200:203], v15 offset:10240
    s_waitcnt vmcnt(6)
    v_mfma_f32_16x16x32_bf16 v[52:55], a[160:163], a[80:83], 0
    global_load_dwordx4 a[16:19], v5, s[4:5] offset:0 sc1
    ds_read_b128 a[204:207], v15 offset:11264
    v_mfma_f32_16x16x32_bf16 v[36:39], a[164:167], a[0:3], 0
    ds_read_b128 a[208:211], v15 offset:12288
    v_mfma_f32_16x16x32_bf16 v[56:59], a[164:167], a[80:83], 0
    ds_read_b128 a[212:215], v15 offset:13312
    v_mfma_f32_16x16x32_bf16 v[40:43], a[168:171], a[0:3], 0
    global_load_dwordx4 a[96:99], v8, s[4:5] offset:-4096 sc1
    ds_read_b128 a[216:219], v15 offset:14336
    v_mfma_f32_16x16x32_bf16 v[60:63], a[168:171], a[80:83], 0
    v_mfma_f32_16x16x32_bf16 v[44:47], a[172:175], a[0:3], 0
    v_mfma_f32_16x16x32_bf16 v[64:67], a[172:175], a[80:83], 0
    global_load_dwordx4 a[20:23], v5, s[4:5] offset:1024 sc1
    v_mfma_f32_16x16x32_bf16 v[48:51], a[176:179], a[0:3], 0
    v_mfma_f32_16x16x32_bf16 v[68:71], a[176:179], a[80:83], 0
    s_waitcnt lgkmcnt(5)
    s_waitcnt vmcnt(8)
    v_mfma_f32_16x16x32_bf16 v[32:35], a[180:183], a[4:7], v[32:35]
    global_load_dwordx4 a[100:103], v8, s[4:5] offset:-3072 sc1
    ds_read_b128 a[160:163], v15 offset:15360
    s_waitcnt vmcnt(8)
    v_mfma_f32_16x16x32_bf16 v[52:55], a[180:183], a[84:87], v[52:55]
    ds_read_b128 a[164:167], v15 offset:16384
    v_mfma_f32_16x16x32_bf16 v[36:39], a[184:187], a[4:7], v[36:39]
    ds_read_b128 a[168:171], v15 offset:17408
    v_mfma_f32_16x16x32_bf16 v[56:59], a[184:187], a[84:87], v[56:59]
    global_load_dwordx4 a[24:27], v5, s[4:5] offset:2048 sc1
    ds_read_b128 a[172:175], v15 offset:18432
    v_mfma_f32_16x16x32_bf16 v[40:43], a[188:191], a[4:7], v[40:43]
    ds_read_b128 a[176:179], v15 offset:19456
    v_mfma_f32_16x16x32_bf16 v[60:63], a[188:191], a[84:87], v[60:63]
    v_mfma_f32_16x16x32_bf16 v[44:47], a[192:195], a[4:7], v[44:47]
    global_load_dwordx4 a[104:107], v8, s[4:5] offset:-2048 sc1
    v_mfma_f32_16x16x32_bf16 v[64:67], a[192:195], a[84:87], v[64:67]
    v_mfma_f32_16x16x32_bf16 v[48:51], a[196:199], a[4:7], v[48:51]
    v_mfma_f32_16x16x32_bf16 v[68:71], a[196:199], a[84:87], v[68:71]
    s_barrier
    s_waitcnt lgkmcnt(5)
    s_waitcnt vmcnt(9)
    v_mfma_f32_16x16x32_bf16 v[32:35], a[200:203], a[8:11], v[32:35]
    global_load_dwordx4 a[28:31], v5, s[4:5] offset:3072 sc1
    ds_read_b128 a[180:183], v15 offset:20480
    s_waitcnt vmcnt(9)
    v_mfma_f32_16x16x32_bf16 v[52:55], a[200:203], a[88:91], v[52:55]
    ds_read_b128 a[184:187], v15 offset:21504
    v_mfma_f32_16x16x32_bf16 v[36:39], a[204:207], a[8:11], v[36:39]
    ds_read_b128 a[188:191], v15 offset:22528
    global_load_dwordx4 a[108:111], v8, s[4:5] offset:-1024 sc1
    v_mfma_f32_16x16x32_bf16 v[56:59], a[204:207], a[88:91], v[56:59]
    ds_read_b128 a[192:195], v15 offset:23552
    v_mfma_f32_16x16x32_bf16 v[40:43], a[208:211], a[8:11], v[40:43]
    ds_read_b128 a[196:199], v10 offset:49152
    v_mfma_f32_16x16x32_bf16 v[60:63], a[208:211], a[88:91], v[60:63]
    global_load_dwordx4 a[32:35], v6, s[4:5] offset:-4096 sc1
    v_mfma_f32_16x16x32_bf16 v[44:47], a[212:215], a[8:11], v[44:47]
    v_mfma_f32_16x16x32_bf16 v[64:67], a[212:215], a[88:91], v[64:67]
    v_mfma_f32_16x16x32_bf16 v[48:51], a[216:219], a[8:11], v[48:51]
    v_mfma_f32_16x16x32_bf16 v[68:71], a[216:219], a[88:91], v[68:71]
    s_waitcnt lgkmcnt(5)
    global_load_dwordx4 a[112:115], v8, s[4:5] offset:0 sc1
    s_waitcnt vmcnt(11)
    v_mfma_f32_16x16x32_bf16 v[32:35], a[160:163], a[12:15], v[32:35]
    ds_read_b128 a[200:203], v10 offset:50176
    s_waitcnt vmcnt(10)
    v_mfma_f32_16x16x32_bf16 v[52:55], a[160:163], a[92:95], v[52:55]
    ds_read_b128 a[204:207], v10 offset:51200
    v_mfma_f32_16x16x32_bf16 v[36:39], a[164:167], a[12:15], v[36:39]
    global_load_dwordx4 v[16:19], v5, s[6:7] offset:-4096 sc1
    ds_read_b128 a[208:211], v10 offset:52224
    v_mfma_f32_16x16x32_bf16 v[56:59], a[164:167], a[92:95], v[56:59]
    ds_read_b128 a[212:215], v10 offset:53248
    v_mfma_f32_16x16x32_bf16 v[40:43], a[168:171], a[12:15], v[40:43]
    ds_read_b128 a[216:219], v10 offset:54272
    v_mfma_f32_16x16x32_bf16 v[60:63], a[168:171], a[92:95], v[60:63]
    global_load_dwordx4 v[20:23], v5, s[6:7] offset:-3072 sc1
    v_mfma_f32_16x16x32_bf16 v[44:47], a[172:175], a[12:15], v[44:47]
    v_mfma_f32_16x16x32_bf16 v[64:67], a[172:175], a[92:95], v[64:67]
    v_mfma_f32_16x16x32_bf16 v[48:51], a[176:179], a[12:15], v[48:51]
    global_load_dwordx4 a[36:39], v6, s[4:5] offset:-3072 sc1
    v_mfma_f32_16x16x32_bf16 v[68:71], a[176:179], a[92:95], v[68:71]
    s_waitcnt lgkmcnt(5)
    s_waitcnt vmcnt(12)
    v_mfma_f32_16x16x32_bf16 v[32:35], a[180:183], a[16:19], v[32:35]
    ds_read_b128 a[160:163], v10 offset:55296
    s_waitcnt vmcnt(11)
    v_mfma_f32_16x16x32_bf16 v[52:55], a[180:183], a[96:99], v[52:55]
    global_load_dwordx4 a[116:119], v8, s[4:5] offset:1024 sc1
    ds_read_b128 a[164:167], v10 offset:56320
    v_mfma_f32_16x16x32_bf16 v[36:39], a[184:187], a[16:19], v[36:39]
    ds_read_b128 a[168:171], v10 offset:57344
    v_mfma_f32_16x16x32_bf16 v[56:59], a[184:187], a[96:99], v[56:59]
    ds_read_b128 a[172:175], v10 offset:58368
    v_mfma_f32_16x16x32_bf16 v[40:43], a[188:191], a[16:19], v[40:43]
    global_load_dwordx4 a[40:43], v6, s[4:5] offset:-2048 sc1
    ds_read_b128 a[176:179], v10 offset:59392
    v_mfma_f32_16x16x32_bf16 v[60:63], a[188:191], a[96:99], v[60:63]
    v_mfma_f32_16x16x32_bf16 v[44:47], a[192:195], a[16:19], v[44:47]
    v_mfma_f32_16x16x32_bf16 v[64:67], a[192:195], a[96:99], v[64:67]
    global_load_dwordx4 a[120:123], v8, s[4:5] offset:2048 sc1
    v_mfma_f32_16x16x32_bf16 v[48:51], a[196:199], a[16:19], v[48:51]
    v_mfma_f32_16x16x32_bf16 v[68:71], a[196:199], a[96:99], v[68:71]
    s_waitcnt lgkmcnt(5)
    s_waitcnt vmcnt(13)
    v_mfma_f32_16x16x32_bf16 v[32:35], a[200:203], a[20:23], v[32:35]
    ds_read_b128 a[180:183], v10 offset:60416
    s_waitcnt vmcnt(12)
    v_mfma_f32_16x16x32_bf16 v[52:55], a[200:203], a[100:103], v[52:55]
    global_load_dwordx4 a[44:47], v6, s[4:5] offset:-1024 sc1
    ds_read_b128 a[184:187], v10 offset:61440
    v_mfma_f32_16x16x32_bf16 v[36:39], a[204:207], a[20:23], v[36:39]
    ds_read_b128 a[188:191], v10 offset:62464
    v_mfma_f32_16x16x32_bf16 v[56:59], a[204:207], a[100:103], v[56:59]
    ds_read_b128 a[192:195], v10 offset:63488
    global_load_dwordx4 a[124:127], v8, s[4:5] offset:3072 sc1
    v_mfma_f32_16x16x32_bf16 v[40:43], a[208:211], a[20:23], v[40:43]
    ds_read_b128 a[196:199], v10 offset:64512
    v_mfma_f32_16x16x32_bf16 v[60:63], a[208:211], a[100:103], v[60:63]
    v_mfma_f32_16x16x32_bf16 v[44:47], a[212:215], a[20:23], v[44:47]
    v_mfma_f32_16x16x32_bf16 v[64:67], a[212:215], a[100:103], v[64:67]
    global_load_dwordx4 a[48:51], v6, s[4:5] offset:0 sc1
    v_mfma_f32_16x16x32_bf16 v[48:51], a[216:219], a[20:23], v[48:51]
    v_mfma_f32_16x16x32_bf16 v[68:71], a[216:219], a[100:103], v[68:71]
    s_barrier
    s_waitcnt lgkmcnt(5)
    s_waitcnt vmcnt(14)
    v_mfma_f32_16x16x32_bf16 v[32:35], a[160:163], a[24:27], v[32:35]
    global_load_dwordx4 a[128:131], v9, s[4:5] offset:-4096 sc1
    ds_read_b128 a[200:203], v15 offset:24576
    s_waitcnt vmcnt(14)
    v_mfma_f32_16x16x32_bf16 v[52:55], a[160:163], a[104:107], v[52:55]
    ds_read_b128 a[204:207], v15 offset:25600
    v_mfma_f32_16x16x32_bf16 v[36:39], a[164:167], a[24:27], v[36:39]
    ds_read_b128 a[208:211], v15 offset:26624
    v_mfma_f32_16x16x32_bf16 v[56:59], a[164:167], a[104:107], v[56:59]
    global_load_dwordx4 a[52:55], v6, s[4:5] offset:1024 sc1
    ds_read_b128 a[212:215], v15 offset:27648
    v_mfma_f32_16x16x32_bf16 v[40:43], a[168:171], a[24:27], v[40:43]
    ds_read_b128 a[216:219], v15 offset:28672
    v_mfma_f32_16x16x32_bf16 v[60:63], a[168:171], a[104:107], v[60:63]
    v_mfma_f32_16x16x32_bf16 v[44:47], a[172:175], a[24:27], v[44:47]
    global_load_dwordx4 a[132:135], v9, s[4:5] offset:-3072 sc1
    v_mfma_f32_16x16x32_bf16 v[64:67], a[172:175], a[104:107], v[64:67]
    v_mfma_f32_16x16x32_bf16 v[48:51], a[176:179], a[24:27], v[48:51]
    v_mfma_f32_16x16x32_bf16 v[68:71], a[176:179], a[104:107], v[68:71]
    s_waitcnt lgkmcnt(5)
    global_load_dwordx4 a[56:59], v6, s[4:5] offset:2048 sc1
    s_waitcnt vmcnt(16)
    v_mfma_f32_16x16x32_bf16 v[32:35], a[180:183], a[28:31], v[32:35]
    ds_read_b128 a[160:163], v15 offset:29696
    s_waitcnt vmcnt(15)
    v_mfma_f32_16x16x32_bf16 v[52:55], a[180:183], a[108:111], v[52:55]
    ds_read_b128 a[164:167], v15 offset:30720
    v_mfma_f32_16x16x32_bf16 v[36:39], a[184:187], a[28:31], v[36:39]
    global_load_dwordx4 a[136:139], v9, s[4:5] offset:-2048 sc1
    ds_read_b128 a[168:171], v15 offset:31744
    v_mfma_f32_16x16x32_bf16 v[56:59], a[184:187], a[108:111], v[56:59]
    ds_read_b128 a[172:175], v10 offset:0
    v_mfma_f32_16x16x32_bf16 v[40:43], a[188:191], a[28:31], v[40:43]
    ds_read_b128 a[176:179], v10 offset:1024
    v_mfma_f32_16x16x32_bf16 v[60:63], a[188:191], a[108:111], v[60:63]
    global_load_dwordx4 a[60:63], v6, s[4:5] offset:3072 sc1
    v_mfma_f32_16x16x32_bf16 v[44:47], a[192:195], a[28:31], v[44:47]
    v_mfma_f32_16x16x32_bf16 v[64:67], a[192:195], a[108:111], v[64:67]
    v_mfma_f32_16x16x32_bf16 v[48:51], a[196:199], a[28:31], v[48:51]
    v_mfma_f32_16x16x32_bf16 v[68:71], a[196:199], a[108:111], v[68:71]
    s_waitcnt lgkmcnt(5)
    global_load_dwordx4 a[140:143], v9, s[4:5] offset:-1024 sc1
    s_waitcnt vmcnt(17)
    v_mfma_f32_16x16x32_bf16 v[32:35], a[200:203], a[32:35], v[32:35]
    ds_read_b128 a[180:183], v10 offset:2048
    s_waitcnt vmcnt(16)
    v_mfma_f32_16x16x32_bf16 v[52:55], a[200:203], a[112:115], v[52:55]
    ds_read_b128 a[184:187], v10 offset:3072
    v_mfma_f32_16x16x32_bf16 v[36:39], a[204:207], a[32:35], v[36:39]
    global_load_dwordx4 a[64:67], v7, s[4:5] offset:-4096 sc1
    ds_read_b128 a[188:191], v10 offset:4096
    v_mfma_f32_16x16x32_bf16 v[56:59], a[204:207], a[112:115], v[56:59]
    ds_read_b128 a[192:195], v10 offset:5120
    v_mfma_f32_16x16x32_bf16 v[40:43], a[208:211], a[32:35], v[40:43]
    ds_read_b128 a[196:199], v10 offset:6144
    global_load_dwordx4 a[144:147], v9, s[4:5] offset:0 sc1
    v_mfma_f32_16x16x32_bf16 v[60:63], a[208:211], a[112:115], v[60:63]
    v_mfma_f32_16x16x32_bf16 v[44:47], a[212:215], a[32:35], v[44:47]
    v_mfma_f32_16x16x32_bf16 v[64:67], a[212:215], a[112:115], v[64:67]
    v_mfma_f32_16x16x32_bf16 v[48:51], a[216:219], a[32:35], v[48:51]
    global_load_dwordx4 a[68:71], v7, s[4:5] offset:-3072 sc1
    v_mfma_f32_16x16x32_bf16 v[68:71], a[216:219], a[112:115], v[68:71]
    s_waitcnt lgkmcnt(5)
    s_waitcnt vmcnt(16)
    v_mfma_f32_16x16x32_bf16 v[32:35], a[160:163], a[36:39], v[32:35]
    ds_read_b128 a[200:203], v10 offset:7168
    s_waitcnt vmcnt(15)
    v_mfma_f32_16x16x32_bf16 v[52:55], a[160:163], a[116:119], v[52:55]
    global_load_dwordx4 a[148:151], v9, s[4:5] offset:1024 sc1
    ds_read_b128 a[204:207], v10 offset:8192
    v_mfma_f32_16x16x32_bf16 v[36:39], a[164:167], a[36:39], v[36:39]
    ds_read_b128 a[208:211], v10 offset:9216
    v_mfma_f32_16x16x32_bf16 v[56:59], a[164:167], a[116:119], v[56:59]
    ds_read_b128 a[212:215], v10 offset:10240
    v_mfma_f32_16x16x32_bf16 v[40:43], a[168:171], a[36:39], v[40:43]
    global_load_dwordx4 a[232:235], v5, s[8:9] offset:-4096
    ds_read_b128 a[216:219], v10 offset:11264
    v_mfma_f32_16x16x32_bf16 v[60:63], a[168:171], a[116:119], v[60:63]
    v_mfma_f32_16x16x32_bf16 v[44:47], a[172:175], a[36:39], v[44:47]
    v_mfma_f32_16x16x32_bf16 v[64:67], a[172:175], a[116:119], v[64:67]
    global_load_dwordx4 a[236:239], v5, s[8:9] offset:-3072
    v_mfma_f32_16x16x32_bf16 v[48:51], a[176:179], a[36:39], v[48:51]
    v_mfma_f32_16x16x32_bf16 v[68:71], a[176:179], a[116:119], v[68:71]
    s_waitcnt lgkmcnt(5)
    s_waitcnt vmcnt(17)
    v_mfma_f32_16x16x32_bf16 v[32:35], a[180:183], a[40:43], v[32:35]
    ds_read_b128 a[160:163], v10 offset:12288
    global_load_dwordx4 a[240:243], v5, s[8:9] offset:-2048
    s_waitcnt vmcnt(17)
    v_mfma_f32_16x16x32_bf16 v[52:55], a[180:183], a[120:123], v[52:55]
    ds_read_b128 a[164:167], v10 offset:13312
    v_mfma_f32_16x16x32_bf16 v[36:39], a[184:187], a[40:43], v[36:39]
    ds_read_b128 a[168:171], v10 offset:14336
    v_mfma_f32_16x16x32_bf16 v[56:59], a[184:187], a[120:123], v[56:59]
    global_load_dwordx4 a[244:247], v5, s[8:9] offset:-1024
    ds_read_b128 a[172:175], v10 offset:15360
    v_mfma_f32_16x16x32_bf16 v[40:43], a[188:191], a[40:43], v[40:43]
    ds_read_b128 a[176:179], v10 offset:16384
    v_mfma_f32_16x16x32_bf16 v[60:63], a[188:191], a[120:123], v[60:63]
    v_mfma_f32_16x16x32_bf16 v[44:47], a[192:195], a[40:43], v[44:47]
    global_load_dwordx4 a[248:251], v5, s[8:9] offset:0
    v_mfma_f32_16x16x32_bf16 v[64:67], a[192:195], a[120:123], v[64:67]
    v_mfma_f32_16x16x32_bf16 v[48:51], a[196:199], a[40:43], v[48:51]
    v_mfma_f32_16x16x32_bf16 v[68:71], a[196:199], a[120:123], v[68:71]
    s_waitcnt lgkmcnt(5)
    s_waitcnt vmcnt(18)
    v_mfma_f32_16x16x32_bf16 v[32:35], a[200:203], a[44:47], v[32:35]
    global_load_dwordx4 a[252:255], v5, s[8:9] offset:1024
    ds_read_b128 a[180:183], v10 offset:17408
    s_waitcnt vmcnt(18)
    v_mfma_f32_16x16x32_bf16 v[52:55], a[200:203], a[124:127], v[52:55]
    ds_read_b128 a[184:187], v10 offset:18432
    v_mfma_f32_16x16x32_bf16 v[36:39], a[204:207], a[44:47], v[36:39]
    ds_read_b128 a[188:191], v10 offset:19456
    v_mfma_f32_16x16x32_bf16 v[56:59], a[204:207], a[124:127], v[56:59]
    global_load_dwordx4 a[72:75], v7, s[4:5] offset:-2048 sc1
    ds_read_b128 a[192:195], v10 offset:20480
    v_mfma_f32_16x16x32_bf16 v[40:43], a[208:211], a[44:47], v[40:43]
    ds_read_b128 a[196:199], v10 offset:21504
    v_mfma_f32_16x16x32_bf16 v[60:63], a[208:211], a[124:127], v[60:63]
    v_mfma_f32_16x16x32_bf16 v[44:47], a[212:215], a[44:47], v[44:47]
    global_load_dwordx4 a[152:155], v9, s[4:5] offset:2048 sc1
    v_mfma_f32_16x16x32_bf16 v[64:67], a[212:215], a[124:127], v[64:67]
    v_mfma_f32_16x16x32_bf16 v[48:51], a[216:219], a[44:47], v[48:51]
    v_mfma_f32_16x16x32_bf16 v[68:71], a[216:219], a[124:127], v[68:71]
    s_barrier
    s_waitcnt lgkmcnt(5)
    global_load_dwordx4 a[76:79], v7, s[4:5] offset:-1024 sc1
    s_waitcnt vmcnt(20)
    v_mfma_f32_16x16x32_bf16 v[32:35], a[160:163], a[48:51], v[32:35]
    ds_read_b128 a[200:203], v10 offset:22528
    s_waitcnt vmcnt(19)
    v_mfma_f32_16x16x32_bf16 v[52:55], a[160:163], a[128:131], v[52:55]
    ds_read_b128 a[204:207], v10 offset:23552
    v_mfma_f32_16x16x32_bf16 v[36:39], a[164:167], a[48:51], v[36:39]
    global_load_dwordx4 a[156:159], v9, s[4:5] offset:3072 sc1
    ds_read_b128 a[208:211], v10 offset:24576
    v_mfma_f32_16x16x32_bf16 v[56:59], a[164:167], a[128:131], v[56:59]
    ds_read_b128 a[212:215], v10 offset:25600
    v_mfma_f32_16x16x32_bf16 v[40:43], a[168:171], a[48:51], v[40:43]
    ds_read_b128 a[216:219], v10 offset:26624
    v_mfma_f32_16x16x32_bf16 v[60:63], a[168:171], a[128:131], v[60:63]
    s_add_u32 s79, s100, 102400
    s_add_u32 m0, s100, 4096
    s_add_u32 s80, s36, s79
    s_addc_u32 s81, s37, 0
    global_load_lds_dwordx4 v2, s[80:81] offset:-4096
    v_mfma_f32_16x16x32_bf16 v[44:47], a[172:175], a[48:51], v[44:47]
    v_mfma_f32_16x16x32_bf16 v[64:67], a[172:175], a[128:131], v[64:67]
    v_mfma_f32_16x16x32_bf16 v[48:51], a[176:179], a[48:51], v[48:51]
    v_mfma_f32_16x16x32_bf16 v[68:71], a[176:179], a[128:131], v[68:71]
    s_waitcnt lgkmcnt(5)
    s_waitcnt vmcnt(20)
    v_mfma_f32_16x16x32_bf16 v[32:35], a[180:183], a[52:55], v[32:35]
    global_load_lds_dwordx4 v2, s[80:81] offset:-3072
    ds_read_b128 a[160:163], v10 offset:27648
    v_add_f32 v16, v16, v18
    s_waitcnt vmcnt(20)
    v_mfma_f32_16x16x32_bf16 v[52:55], a[180:183], a[132:135], v[52:55]
    ds_read_b128 a[164:167], v10 offset:28672
    v_add_f32 v20, v20, v22
    v_mfma_f32_16x16x32_bf16 v[36:39], a[184:187], a[52:55], v[36:39]
    ds_read_b128 a[168:171], v10 offset:29696
    v_add_f32 v17, v17, v19
    v_mfma_f32_16x16x32_bf16 v[56:59], a[184:187], a[132:135], v[56:59]
    global_load_lds_dwordx4 v2, s[80:81] offset:-2048
    ds_read_b128 a[172:175], v10 offset:30720
    v_add_f32 v21, v21, v23
    v_mfma_f32_16x16x32_bf16 v[40:43], a[188:191], a[52:55], v[40:43]
    ds_read_b128 a[176:179], v10 offset:31744
    v_mfma_f32_16x16x32_bf16 v[60:63], a[188:191], a[132:135], v[60:63]
    v_mov_b32 v28, v16
    v_mfma_f32_16x16x32_bf16 v[44:47], a[192:195], a[52:55], v[44:47]
    v_mov_b32 v30, v20
    v_mfma_f32_16x16x32_bf16 v[64:67], a[192:195], a[132:135], v[64:67]
    v_mov_b32 v29, v17
    v_mfma_f32_16x16x32_bf16 v[48:51], a[196:199], a[52:55], v[48:51]
    v_mov_b32 v31, v21
    v_mfma_f32_16x16x32_bf16 v[68:71], a[196:199], a[132:135], v[68:71]
    v_permlane16_swap_b32 v16, v28
    s_waitcnt lgkmcnt(5)
    s_waitcnt vmcnt(20)
    v_mfma_f32_16x16x32_bf16 v[32:35], a[200:203], a[56:59], v[32:35]
    ds_read_b128 a[180:183], v10 offset:32768
    v_permlane16_swap_b32 v20, v30
    s_waitcnt vmcnt(19)
    v_mfma_f32_16x16x32_bf16 v[52:55], a[200:203], a[136:139], v[52:55]
    ds_read_b128 a[184:187], v10 offset:33792
    v_permlane16_swap_b32 v17, v29
    v_mfma_f32_16x16x32_bf16 v[36:39], a[204:207], a[56:59], v[36:39]
    ds_read_b128 a[188:191], v10 offset:34816
    v_permlane16_swap_b32 v21, v31
    v_mfma_f32_16x16x32_bf16 v[56:59], a[204:207], a[136:139], v[56:59]
    ds_read_b128 a[192:195], v10 offset:35840
    v_add_f32 v16, v16, v28
    v_mfma_f32_16x16x32_bf16 v[40:43], a[208:211], a[56:59], v[40:43]
    ds_read_b128 a[196:199], v10 offset:36864
    v_mfma_f32_16x16x32_bf16 v[60:63], a[208:211], a[136:139], v[60:63]
    v_add_f32 v20, v20, v30
    v_mfma_f32_16x16x32_bf16 v[44:47], a[212:215], a[56:59], v[44:47]
    v_add_f32 v17, v17, v29
    v_mfma_f32_16x16x32_bf16 v[64:67], a[212:215], a[136:139], v[64:67]
    v_add_f32 v21, v21, v31
    v_mfma_f32_16x16x32_bf16 v[48:51], a[216:219], a[56:59], v[48:51]
    v_mov_b32 v28, v16
    v_mfma_f32_16x16x32_bf16 v[68:71], a[216:219], a[136:139], v[68:71]
    v_mov_b32 v30, v20
    s_waitcnt lgkmcnt(5)
    s_waitcnt vmcnt(18)
    v_mfma_f32_16x16x32_bf16 v[32:35], a[160:163], a[60:63], v[32:35]
    ds_read_b128 a[200:203], v10 offset:37888
    v_mov_b32 v29, v17
    s_waitcnt vmcnt(17)
    v_mfma_f32_16x16x32_bf16 v[52:55], a[160:163], a[140:143], v[52:55]
    ds_read_b128 a[204:207], v10 offset:38912
    v_mov_b32 v31, v21
    v_mfma_f32_16x16x32_bf16 v[36:39], a[164:167], a[60:63], v[36:39]
    ds_read_b128 a[208:211], v10 offset:39936
    v_permlane32_swap_b32 v16, v28
    v_mfma_f32_16x16x32_bf16 v[56:59], a[164:167], a[140:143], v[56:59]
    ds_read_b128 a[212:215], v10 offset:40960
    v_permlane32_swap_b32 v20, v30
    v_mfma_f32_16x16x32_bf16 v[40:43], a[168:171], a[60:63], v[40:43]
    ds_read_b128 a[216:219], v10 offset:41984
    v_mfma_f32_16x16x32_bf16 v[60:63], a[168:171], a[140:143], v[60:63]
    v_permlane32_swap_b32 v17, v29
    v_mfma_f32_16x16x32_bf16 v[44:47], a[172:175], a[60:63], v[44:47]
    v_permlane32_swap_b32 v21, v31
    v_mfma_f32_16x16x32_bf16 v[64:67], a[172:175], a[140:143], v[64:67]
    v_add_f32 v16, v16, v28
    v_mfma_f32_16x16x32_bf16 v[48:51], a[176:179], a[60:63], v[48:51]
    v_add_f32 v20, v20, v30
    v_mfma_f32_16x16x32_bf16 v[68:71], a[176:179], a[140:143], v[68:71]
    v_add_f32 v17, v17, v29
    s_waitcnt lgkmcnt(5)
    s_waitcnt vmcnt(16)
    v_mfma_f32_16x16x32_bf16 v[32:35], a[180:183], a[64:67], v[32:35]
    ds_read_b128 a[160:163], v10 offset:43008
    v_add_f32 v21, v21, v31
    s_waitcnt vmcnt(15)
    v_mfma_f32_16x16x32_bf16 v[52:55], a[180:183], a[144:147], v[52:55]
    ds_read_b128 a[164:167], v10 offset:44032
    v_mul_f32 v16, 0xbacccccd, v16
    v_mfma_f32_16x16x32_bf16 v[36:39], a[184:187], a[64:67], v[36:39]
    ds_read_b128 a[168:171], v10 offset:45056
    v_mul_f32 v20, 0xbacccccd, v20
    v_mfma_f32_16x16x32_bf16 v[56:59], a[184:187], a[144:147], v[56:59]
    ds_read_b128 a[172:175], v10 offset:46080
    v_mul_f32 v17, 0x3acccccd, v17
    v_mfma_f32_16x16x32_bf16 v[40:43], a[188:191], a[64:67], v[40:43]
    ds_read_b128 a[176:179], v10 offset:47104
    v_mfma_f32_16x16x32_bf16 v[60:63], a[188:191], a[144:147], v[60:63]
    v_mul_f32 v21, 0x3acccccd, v21
    v_mfma_f32_16x16x32_bf16 v[44:47], a[192:195], a[64:67], v[44:47]
    v_fma_f32 v17, -v16, v16, v17
    v_mfma_f32_16x16x32_bf16 v[64:67], a[192:195], a[144:147], v[64:67]
    v_fma_f32 v21, -v20, v20, v21
    v_mfma_f32_16x16x32_bf16 v[48:51], a[196:199], a[64:67], v[48:51]
    v_max_f32 v17, 0, v17
    v_mfma_f32_16x16x32_bf16 v[68:71], a[196:199], a[144:147], v[68:71]
    v_max_f32 v21, 0, v21
    s_waitcnt vmcnt(0)
    s_barrier
    s_waitcnt lgkmcnt(5)
    v_mfma_f32_16x16x32_bf16 v[32:35], a[200:203], a[68:71], v[32:35]
    ds_read_b128 a[180:183], v10 offset:48128
    v_add_f32 v17, 0x3727c5ac, v17
    v_mfma_f32_16x16x32_bf16 v[52:55], a[200:203], a[148:151], v[52:55]
    ds_read_b128 a[184:187], v2 offset:0
    v_add_f32 v21, 0x3727c5ac, v21
    v_mfma_f32_16x16x32_bf16 v[36:39], a[204:207], a[68:71], v[36:39]
    ds_read_b128 a[188:191], v2 offset:1024
    v_rsq_f32 v24, v17
    v_mfma_f32_16x16x32_bf16 v[56:59], a[204:207], a[148:151], v[56:59]
    ds_read_b128 a[192:195], v2 offset:2048
    v_rsq_f32 v26, v21
    v_mfma_f32_16x16x32_bf16 v[40:43], a[208:211], a[68:71], v[40:43]
    ds_read_b128 a[196:199], v2 offset:3072
    v_mfma_f32_16x16x32_bf16 v[60:63], a[208:211], a[148:151], v[60:63]
    v_cvt_pk_bf16_f32 v28, v16, v16
    v_mfma_f32_16x16x32_bf16 v[44:47], a[212:215], a[68:71], v[44:47]
    v_cvt_pk_bf16_f32 v30, v20, v20
    v_mfma_f32_16x16x32_bf16 v[64:67], a[212:215], a[148:151], v[64:67]
    v_and_b32 v28, 0xffff0000, v28
    v_mfma_f32_16x16x32_bf16 v[48:51], a[216:219], a[68:71], v[48:51]
    v_and_b32 v30, 0xffff0000, v30
    v_mfma_f32_16x16x32_bf16 v[68:71], a[216:219], a[148:151], v[68:71]
    v_sub_f32 v28, v16, v28
    s_waitcnt lgkmcnt(5)
    v_mfma_f32_16x16x32_bf16 v[32:35], a[160:163], a[72:75], v[32:35]
    ds_read_b128 a[200:203], v2 offset:4096
    v_sub_f32 v30, v20, v30
    v_mfma_f32_16x16x32_bf16 v[52:55], a[160:163], a[152:155], v[52:55]
    ds_read_b128 a[204:207], v2 offset:5120
    v_cvt_pk_bf16_f32 v104, v16, v28
    v_mfma_f32_16x16x32_bf16 v[36:39], a[164:167], a[72:75], v[36:39]
    ds_read_b128 a[208:211], v2 offset:6144
    v_cvt_pk_bf16_f32 v108, v20, v30
    v_mfma_f32_16x16x32_bf16 v[56:59], a[164:167], a[152:155], v[56:59]
    ds_read_b128 a[212:215], v2 offset:7168
    v_mov_b32 v106, 0
    v_mfma_f32_16x16x32_bf16 v[40:43], a[168:171], a[72:75], v[40:43]
    ds_read_b128 a[216:219], v2 offset:8192
    v_mfma_f32_16x16x32_bf16 v[60:63], a[168:171], a[152:155], v[60:63]
    v_mov_b32 v110, 0
    v_mfma_f32_16x16x32_bf16 v[44:47], a[172:175], a[72:75], v[44:47]
    v_cvt_pk_bf16_f32 v105, v16, v106
    v_mfma_f32_16x16x32_bf16 v[64:67], a[172:175], a[152:155], v[64:67]
    v_cvt_pk_bf16_f32 v109, v20, v110
    v_mfma_f32_16x16x32_bf16 v[48:51], a[176:179], a[72:75], v[48:51]
    v_mov_b32 v107, 0
    v_mfma_f32_16x16x32_bf16 v[68:71], a[176:179], a[152:155], v[68:71]
    v_mov_b32 v111, 0
    s_waitcnt lgkmcnt(5)
    v_mfma_f32_16x16x32_bf16 v[32:35], a[180:183], a[76:79], v[32:35]
    v_mfma_f32_16x16x32_bf16 v[52:55], a[180:183], a[156:159], v[52:55]
    v_mfma_f32_16x16x32_bf16 v[36:39], a[184:187], a[76:79], v[36:39]
    v_mfma_f32_16x16x32_bf16 v[56:59], a[184:187], a[156:159], v[56:59]
    v_mfma_f32_16x16x32_bf16 v[40:43], a[188:191], a[76:79], v[40:43]
    v_mfma_f32_16x16x32_bf16 v[60:63], a[188:191], a[156:159], v[60:63]
    v_mfma_f32_16x16x32_bf16 v[44:47], a[192:195], a[76:79], v[44:47]
    v_mfma_f32_16x16x32_bf16 v[64:67], a[192:195], a[156:159], v[64:67]
    v_mfma_f32_16x16x32_bf16 v[48:51], a[196:199], a[76:79], v[48:51]
    v_mfma_f32_16x16x32_bf16 v[68:71], a[196:199], a[156:159], v[68:71]
    s_waitcnt lgkmcnt(0)
    v_mfma_f32_16x16x32_bf16 v[32:35], a[200:203], v[104:107], v[32:35]
    v_mfma_f32_16x16x32_bf16 v[52:55], a[200:203], v[108:111], v[52:55]
    v_mfma_f32_16x16x32_bf16 v[36:39], a[204:207], v[104:107], v[36:39]
    v_mfma_f32_16x16x32_bf16 v[56:59], a[204:207], v[108:111], v[56:59]
    v_mfma_f32_16x16x32_bf16 v[40:43], a[208:211], v[104:107], v[40:43]
    v_mfma_f32_16x16x32_bf16 v[60:63], a[208:211], v[108:111], v[60:63]
    v_mfma_f32_16x16x32_bf16 v[44:47], a[212:215], v[104:107], v[44:47]
    v_mfma_f32_16x16x32_bf16 v[64:67], a[212:215], v[108:111], v[64:67]
    v_mfma_f32_16x16x32_bf16 v[48:51], a[216:219], v[104:107], v[48:51]
    v_mfma_f32_16x16x32_bf16 v[68:71], a[216:219], v[108:111], v[68:71]
    s_nop 7
    s_branch L_layer
L_last_61:
    global_load_dwordx4 a[0:3], v5, s[12:13] offset:-4096 sc1
    global_load_dwordx4 a[4:7], v5, s[12:13] offset:-3072 sc1
    global_load_dwordx4 a[8:11], v5, s[12:13] offset:-2048 sc1
    global_load_dwordx4 a[12:15], v5, s[12:13] offset:-1024 sc1
    global_load_dwordx4 a[16:19], v5, s[12:13] offset:0 sc1
    global_load_dwordx4 a[20:23], v5, s[12:13] offset:1024 sc1
    s_barrier
    global_load_dwordx4 a[24:27], v5, s[12:13] offset:2048 sc1
    ds_read_b128 a[192:195], v10 offset:32768
    ds_read_b128 a[196:199], v10 offset:33792
    ds_read_b128 a[200:203], v10 offset:34816
    ds_read_b128 a[204:207], v10 offset:35840
    ds_read_b128 a[208:211], v10 offset:36864
    ds_read_b128 a[212:215], v10 offset:37888
    ds_read_b128 a[216:219], v10 offset:38912
    ds_read_b128 a[220:223], v10 offset:39936
    ds_read_b128 a[224:227], v10 offset:40960
    global_load_dwordx4 a[28:31], v5, s[12:13] offset:3072 sc1
    ds_read_b128 a[228:231], v10 offset:41984
    s_waitcnt lgkmcnt(5)
    s_waitcnt vmcnt(7)
    v_mfma_f32_16x16x32_bf16 v[32:35], a[192:195], a[0:3], 0
    ds_read_b128 a[232:235], v10 offset:43008
    v_mfma_f32_16x16x32_bf16 v[36:39], a[196:199], a[0:3], 0
    global_load_dwordx4 a[32:35], v6, s[12:13] offset:-4096 sc1
    ds_read_b128 a[236:239], v10 offset:44032
    v_mfma_f32_16x16x32_bf16 v[40:43], a[200:203], a[0:3], 0
    ds_read_b128 a[240:243], v10 offset:45056
    v_mfma_f32_16x16x32_bf16 v[44:47], a[204:207], a[0:3], 0
    global_load_dwordx4 a[36:39], v6, s[12:13] offset:-3072 sc1
    ds_read_b128 a[244:247], v10 offset:46080
    v_mfma_f32_16x16x32_bf16 v[48:51], a[208:211], a[0:3], 0
    ds_read_b128 a[248:251], v10 offset:47104
    s_barrier
    s_waitcnt lgkmcnt(5)
    s_waitcnt vmcnt(8)
    v_mfma_f32_16x16x32_bf16 v[32:35], a[212:215], a[4:7], v[32:35]
    global_load_dwordx4 a[40:43], v6, s[12:13] offset:-2048 sc1
    ds_read_b128 a[192:195], v10 offset:48128
    v_mfma_f32_16x16x32_bf16 v[36:39], a[216:219], a[4:7], v[36:39]
    ds_read_b128 a[196:199], v2 offset:0
    global_load_dwordx4 a[44:47], v6, s[12:13] offset:-1024 sc1
    v_mfma_f32_16x16x32_bf16 v[40:43], a[220:223], a[4:7], v[40:43]
    ds_read_b128 a[200:203], v2 offset:1024
    v_mfma_f32_16x16x32_bf16 v[44:47], a[224:227], a[4:7], v[44:47]
    global_load_dwordx4 a[48:51], v6, s[12:13] offset:0 sc1
    ds_read_b128 a[204:207], v2 offset:2048
    v_mfma_f32_16x16x32_bf16 v[48:51], a[228:231], a[4:7], v[48:51]
    ds_read_b128 a[208:211], v2 offset:3072
    s_waitcnt lgkmcnt(5)
    s_waitcnt vmcnt(10)
    v_mfma_f32_16x16x32_bf16 v[32:35], a[232:235], a[8:11], v[32:35]
    global_load_dwordx4 a[52:55], v6, s[12:13] offset:1024 sc1
    ds_read_b128 a[212:215], v2 offset:4096
    v_mfma_f32_16x16x32_bf16 v[36:39], a[236:239], a[8:11], v[36:39]
    ds_read_b128 a[216:219], v2 offset:5120
    v_mfma_f32_16x16x32_bf16 v[40:43], a[240:243], a[8:11], v[40:43]
    global_load_dwordx4 a[56:59], v6, s[12:13] offset:2048 sc1
    ds_read_b128 a[220:223], v2 offset:6144
    v_mfma_f32_16x16x32_bf16 v[44:47], a[244:247], a[8:11], v[44:47]
    ds_read_b128 a[224:227], v2 offset:7168
    v_mfma_f32_16x16x32_bf16 v[48:51], a[248:251], a[8:11], v[48:51]
    global_load_dwordx4 a[60:63], v6, s[12:13] offset:3072 sc1
    ds_read_b128 a[228:231], v2 offset:8192
    s_waitcnt lgkmcnt(5)
    s_waitcnt vmcnt(12)
    v_mfma_f32_16x16x32_bf16 v[32:35], a[192:195], a[12:15], v[32:35]
    ds_read_b128 a[232:235], v2 offset:9216
    global_load_dwordx4 a[64:67], v7, s[12:13] offset:-4096 sc1
    v_mfma_f32_16x16x32_bf16 v[36:39], a[196:199], a[12:15], v[36:39]
    ds_read_b128 a[236:239], v2 offset:10240
    v_mfma_f32_16x16x32_bf16 v[40:43], a[200:203], a[12:15], v[40:43]
    global_load_dwordx4 a[68:71], v7, s[12:13] offset:-3072 sc1
    ds_read_b128 a[240:243], v2 offset:11264
    v_mfma_f32_16x16x32_bf16 v[44:47], a[204:207], a[12:15], v[44:47]
    ds_read_b128 a[244:247], v2 offset:12288
    v_mfma_f32_16x16x32_bf16 v[48:51], a[208:211], a[12:15], v[48:51]
    global_load_dwordx4 a[72:75], v7, s[12:13] offset:-2048 sc1
    ds_read_b128 a[248:251], v2 offset:13312
    s_waitcnt lgkmcnt(5)
    s_waitcnt vmcnt(14)
    v_mfma_f32_16x16x32_bf16 v[32:35], a[212:215], a[16:19], v[32:35]
    ds_read_b128 a[192:195], v2 offset:14336
    v_mfma_f32_16x16x32_bf16 v[36:39], a[216:219], a[16:19], v[36:39]
    global_load_dwordx4 a[76:79], v7, s[12:13] offset:-1024 sc1
    ds_read_b128 a[196:199], v2 offset:15360
    v_mfma_f32_16x16x32_bf16 v[40:43], a[220:223], a[16:19], v[40:43]
    ds_read_b128 a[200:203], v2 offset:16384
    v_mfma_f32_16x16x32_bf16 v[44:47], a[224:227], a[16:19], v[44:47]
    global_load_dwordx4 a[80:83], v7, s[12:13] offset:0 sc1
    ds_read_b128 a[204:207], v2 offset:17408
    v_mfma_f32_16x16x32_bf16 v[48:51], a[228:231], a[16:19], v[48:51]
    ds_read_b128 a[208:211], v2 offset:18432
    s_waitcnt lgkmcnt(5)
    global_load_dwordx4 a[84:87], v7, s[12:13] offset:1024 sc1
    s_waitcnt vmcnt(16)
    v_mfma_f32_16x16x32_bf16 v[32:35], a[232:235], a[20:23], v[32:35]
    ds_read_b128 a[212:215], v2 offset:19456
    v_mfma_f32_16x16x32_bf16 v[36:39], a[236:239], a[20:23], v[36:39]
    s_add_u32 s79, s98, 135168
    s_add_u32 m0, s98, 69632
    s_add_u32 s80, s44, s79
    s_addc_u32 s81, s45, 0
    global_load_lds_dwordx4 v2, s[80:81] offset:-4096
    ds_read_b128 a[216:219], v2 offset:20480
    v_mfma_f32_16x16x32_bf16 v[40:43], a[240:243], a[20:23], v[40:43]
    ds_read_b128 a[220:223], v2 offset:21504
    v_mfma_f32_16x16x32_bf16 v[44:47], a[244:247], a[20:23], v[44:47]
    ds_read_b128 a[224:227], v2 offset:22528
    v_mfma_f32_16x16x32_bf16 v[48:51], a[248:251], a[20:23], v[48:51]
    ds_read_b128 a[228:231], v2 offset:23552
    s_waitcnt lgkmcnt(0)
    s_barrier
    s_waitcnt vmcnt(16)
    v_mfma_f32_16x16x32_bf16 v[32:35], a[192:195], a[24:27], v[32:35]
    global_load_dwordx4 a[88:91], v7, s[12:13] offset:2048 sc1
    ds_read_b128 a[232:235], v2 offset:24576
    v_mfma_f32_16x16x32_bf16 v[36:39], a[196:199], a[24:27], v[36:39]
    ds_read_b128 a[236:239], v2 offset:25600
    v_mfma_f32_16x16x32_bf16 v[40:43], a[200:203], a[24:27], v[40:43]
    global_load_lds_dwordx4 v2, s[80:81] offset:-3072
    ds_read_b128 a[240:243], v2 offset:26624
    v_mfma_f32_16x16x32_bf16 v[44:47], a[204:207], a[24:27], v[44:47]
    ds_read_b128 a[244:247], v2 offset:27648
    v_mfma_f32_16x16x32_bf16 v[48:51], a[208:211], a[24:27], v[48:51]
    ds_read_b128 a[248:251], v2 offset:28672
    s_waitcnt vmcnt(17)
    v_mfma_f32_16x16x32_bf16 v[32:35], a[212:215], a[28:31], v[32:35]
    global_load_dwordx4 a[92:95], v7, s[12:13] offset:3072 sc1
    ds_read_b128 a[192:195], v2 offset:29696
    v_mfma_f32_16x16x32_bf16 v[36:39], a[216:219], a[28:31], v[36:39]
    ds_read_b128 a[196:199], v2 offset:30720
    v_mfma_f32_16x16x32_bf16 v[40:43], a[220:223], a[28:31], v[40:43]
    global_load_lds_dwordx4 v2, s[80:81] offset:-2048
    ds_read_b128 a[200:203], v2 offset:31744
    v_mfma_f32_16x16x32_bf16 v[44:47], a[224:227], a[28:31], v[44:47]
    ds_read_b128 a[204:207], v2 offset:32768
    v_mfma_f32_16x16x32_bf16 v[48:51], a[228:231], a[28:31], v[48:51]
    ds_read_b128 a[208:211], v2 offset:33792
    s_waitcnt lgkmcnt(5)
    s_waitcnt vmcnt(18)
    v_mfma_f32_16x16x32_bf16 v[32:35], a[232:235], a[32:35], v[32:35]
    ds_read_b128 a[212:215], v2 offset:34816
    global_load_dwordx4 a[96:99], v8, s[12:13] offset:-4096 sc1
    v_mfma_f32_16x16x32_bf16 v[36:39], a[236:239], a[32:35], v[36:39]
    ds_read_b128 a[216:219], v2 offset:35840
    v_mfma_f32_16x16x32_bf16 v[40:43], a[240:243], a[32:35], v[40:43]
    global_load_lds_dwordx4 v2, s[80:81] offset:-1024
    ds_read_b128 a[220:223], v2 offset:36864
    v_mfma_f32_16x16x32_bf16 v[44:47], a[244:247], a[32:35], v[44:47]
    ds_read_b128 a[224:227], v2 offset:37888
    v_mfma_f32_16x16x32_bf16 v[48:51], a[248:251], a[32:35], v[48:51]
    ds_read_b128 a[228:231], v2 offset:38912
    s_waitcnt lgkmcnt(5)
    s_waitcnt vmcnt(19)
    v_mfma_f32_16x16x32_bf16 v[32:35], a[192:195], a[36:39], v[32:35]
    ds_read_b128 a[232:235], v2 offset:39936
    v_mfma_f32_16x16x32_bf16 v[36:39], a[196:199], a[36:39], v[36:39]
    global_load_dwordx4 a[100:103], v8, s[12:13] offset:-3072 sc1
    ds_read_b128 a[236:239], v2 offset:40960
    v_mfma_f32_16x16x32_bf16 v[40:43], a[200:203], a[36:39], v[40:43]
    ds_read_b128 a[240:243], v2 offset:41984
    global_load_lds_dwordx4 v2, s[80:81] offset:0
    v_mfma_f32_16x16x32_bf16 v[44:47], a[204:207], a[36:39], v[44:47]
    ds_read_b128 a[244:247], v2 offset:43008
    v_mfma_f32_16x16x32_bf16 v[48:51], a[208:211], a[36:39], v[48:51]
    ds_read_b128 a[248:251], v2 offset:44032
    s_waitcnt lgkmcnt(5)
    s_waitcnt vmcnt(20)
    v_mfma_f32_16x16x32_bf16 v[32:35], a[212:215], a[40:43], v[32:35]
    ds_read_b128 a[192:195], v2 offset:45056
    v_mfma_f32_16x16x32_bf16 v[36:39], a[216:219], a[40:43], v[36:39]
    global_load_dwordx4 a[104:107], v8, s[12:13] offset:-2048 sc1
    ds_read_b128 a[196:199], v2 offset:46080
    v_mfma_f32_16x16x32_bf16 v[40:43], a[220:223], a[40:43], v[40:43]
    ds_read_b128 a[200:203], v2 offset:47104
    v_mfma_f32_16x16x32_bf16 v[44:47], a[224:227], a[40:43], v[44:47]
    global_load_lds_dwordx4 v2, s[80:81] offset:1024
    ds_read_b128 a[204:207], v2 offset:48128
    v_mfma_f32_16x16x32_bf16 v[48:51], a[228:231], a[40:43], v[48:51]
    ds_read_b128 a[208:211], v2 offset:49152
    s_waitcnt lgkmcnt(0)
    s_barrier
    s_waitcnt vmcnt(21)
    v_mfma_f32_16x16x32_bf16 v[32:35], a[232:235], a[44:47], v[32:35]
    ds_read_b128 a[212:215], v2 offset:50176
    v_mfma_f32_16x16x32_bf16 v[36:39], a[236:239], a[44:47], v[36:39]
    global_load_dwordx4 a[108:111], v8, s[12:13] offset:-1024 sc1
    ds_read_b128 a[216:219], v2 offset:51200
    v_mfma_f32_16x16x32_bf16 v[40:43], a[240:243], a[44:47], v[40:43]
    ds_read_b128 a[220:223], v2 offset:52224
    v_mfma_f32_16x16x32_bf16 v[44:47], a[244:247], a[44:47], v[44:47]
    s_add_u32 s79, s98, 159744
    s_add_u32 m0, s98, 94208
    s_add_u32 s80, s44, s79
    s_addc_u32 s81, s45, 0
    global_load_lds_dwordx4 v2, s[80:81] offset:-4096
    ds_read_b128 a[224:227], v15 offset:24576
    v_mfma_f32_16x16x32_bf16 v[48:51], a[248:251], a[44:47], v[48:51]
    ds_read_b128 a[228:231], v15 offset:25600
    s_waitcnt vmcnt(22)
    v_mfma_f32_16x16x32_bf16 v[32:35], a[192:195], a[48:51], v[32:35]
    ds_read_b128 a[232:235], v15 offset:26624
    v_mfma_f32_16x16x32_bf16 v[36:39], a[196:199], a[48:51], v[36:39]
    global_load_dwordx4 a[112:115], v8, s[12:13] offset:0 sc1
    ds_read_b128 a[236:239], v15 offset:27648
    v_mfma_f32_16x16x32_bf16 v[40:43], a[200:203], a[48:51], v[40:43]
    ds_read_b128 a[240:243], v15 offset:28672
    v_mfma_f32_16x16x32_bf16 v[44:47], a[204:207], a[48:51], v[44:47]
    global_load_lds_dwordx4 v2, s[80:81] offset:-3072
    ds_read_b128 a[244:247], v15 offset:29696
    v_mfma_f32_16x16x32_bf16 v[48:51], a[208:211], a[48:51], v[48:51]
    ds_read_b128 a[248:251], v15 offset:30720
    s_waitcnt lgkmcnt(5)
    s_waitcnt vmcnt(23)
    v_mfma_f32_16x16x32_bf16 v[32:35], a[212:215], a[52:55], v[32:35]
    ds_read_b128 a[192:195], v15 offset:31744
    global_load_dwordx4 a[116:119], v8, s[12:13] offset:1024 sc1
    v_mfma_f32_16x16x32_bf16 v[36:39], a[216:219], a[52:55], v[36:39]
    ds_read_b128 a[196:199], v10 offset:49152
    v_mfma_f32_16x16x32_bf16 v[40:43], a[220:223], a[52:55], v[40:43]
    global_load_lds_dwordx4 v2, s[80:81] offset:-2048
    ds_read_b128 a[200:203], v10 offset:50176
    v_mfma_f32_16x16x32_bf16 v[44:47], a[224:227], a[52:55], v[44:47]
    ds_read_b128 a[204:207], v10 offset:51200
    v_mfma_f32_16x16x32_bf16 v[48:51], a[228:231], a[52:55], v[48:51]
    ds_read_b128 a[208:211], v10 offset:52224
    s_waitcnt lgkmcnt(5)
    s_waitcnt vmcnt(24)
    v_mfma_f32_16x16x32_bf16 v[32:35], a[232:235], a[56:59], v[32:35]
    global_load_dwordx4 a[120:123], v8, s[12:13] offset:2048 sc1
    ds_read_b128 a[212:215], v10 offset:53248
    v_mfma_f32_16x16x32_bf16 v[36:39], a[236:239], a[56:59], v[36:39]
    ds_read_b128 a[216:219], v10 offset:54272
    v_mfma_f32_16x16x32_bf16 v[40:43], a[240:243], a[56:59], v[40:43]
    global_load_lds_dwordx4 v2, s[80:81] offset:-1024
    ds_read_b128 a[220:223], v10 offset:55296
    v_mfma_f32_16x16x32_bf16 v[44:47], a[244:247], a[56:59], v[44:47]
    ds_read_b128 a[224:227], v10 offset:56320
    v_mfma_f32_16x16x32_bf16 v[48:51], a[248:251], a[56:59], v[48:51]
    ds_read_b128 a[228:231], v10 offset:57344
    s_waitcnt lgkmcnt(5)
    global_load_dwordx4 a[124:127], v8, s[12:13] offset:3072 sc1
    s_waitcnt vmcnt(26)
    v_mfma_f32_16x16x32_bf16 v[32:35], a[192:195], a[60:63], v[32:35]
    ds_read_b128 a[232:235], v10 offset:58368
    v_mfma_f32_16x16x32_bf16 v[36:39], a[196:199], a[60:63], v[36:39]
    global_load_lds_dwordx4 v2, s[80:81] offset:0
    ds_read_b128 a[236:239], v10 offset:59392
    v_mfma_f32_16x16x32_bf16 v[40:43], a[200:203], a[60:63], v[40:43]
    ds_read_b128 a[240:243], v10 offset:60416
    v_mfma_f32_16x16x32_bf16 v[44:47], a[204:207], a[60:63], v[44:47]
    ds_read_b128 a[244:247], v10 offset:61440
    v_mfma_f32_16x16x32_bf16 v[48:51], a[208:211], a[60:63], v[48:51]
    global_load_lds_dwordx4 v2, s[80:81] offset:1024
    ds_read_b128 a[248:251], v10 offset:62464
    s_waitcnt lgkmcnt(0)
    s_barrier
    s_waitcnt vmcnt(27)
    v_mfma_f32_16x16x32_bf16 v[32:35], a[212:215], a[64:67], v[32:35]
    ds_read_b128 a[192:195], v10 offset:63488
    v_mfma_f32_16x16x32_bf16 v[36:39], a[216:219], a[64:67], v[36:39]
    ds_read_b128 a[196:199], v10 offset:64512
    v_mfma_f32_16x16x32_bf16 v[40:43], a[220:223], a[64:67], v[40:43]
    global_load_dwordx4 a[128:131], v9, s[12:13] offset:-4096 sc1
    ds_read_b128 a[200:203], v2 offset:53248
    v_mfma_f32_16x16x32_bf16 v[44:47], a[224:227], a[64:67], v[44:47]
    ds_read_b128 a[204:207], v2 offset:54272
    v_mfma_f32_16x16x32_bf16 v[48:51], a[228:231], a[64:67], v[48:51]
    s_add_u32 s79, s99, 184320
    s_add_u32 m0, s99, 4096
    s_add_u32 s80, s44, s79
    s_addc_u32 s81, s45, 0
    global_load_lds_dwordx4 v2, s[80:81] offset:-4096
    ds_read_b128 a[208:211], v2 offset:55296
    s_waitcnt vmcnt(28)
    v_mfma_f32_16x16x32_bf16 v[32:35], a[232:235], a[68:71], v[32:35]
    ds_read_b128 a[212:215], v2 offset:56320
    v_mfma_f32_16x16x32_bf16 v[36:39], a[236:239], a[68:71], v[36:39]
    ds_read_b128 a[216:219], v2 offset:57344
    global_load_dwordx4 a[132:135], v9, s[12:13] offset:-3072 sc1
    v_mfma_f32_16x16x32_bf16 v[40:43], a[240:243], a[68:71], v[40:43]
    ds_read_b128 a[220:223], v2 offset:58368
    v_mfma_f32_16x16x32_bf16 v[44:47], a[244:247], a[68:71], v[44:47]
    global_load_lds_dwordx4 v2, s[80:81] offset:-3072
    ds_read_b128 a[224:227], v2 offset:59392
    v_mfma_f32_16x16x32_bf16 v[48:51], a[248:251], a[68:71], v[48:51]
    ds_read_b128 a[228:231], v2 offset:60416
    s_waitcnt lgkmcnt(5)
    s_waitcnt vmcnt(29)
    v_mfma_f32_16x16x32_bf16 v[32:35], a[192:195], a[72:75], v[32:35]
    ds_read_b128 a[232:235], v2 offset:61440
    v_mfma_f32_16x16x32_bf16 v[36:39], a[196:199], a[72:75], v[36:39]
    global_load_dwordx4 a[136:139], v9, s[12:13] offset:-2048 sc1
    ds_read_b128 a[236:239], v2 offset:62464
    v_mfma_f32_16x16x32_bf16 v[40:43], a[200:203], a[72:75], v[40:43]
    ds_read_b128 a[240:243], v2 offset:63488
    v_mfma_f32_16x16x32_bf16 v[44:47], a[204:207], a[72:75], v[44:47]
    global_load_lds_dwordx4 v2, s[80:81] offset:-2048
    ds_read_b128 a[244:247], v2 offset:64512
    v_mfma_f32_16x16x32_bf16 v[48:51], a[208:211], a[72:75], v[48:51]
    ds_read_b128 a[248:251], v15 offset:0
    s_waitcnt lgkmcnt(5)
    s_waitcnt vmcnt(30)
    v_mfma_f32_16x16x32_bf16 v[32:35], a[212:215], a[76:79], v[32:35]
    ds_read_b128 a[192:195], v15 offset:1024
    global_load_dwordx4 a[140:143], v9, s[12:13] offset:-1024 sc1
    v_mfma_f32_16x16x32_bf16 v[36:39], a[216:219], a[76:79], v[36:39]
    ds_read_b128 a[196:199], v15 offset:2048
    v_mfma_f32_16x16x32_bf16 v[40:43], a[220:223], a[76:79], v[40:43]
    global_load_lds_dwordx4 v2, s[80:81] offset:-1024
    ds_read_b128 a[200:203], v15 offset:3072
    v_mfma_f32_16x16x32_bf16 v[44:47], a[224:227], a[76:79], v[44:47]
    ds_read_b128 a[204:207], v15 offset:4096
    v_mfma_f32_16x16x32_bf16 v[48:51], a[228:231], a[76:79], v[48:51]
    ds_read_b128 a[208:211], v15 offset:5120
    s_waitcnt lgkmcnt(5)
    s_waitcnt vmcnt(31)
    v_mfma_f32_16x16x32_bf16 v[32:35], a[232:235], a[80:83], v[32:35]
    global_load_dwordx4 a[144:147], v9, s[12:13] offset:0 sc1
    ds_read_b128 a[212:215], v15 offset:6144
    ds_read_b128 a[216:219], v15 offset:7168
    v_mfma_f32_16x16x32_bf16 v[36:39], a[236:239], a[80:83], v[36:39]
    ds_read_b128 a[220:223], v15 offset:8192
    global_load_dwordx4 v[56:59], v2, s[16:17] sc1
    global_load_lds_dwordx4 v2, s[80:81] offset:0
    v_mfma_f32_16x16x32_bf16 v[40:43], a[240:243], a[80:83], v[40:43]
    ds_read_b128 a[224:227], v15 offset:9216
    global_load_dwordx4 v[60:63], v2, s[16:17] offset:1024 sc1
    v_mfma_f32_16x16x32_bf16 v[44:47], a[244:247], a[80:83], v[44:47]
    ds_read_b128 a[228:231], v15 offset:10240
    global_load_dwordx2 v[64:65], v244, s[20:21] sc1
    v_mfma_f32_16x16x32_bf16 v[48:51], a[248:251], a[80:83], v[48:51]
    s_waitcnt lgkmcnt(5)
    global_load_dwordx4 a[148:151], v9, s[12:13] offset:1024 sc1
    s_waitcnt vmcnt(36)
    v_mfma_f32_16x16x32_bf16 v[32:35], a[192:195], a[84:87], v[32:35]
    ds_read_b128 a[232:235], v15 offset:11264
    v_mfma_f32_16x16x32_bf16 v[36:39], a[196:199], a[84:87], v[36:39]
    global_load_lds_dwordx4 v2, s[80:81] offset:1024
    ds_read_b128 a[236:239], v15 offset:12288
    v_mfma_f32_16x16x32_bf16 v[40:43], a[200:203], a[84:87], v[40:43]
    ds_read_b128 a[240:243], v15 offset:13312
    v_mfma_f32_16x16x32_bf16 v[44:47], a[204:207], a[84:87], v[44:47]
    ds_read_b128 a[244:247], v15 offset:14336
    global_load_lds_dwordx4 v2, s[80:81] offset:2048
    v_mfma_f32_16x16x32_bf16 v[48:51], a[208:211], a[84:87], v[48:51]
    ds_read_b128 a[248:251], v15 offset:15360
    s_waitcnt lgkmcnt(5)
    s_waitcnt vmcnt(36)
    v_mfma_f32_16x16x32_bf16 v[32:35], a[212:215], a[88:91], v[32:35]
    ds_read_b128 a[192:195], v15 offset:16384
    v_mfma_f32_16x16x32_bf16 v[36:39], a[216:219], a[88:91], v[36:39]
    global_load_dwordx4 a[152:155], v9, s[12:13] offset:2048 sc1
    ds_read_b128 a[196:199], v15 offset:17408
    v_mfma_f32_16x16x32_bf16 v[40:43], a[220:223], a[88:91], v[40:43]
    ds_read_b128 a[200:203], v15 offset:18432
    v_mfma_f32_16x16x32_bf16 v[44:47], a[224:227], a[88:91], v[44:47]
    s_add_u32 s79, s98, 212992
    s_add_u32 m0, s98, 32768
    s_add_u32 s80, s44, s79
    s_addc_u32 s81, s45, 0
    global_load_lds_dwordx4 v2, s[80:81] offset:-4096
    ds_read_b128 a[204:207], v15 offset:19456
    v_mfma_f32_16x16x32_bf16 v[48:51], a[228:231], a[88:91], v[48:51]
    ds_read_b128 a[208:211], v15 offset:20480
    s_waitcnt vmcnt(29)
    s_waitcnt lgkmcnt(0)
    s_barrier
    v_mfma_f32_16x16x32_bf16 v[32:35], a[232:235], a[92:95], v[32:35]
    ds_read_b128 a[212:215], v15 offset:21504
    v_mfma_f32_16x16x32_bf16 v[36:39], a[236:239], a[92:95], v[36:39]
    global_load_dwordx4 a[156:159], v9, s[12:13] offset:3072 sc1
    ds_read_b128 a[216:219], v15 offset:22528
    v_mfma_f32_16x16x32_bf16 v[40:43], a[240:243], a[92:95], v[40:43]
    ds_read_b128 a[220:223], v15 offset:23552
    v_mfma_f32_16x16x32_bf16 v[44:47], a[244:247], a[92:95], v[44:47]
    global_load_lds_dwordx4 v2, s[80:81] offset:-3072
    ds_read_b128 a[224:227], v10 offset:0
    v_mfma_f32_16x16x32_bf16 v[48:51], a[248:251], a[92:95], v[48:51]
    ds_read_b128 a[228:231], v10 offset:1024
    v_mfma_f32_16x16x32_bf16 v[32:35], a[192:195], a[96:99], v[32:35]
    ds_read_b128 a[232:235], v10 offset:2048
    global_load_dwordx4 a[160:163], v5, s[14:15] offset:-4096 sc1
    v_mfma_f32_16x16x32_bf16 v[36:39], a[196:199], a[96:99], v[36:39]
    ds_read_b128 a[236:239], v10 offset:3072
    v_mfma_f32_16x16x32_bf16 v[40:43], a[200:203], a[96:99], v[40:43]
    global_load_lds_dwordx4 v2, s[80:81] offset:-2048
    ds_read_b128 a[240:243], v10 offset:4096
    v_mfma_f32_16x16x32_bf16 v[44:47], a[204:207], a[96:99], v[44:47]
    ds_read_b128 a[244:247], v10 offset:5120
    v_mfma_f32_16x16x32_bf16 v[48:51], a[208:211], a[96:99], v[48:51]
    ds_read_b128 a[248:251], v10 offset:6144
    s_waitcnt lgkmcnt(5)
    v_mfma_f32_16x16x32_bf16 v[32:35], a[212:215], a[100:103], v[32:35]
    global_load_dwordx4 a[164:167], v5, s[14:15] offset:-3072 sc1
    ds_read_b128 a[192:195], v10 offset:7168
    v_mfma_f32_16x16x32_bf16 v[36:39], a[216:219], a[100:103], v[36:39]
    ds_read_b128 a[196:199], v10 offset:8192
    v_mfma_f32_16x16x32_bf16 v[40:43], a[220:223], a[100:103], v[40:43]
    global_load_lds_dwordx4 v2, s[80:81] offset:-1024
    ds_read_b128 a[200:203], v10 offset:9216
    v_mfma_f32_16x16x32_bf16 v[44:47], a[224:227], a[100:103], v[44:47]
    ds_read_b128 a[204:207], v10 offset:10240
    v_mfma_f32_16x16x32_bf16 v[48:51], a[228:231], a[100:103], v[48:51]
    ds_read_b128 a[208:211], v10 offset:11264
    s_waitcnt lgkmcnt(5)
    global_load_dwordx4 a[168:171], v5, s[14:15] offset:-2048 sc1
    v_mfma_f32_16x16x32_bf16 v[32:35], a[232:235], a[104:107], v[32:35]
    ds_read_b128 a[212:215], v10 offset:12288
    v_mfma_f32_16x16x32_bf16 v[36:39], a[236:239], a[104:107], v[36:39]
    global_load_lds_dwordx4 v2, s[80:81] offset:0
    ds_read_b128 a[216:219], v10 offset:13312
    v_mfma_f32_16x16x32_bf16 v[40:43], a[240:243], a[104:107], v[40:43]
    ds_read_b128 a[220:223], v10 offset:14336
    v_mfma_f32_16x16x32_bf16 v[44:47], a[244:247], a[104:107], v[44:47]
    ds_read_b128 a[224:227], v10 offset:15360
    v_mfma_f32_16x16x32_bf16 v[48:51], a[248:251], a[104:107], v[48:51]
    global_load_lds_dwordx4 v2, s[80:81] offset:1024
    ds_read_b128 a[228:231], v10 offset:16384
    s_waitcnt lgkmcnt(5)
    s_waitcnt vmcnt(37)
    v_mfma_f32_16x16x32_bf16 v[32:35], a[192:195], a[108:111], v[32:35]
    ds_read_b128 a[232:235], v10 offset:17408
    v_mfma_f32_16x16x32_bf16 v[36:39], a[196:199], a[108:111], v[36:39]
    ds_read_b128 a[236:239], v10 offset:18432
    v_mfma_f32_16x16x32_bf16 v[40:43], a[200:203], a[108:111], v[40:43]
    global_load_dwordx4 a[172:175], v5, s[14:15] offset:-1024 sc1
    ds_read_b128 a[240:243], v10 offset:19456
    v_mfma_f32_16x16x32_bf16 v[44:47], a[204:207], a[108:111], v[44:47]
    ds_read_b128 a[244:247], v10 offset:20480
    v_mfma_f32_16x16x32_bf16 v[48:51], a[208:211], a[108:111], v[48:51]
    s_add_u32 s79, s100, 237568
    s_add_u32 m0, s100, 57344
    s_add_u32 s80, s44, s79
    s_addc_u32 s81, s45, 0
    global_load_lds_dwordx4 v2, s[80:81] offset:-4096
    ds_read_b128 a[248:251], v10 offset:21504
    s_waitcnt vmcnt(29)
    s_barrier
    s_waitcnt lgkmcnt(5)
    v_mfma_f32_16x16x32_bf16 v[32:35], a[212:215], a[112:115], v[32:35]
    ds_read_b128 a[192:195], v10 offset:22528
    v_mfma_f32_16x16x32_bf16 v[36:39], a[216:219], a[112:115], v[36:39]
    global_load_dwordx4 a[176:179], v5, s[14:15] offset:0 sc1
    ds_read_b128 a[196:199], v10 offset:23552
    v_mfma_f32_16x16x32_bf16 v[40:43], a[220:223], a[112:115], v[40:43]
    ds_read_b128 a[200:203], v10 offset:24576
    v_mfma_f32_16x16x32_bf16 v[44:47], a[224:227], a[112:115], v[44:47]
    global_load_lds_dwordx4 v2, s[80:81] offset:-3072
    ds_read_b128 a[204:207], v10 offset:25600
    v_mfma_f32_16x16x32_bf16 v[48:51], a[228:231], a[112:115], v[48:51]
    ds_read_b128 a[208:211], v10 offset:26624
    s_waitcnt lgkmcnt(5)
    v_mfma_f32_16x16x32_bf16 v[32:35], a[232:235], a[116:119], v[32:35]
    ds_read_b128 a[212:215], v10 offset:27648
    v_mfma_f32_16x16x32_bf16 v[36:39], a[236:239], a[116:119], v[36:39]
    global_load_dwordx4 a[180:183], v5, s[14:15] offset:1024 sc1
    ds_read_b128 a[216:219], v10 offset:28672
    v_mfma_f32_16x16x32_bf16 v[40:43], a[240:243], a[116:119], v[40:43]
    ds_read_b128 a[220:223], v10 offset:29696
    v_mfma_f32_16x16x32_bf16 v[44:47], a[244:247], a[116:119], v[44:47]
    global_load_lds_dwordx4 v2, s[80:81] offset:-2048
    ds_read_b128 a[224:227], v10 offset:30720
    v_mfma_f32_16x16x32_bf16 v[48:51], a[248:251], a[116:119], v[48:51]
    ds_read_b128 a[228:231], v10 offset:31744
    s_waitcnt lgkmcnt(5)
    v_mfma_f32_16x16x32_bf16 v[32:35], a[192:195], a[120:123], v[32:35]
    ds_read_b128 a[232:235], v10 offset:32768
    global_load_dwordx4 a[184:187], v5, s[14:15] offset:2048 sc1
    v_mfma_f32_16x16x32_bf16 v[36:39], a[196:199], a[120:123], v[36:39]
    ds_read_b128 a[236:239], v10 offset:33792
    v_mfma_f32_16x16x32_bf16 v[40:43], a[200:203], a[120:123], v[40:43]
    ds_read_b128 a[240:243], v10 offset:34816
    v_mfma_f32_16x16x32_bf16 v[44:47], a[204:207], a[120:123], v[44:47]
    ds_read_b128 a[244:247], v10 offset:35840
    v_mfma_f32_16x16x32_bf16 v[48:51], a[208:211], a[120:123], v[48:51]
    ds_read_b128 a[248:251], v10 offset:36864
    s_waitcnt lgkmcnt(5)
    global_load_dwordx4 a[188:191], v5, s[14:15] offset:3072 sc1
    v_mfma_f32_16x16x32_bf16 v[32:35], a[212:215], a[124:127], v[32:35]
    ds_read_b128 a[192:195], v10 offset:37888
    v_mfma_f32_16x16x32_bf16 v[36:39], a[216:219], a[124:127], v[36:39]
    ds_read_b128 a[196:199], v10 offset:38912
    v_mfma_f32_16x16x32_bf16 v[40:43], a[220:223], a[124:127], v[40:43]
    ds_read_b128 a[200:203], v10 offset:39936
    v_mfma_f32_16x16x32_bf16 v[44:47], a[224:227], a[124:127], v[44:47]
    ds_read_b128 a[204:207], v10 offset:40960
    v_mfma_f32_16x16x32_bf16 v[48:51], a[228:231], a[124:127], v[48:51]
    ds_read_b128 a[208:211], v10 offset:41984
    s_waitcnt lgkmcnt(5)
    s_waitcnt vmcnt(34)
    v_mfma_f32_16x16x32_bf16 v[32:35], a[232:235], a[128:131], v[32:35]
    ds_read_b128 a[212:215], v10 offset:43008
    v_mfma_f32_16x16x32_bf16 v[36:39], a[236:239], a[128:131], v[36:39]
    ds_read_b128 a[216:219], v10 offset:44032
    v_mfma_f32_16x16x32_bf16 v[40:43], a[240:243], a[128:131], v[40:43]
    ds_read_b128 a[220:223], v10 offset:45056
    v_mfma_f32_16x16x32_bf16 v[44:47], a[244:247], a[128:131], v[44:47]
    ds_read_b128 a[224:227], v10 offset:46080
    v_mfma_f32_16x16x32_bf16 v[48:51], a[248:251], a[128:131], v[48:51]
    ds_read_b128 a[228:231], v10 offset:47104
    s_waitcnt vmcnt(19)
    s_barrier
    s_waitcnt lgkmcnt(5)
    v_mfma_f32_16x16x32_bf16 v[32:35], a[192:195], a[132:135], v[32:35]
    ds_read_b128 a[232:235], v10 offset:48128
    v_mfma_f32_16x16x32_bf16 v[36:39], a[196:199], a[132:135], v[36:39]
    ds_read_b128 a[236:239], v2 offset:0
    v_mfma_f32_16x16x32_bf16 v[40:43], a[200:203], a[132:135], v[40:43]
    ds_read_b128 a[240:243], v2 offset:1024
    v_mfma_f32_16x16x32_bf16 v[44:47], a[204:207], a[132:135], v[44:47]
    ds_read_b128 a[244:247], v2 offset:2048
    v_mfma_f32_16x16x32_bf16 v[48:51], a[208:211], a[132:135], v[48:51]
    ds_read_b128 a[248:251], v2 offset:3072
    s_waitcnt lgkmcnt(5)
    v_mfma_f32_16x16x32_bf16 v[32:35], a[212:215], a[136:139], v[32:35]
    ds_read_b128 a[192:195], v2 offset:4096
    v_mfma_f32_16x16x32_bf16 v[36:39], a[216:219], a[136:139], v[36:39]
    ds_read_b128 a[196:199], v2 offset:5120
    v_mfma_f32_16x16x32_bf16 v[40:43], a[220:223], a[136:139], v[40:43]
    ds_read_b128 a[200:203], v2 offset:6144
    v_mfma_f32_16x16x32_bf16 v[44:47], a[224:227], a[136:139], v[44:47]
    ds_read_b128 a[204:207], v2 offset:7168
    v_mfma_f32_16x16x32_bf16 v[48:51], a[228:231], a[136:139], v[48:51]
    ds_read_b128 a[208:211], v2 offset:8192
    s_waitcnt lgkmcnt(5)
    v_mfma_f32_16x16x32_bf16 v[32:35], a[232:235], a[140:143], v[32:35]
    ds_read_b128 a[212:215], v2 offset:9216
    v_mfma_f32_16x16x32_bf16 v[36:39], a[236:239], a[140:143], v[36:39]
    ds_read_b128 a[216:219], v2 offset:10240
    v_mfma_f32_16x16x32_bf16 v[40:43], a[240:243], a[140:143], v[40:43]
    ds_read_b128 a[220:223], v2 offset:11264
    v_mfma_f32_16x16x32_bf16 v[44:47], a[244:247], a[140:143], v[44:47]
    ds_read_b128 a[224:227], v2 offset:12288
    v_mfma_f32_16x16x32_bf16 v[48:51], a[248:251], a[140:143], v[48:51]
    ds_read_b128 a[228:231], v2 offset:13312
    s_waitcnt lgkmcnt(5)
    v_mfma_f32_16x16x32_bf16 v[32:35], a[192:195], a[144:147], v[32:35]
    ds_read_b128 a[232:235], v2 offset:14336
    v_mfma_f32_16x16x32_bf16 v[36:39], a[196:199], a[144:147], v[36:39]
    ds_read_b128 a[236:239], v2 offset:15360
    v_mfma_f32_16x16x32_bf16 v[40:43], a[200:203], a[144:147], v[40:43]
    ds_read_b128 a[240:243], v2 offset:16384
    v_mfma_f32_16x16x32_bf16 v[44:47], a[204:207], a[144:147], v[44:47]
    ds_read_b128 a[244:247], v2 offset:17408
    v_mfma_f32_16x16x32_bf16 v[48:51], a[208:211], a[144:147], v[48:51]
    ds_read_b128 a[248:251], v2 offset:18432
    s_waitcnt lgkmcnt(5)
    v_mfma_f32_16x16x32_bf16 v[32:35], a[212:215], a[148:151], v[32:35]
    ds_read_b128 a[192:195], v2 offset:19456
    v_mfma_f32_16x16x32_bf16 v[36:39], a[216:219], a[148:151], v[36:39]
    ds_read_b128 a[196:199], v2 offset:20480
    v_mfma_f32_16x16x32_bf16 v[40:43], a[220:223], a[148:151], v[40:43]
    ds_read_b128 a[200:203], v2 offset:21504
    v_mfma_f32_16x16x32_bf16 v[44:47], a[224:227], a[148:151], v[44:47]
    ds_read_b128 a[204:207], v2 offset:22528
    v_mfma_f32_16x16x32_bf16 v[48:51], a[228:231], a[148:151], v[48:51]
    ds_read_b128 a[208:211], v2 offset:23552
    s_waitcnt vmcnt(8)
    s_barrier
    s_waitcnt lgkmcnt(5)
    v_mfma_f32_16x16x32_bf16 v[32:35], a[232:235], a[152:155], v[32:35]
    ds_read_b128 a[212:215], v2 offset:24576
    v_mfma_f32_16x16x32_bf16 v[36:39], a[236:239], a[152:155], v[36:39]
    ds_read_b128 a[216:219], v2 offset:25600
    v_mfma_f32_16x16x32_bf16 v[40:43], a[240:243], a[152:155], v[40:43]
    ds_read_b128 a[220:223], v2 offset:26624
    v_mfma_f32_16x16x32_bf16 v[44:47], a[244:247], a[152:155], v[44:47]
    ds_read_b128 a[224:227], v2 offset:27648
    v_mfma_f32_16x16x32_bf16 v[48:51], a[248:251], a[152:155], v[48:51]
    ds_read_b128 a[228:231], v2 offset:28672
    s_waitcnt lgkmcnt(5)
    v_mfma_f32_16x16x32_bf16 v[32:35], a[192:195], a[156:159], v[32:35]
    ds_read_b128 a[232:235], v2 offset:29696
    v_mfma_f32_16x16x32_bf16 v[36:39], a[196:199], a[156:159], v[36:39]
    ds_read_b128 a[236:239], v2 offset:30720
    v_mfma_f32_16x16x32_bf16 v[40:43], a[200:203], a[156:159], v[40:43]
    ds_read_b128 a[240:243], v2 offset:31744
    v_mfma_f32_16x16x32_bf16 v[44:47], a[204:207], a[156:159], v[44:47]
    ds_read_b128 a[244:247], v2 offset:32768
    v_mfma_f32_16x16x32_bf16 v[48:51], a[208:211], a[156:159], v[48:51]
    ds_read_b128 a[248:251], v2 offset:33792
    s_waitcnt lgkmcnt(5)
    v_mfma_f32_16x16x32_bf16 v[32:35], a[212:215], a[160:163], v[32:35]
    ds_read_b128 a[192:195], v2 offset:34816
    v_mfma_f32_16x16x32_bf16 v[36:39], a[216:219], a[160:163], v[36:39]
    ds_read_b128 a[196:199], v2 offset:35840
    v_mfma_f32_16x16x32_bf16 v[40:43], a[220:223], a[160:163], v[40:43]
    ds_read_b128 a[200:203], v2 offset:36864
    v_mfma_f32_16x16x32_bf16 v[44:47], a[224:227], a[160:163], v[44:47]
    ds_read_b128 a[204:207], v2 offset:37888
    v_mfma_f32_16x16x32_bf16 v[48:51], a[228:231], a[160:163], v[48:51]
    ds_read_b128 a[208:211], v2 offset:38912
    s_waitcnt lgkmcnt(5)
    v_mfma_f32_16x16x32_bf16 v[32:35], a[232:235], a[164:167], v[32:35]
    ds_read_b128 a[212:215], v2 offset:39936
    v_mfma_f32_16x16x32_bf16 v[36:39], a[236:239], a[164:167], v[36:39]
    ds_read_b128 a[216:219], v2 offset:40960
    v_mfma_f32_16x16x32_bf16 v[40:43], a[240:243], a[164:167], v[40:43]
    ds_read_b128 a[220:223], v2 offset:41984
    v_mfma_f32_16x16x32_bf16 v[44:47], a[244:247], a[164:167], v[44:47]
    ds_read_b128 a[224:227], v2 offset:43008
    v_mfma_f32_16x16x32_bf16 v[48:51], a[248:251], a[164:167], v[48:51]
    ds_read_b128 a[228:231], v2 offset:44032
    s_waitcnt lgkmcnt(5)
    v_mfma_f32_16x16x32_bf16 v[32:35], a[192:195], a[168:171], v[32:35]
    ds_read_b128 a[232:235], v2 offset:45056
    v_mfma_f32_16x16x32_bf16 v[36:39], a[196:199], a[168:171], v[36:39]
    ds_read_b128 a[236:239], v2 offset:46080
    v_mfma_f32_16x16x32_bf16 v[40:43], a[200:203], a[168:171], v[40:43]
    ds_read_b128 a[240:243], v2 offset:47104
    v_mfma_f32_16x16x32_bf16 v[44:47], a[204:207], a[168:171], v[44:47]
    ds_read_b128 a[244:247], v2 offset:48128
    v_mfma_f32_16x16x32_bf16 v[48:51], a[208:211], a[168:171], v[48:51]
    ds_read_b128 a[248:251], v2 offset:49152
    s_waitcnt vmcnt(2)
    s_barrier
    s_waitcnt lgkmcnt(5)
    v_mfma_f32_16x16x32_bf16 v[32:35], a[212:215], a[172:175], v[32:35]
    ds_read_b128 a[192:195], v2 offset:50176
    ds_read_b128 a[196:199], v2 offset:51200
    v_mfma_f32_16x16x32_bf16 v[36:39], a[216:219], a[172:175], v[36:39]
    ds_read_b128 a[200:203], v2 offset:52224
    v_lshlrev_b32 v72, 16, v56
    v_mfma_f32_16x16x32_bf16 v[40:43], a[220:223], a[172:175], v[40:43]
    ds_read_b128 a[204:207], v2 offset:53248
    v_and_b32 v73, 0xffff0000, v56
    v_mfma_f32_16x16x32_bf16 v[44:47], a[224:227], a[172:175], v[44:47]
    ds_read_b128 a[208:211], v2 offset:54272
    v_lshlrev_b32 v74, 16, v57
    v_mfma_f32_16x16x32_bf16 v[48:51], a[228:231], a[172:175], v[48:51]
    v_and_b32 v75, 0xffff0000, v57
    s_waitcnt lgkmcnt(5)
    v_mfma_f32_16x16x32_bf16 v[32:35], a[232:235], a[176:179], v[32:35]
    ds_read_b128 a[212:215], v2 offset:55296
    ds_read_b128 a[216:219], v2 offset:56320
    v_mfma_f32_16x16x32_bf16 v[36:39], a[236:239], a[176:179], v[36:39]
    ds_read_b128 a[220:223], v2 offset:57344
    v_lshlrev_b32 v76, 16, v58
    v_mfma_f32_16x16x32_bf16 v[40:43], a[240:243], a[176:179], v[40:43]
    ds_read_b128 a[224:227], v2 offset:58368
    v_and_b32 v77, 0xffff0000, v58
    v_mfma_f32_16x16x32_bf16 v[44:47], a[244:247], a[176:179], v[44:47]
    ds_read_b128 a[228:231], v2 offset:59392
    v_lshlrev_b32 v78, 16, v59
    v_mfma_f32_16x16x32_bf16 v[48:51], a[248:251], a[176:179], v[48:51]
    v_and_b32 v79, 0xffff0000, v59
    s_waitcnt lgkmcnt(5)
    v_mfma_f32_16x16x32_bf16 v[32:35], a[192:195], a[180:183], v[32:35]
    ds_read_b128 a[232:235], v2 offset:60416
    ds_read_b128 a[236:239], v2 offset:61440
    v_mfma_f32_16x16x32_bf16 v[36:39], a[196:199], a[180:183], v[36:39]
    ds_read_b128 a[240:243], v2 offset:62464
    v_lshlrev_b32 v80, 16, v60
    v_mfma_f32_16x16x32_bf16 v[40:43], a[200:203], a[180:183], v[40:43]
    ds_read_b128 a[244:247], v2 offset:63488
    v_and_b32 v81, 0xffff0000, v60
    v_mfma_f32_16x16x32_bf16 v[44:47], a[204:207], a[180:183], v[44:47]
    ds_read_b128 a[248:251], v2 offset:64512
    v_lshlrev_b32 v82, 16, v61
    v_mfma_f32_16x16x32_bf16 v[48:51], a[208:211], a[180:183], v[48:51]
    v_and_b32 v83, 0xffff0000, v61
    s_waitcnt lgkmcnt(5)
    s_waitcnt vmcnt(1)
    v_mfma_f32_16x16x32_bf16 v[32:35], a[212:215], a[184:187], v[32:35]
    v_lshlrev_b32 v84, 16, v62
    v_mfma_f32_16x16x32_bf16 v[36:39], a[216:219], a[184:187], v[36:39]
    v_and_b32 v85, 0xffff0000, v62
    v_mfma_f32_16x16x32_bf16 v[40:43], a[220:223], a[184:187], v[40:43]
    v_lshlrev_b32 v86, 16, v63
    v_mfma_f32_16x16x32_bf16 v[44:47], a[224:227], a[184:187], v[44:47]
    v_and_b32 v87, 0xffff0000, v63
    v_mfma_f32_16x16x32_bf16 v[48:51], a[228:231], a[184:187], v[48:51]
    s_waitcnt lgkmcnt(0)
    s_waitcnt vmcnt(0)
    v_mfma_f32_16x16x32_bf16 v[32:35], a[232:235], a[188:191], v[32:35]
    v_lshlrev_b32 v88, 16, v64
    v_mfma_f32_16x16x32_bf16 v[36:39], a[236:239], a[188:191], v[36:39]
    v_and_b32 v89, 0xffff0000, v64
    v_mfma_f32_16x16x32_bf16 v[40:43], a[240:243], a[188:191], v[40:43]
    v_lshlrev_b32 v90, 16, v65
    v_mfma_f32_16x16x32_bf16 v[44:47], a[244:247], a[188:191], v[44:47]
    v_and_b32 v91, 0xffff0000, v65
    v_mfma_f32_16x16x32_bf16 v[48:51], a[248:251], a[188:191], v[48:51]
    s_barrier
    v_pk_add_f32 v[72:73], v[72:73], v[32:33]
    v_pk_add_f32 v[74:75], v[74:75], v[34:35]
    v_pk_add_f32 v[76:77], v[76:77], v[36:37]
    v_pk_add_f32 v[78:79], v[78:79], v[38:39]
    v_pk_add_f32 v[80:81], v[80:81], v[40:41]
    v_pk_add_f32 v[82:83], v[82:83], v[42:43]
    v_pk_add_f32 v[84:85], v[84:85], v[44:45]
    v_pk_add_f32 v[86:87], v[86:87], v[46:47]
    v_pk_add_f32 v[88:89], v[88:89], v[48:49]
    v_pk_add_f32 v[90:91], v[90:91], v[50:51]
    v_cvt_pk_bf16_f32 v96, v72, v73
    v_cvt_pk_bf16_f32 v97, v74, v75
    v_cvt_pk_bf16_f32 v98, v76, v77
    v_cvt_pk_bf16_f32 v99, v78, v79
    v_cvt_pk_bf16_f32 v100, v80, v81
    v_cvt_pk_bf16_f32 v101, v82, v83
    v_cvt_pk_bf16_f32 v102, v84, v85
    v_cvt_pk_bf16_f32 v103, v86, v87
    v_cvt_pk_bf16_f32 v104, v88, v89
    v_cvt_pk_bf16_f32 v105, v90, v91
    s_mul_i32 s30, s74, 20480
    s_mul_i32 s31, s75, 160
    s_add_u32 s30, s30, s31
    s_and_b32 s32, s75, 1
    s_lshl_b32 s33, s32, 5
    s_add_u32 s33, s33, s30
    s_add_u32 s90, s18, s33
    s_addc_u32 s91, s19, 0
    s_cmp_eq_u32 s32, 0
    s_cselect_b32 s33, 128, 0
    s_add_u32 s33, s33, s30
    s_add_u32 s92, s18, s33
    s_addc_u32 s93, s19, 0
    v_mul_u32_u24 v12, 1280, v3
    v_lshl_add_u32 v13, v4, 4, v12
    v_lshl_add_u32 v14, v4, 3, v12
    global_store_dwordx4 v13, v[96:99], s[90:91]
    global_store_dwordx4 v13, v[100:103], s[90:91] offset:64
    global_store_dwordx2 v14, v[104:105], s[92:93]
    s_waitcnt vmcnt(0)
    s_nop 0
L_done:
    s_endpgm
.section .rodata,"a"
.p2align 6
.amdhsa_kernel interleave_layers__linear_kernel_hedgehog__geglu_ffn__prompt_kernel
  .amdhsa_next_free_vgpr 512
  .amdhsa_next_free_sgpr 102
  .amdhsa_accum_offset 256
  .amdhsa_group_segment_fixed_size 0
  .amdhsa_kernarg_size 88
  .amdhsa_user_sgpr_count 2
  .amdhsa_user_sgpr_kernarg_segment_ptr 1
  .amdhsa_system_sgpr_workgroup_id_x 1
.end_amdhsa_kernel
```
